```python
import torch

def _softmax(x, axis=-1):
    return torch.softmax(x, dim=axis)
def _gelu(x):
    return torch.nn.functional.gelu(x, approximate="tanh")
def _silu(x):
    return torch.nn.functional.silu(x)
def _sigmoid(x):
    return torch.sigmoid(x)
def _layernorm(x, axis=-1, eps=1e-5):
    m = x.mean(dim=axis, keepdim=True)
    v = x.var(dim=axis, keepdim=True, unbiased=False)
    return (x - m) / torch.sqrt(v + eps)
def _scatter_add(tgt, idx, src, axis=0):
    return tgt.clone().index_add_(axis, idx, src)
def _segment_sum(src, seg, n):
    out = torch.zeros((n,) + src.shape[1:], dtype=src.dtype)
    return out.index_add_(0, seg, src)
def _pad(x, pw):
    flat = tuple(v for pair in reversed(pw) for v in pair)
    return torch.nn.functional.pad(x, flat)

kernel_name = 'standalone__mha_block_cached__near_ridge'

def setup_inputs():

    _w = (lambda a: (lambda t: t.to(torch.bfloat16) if t.is_floating_point() else t)(torch.as_tensor(a)))
    B, Sq, D = 8, 96, 512
    H, Sk, Dh = 32, 1024, 128
    return {
        "x": _w((lambda *s: torch.randn(*s, dtype=torch.bfloat16) * 0.8)(B, Sq, D)),
        "k_cache": _w((lambda *s: torch.randn(*s, dtype=torch.bfloat16) * 0.8)(B, H, Sk, Dh)),
        "v_cache": _w((lambda *s: torch.randn(*s, dtype=torch.bfloat16) * 0.05)(B, H, Sk, Dh)),
        "wq": _w((lambda *s: torch.randn(*s, dtype=torch.bfloat16) * 0.8)(D, H * Dh) * (D ** -0.5)),
        "wo": _w((lambda *s: torch.randn(*s, dtype=torch.bfloat16) * 0.05)(H * Dh, D) * ((H * Dh) ** -0.5)),
    }

def reference(x, k_cache, v_cache, wq, wo):
    B, Sq, D = x.shape
    H, Dh = 32, 128
    q = (lambda x, *d: x.permute(*d))((x @ wq).reshape(B, Sq, H, Dh), 0, 2, 1, 3)
    scores = torch.einsum("bhqd,bhkd->bhqk", q, k_cache) * (Dh ** -0.5)
    p = _softmax(scores, axis=-1)
    o = torch.einsum("bhqk,bhkd->bhqd", p, v_cache)
    return (lambda x, *d: x.permute(*d))(o, 0, 2, 1, 3).reshape(B, Sq, H * Dh) @ wo
```

```asm
; @launch grid=(256,1,1) block=(256,1,1) lds=163840
.amdgcn_target "amdgcn-amd-amdhsa--gfx950"
.text
.globl standalone__mha_block_cached__near_ridge_kernel
.p2align 8
.type standalone__mha_block_cached__near_ridge_kernel,@function
standalone__mha_block_cached__near_ridge_kernel:
    s_cmp_ge_u32 s2, 256
    s_cbranch_scc1 L_end
    s_load_dwordx16 s[4:19], s[0:1], 0
    s_getpc_b64 s[76:77]
L_pcref:
    s_lshr_b32 s65, s2, 3
    s_lshl_b32 s65, s65, 11
    v_lshl_add_u32 v2, v0, 3, s65
    v_min_u32 v2, L_end-L_pcref-8, v2
    global_load_dwordx2 v[56:57], v2, s[76:77]
    v_lshrrev_b32 v1, 6, v0
    v_and_b32 v0, 63, v0
    v_readfirstlane_b32 s3, v1
    s_lshr_b32 s60, s2, 5
    s_and_b32 s61, s2, 31
    s_and_b32 s62, s2, 7
    s_lshr_b32 s63, s61, 3
    s_cmp_eq_u32 s3, 3
    s_cbranch_scc0 L_compute
    v_lshrrev_b32 v2, 4, v0
    v_and_b32 v3, 15, v0
    v_lshlrev_b32 v4, 2, v2
    v_xor_b32 v4, v4, v3
    v_lshlrev_b32 v5, 4, v4
    v_add_u32 v4, 0, v2
    v_xor_b32 v8, v4, v3
    v_lshlrev_b32 v8, 4, v8
    v_lshl_add_u32 v18, v2, 8, v8
    v_lshl_add_u32 v4, v4, 13, v5
    v_subrev_u32 v14, 0, v4
    v_add_u32 v4, 0, v2
    v_lshl_add_u32 v24, v4, 10, v5
    v_lshl_add_u32 v10, v4, 10, v8
    v_add_u32 v4, 4, v2
    v_xor_b32 v8, v4, v3
    v_lshlrev_b32 v8, 4, v8
    v_lshl_add_u32 v19, v2, 8, v8
    v_lshl_add_u32 v4, v4, 13, v5
    v_subrev_u32 v15, 1024, v4
    v_add_u32 v4, 3, v2
    v_lshl_add_u32 v25, v4, 10, v5
    v_lshl_add_u32 v11, v4, 10, v8
    v_add_u32 v4, 8, v2
    v_xor_b32 v8, v4, v3
    v_lshlrev_b32 v8, 4, v8
    v_lshl_add_u32 v20, v2, 8, v8
    v_lshl_add_u32 v4, v4, 13, v5
    v_subrev_u32 v16, 2048, v4
    v_add_u32 v4, 6, v2
    v_lshl_add_u32 v26, v4, 10, v5
    v_lshl_add_u32 v12, v4, 10, v8
    v_add_u32 v4, 12, v2
    v_xor_b32 v8, v4, v3
    v_lshlrev_b32 v8, 4, v8
    v_lshl_add_u32 v21, v2, 8, v8
    v_lshl_add_u32 v4, v4, 13, v5
    v_subrev_u32 v17, 3072, v4
    v_add_u32 v4, 9, v2
    v_lshl_add_u32 v27, v4, 10, v5
    v_lshl_add_u32 v13, v4, 10, v8
    v_lshl_add_u32 v22, v2, 8, v5
    v_lshlrev_b32 v6, 2, v0
    v_add_u32 v6, 155648, v6
    v_mov_b32 v8, 0
    v_and_b32 v7, 3, v0
    v_lshlrev_b32 v7, 8, v7
    v_add_u32 v7, 155904, v7
    s_add_u32 s64, s60, s63
    s_mul_i32 s65, s60, 98304
    s_lshl_b32 s67, s61, 8
    s_waitcnt lgkmcnt(0)
    s_add_u32 s28, s4, s65
    s_addc_u32 s29, s5, 0
    s_mov_b32 s30, 98304
    s_mov_b32 s31, 0x20000
    s_add_u32 s65, s64, 0
    s_and_b32 s65, s65, 3
    s_lshl_b32 s66, s65, 8
    s_mov_b32 m0, 32768
    s_nop 0
    buffer_load_dwordx4 v10, s[28:31], s66 offen offset:0  lds
    buffer_load_dwordx4 v11, s[28:31], s66 offen offset:1024  lds
    buffer_load_dwordx4 v12, s[28:31], s66 offen offset:2048  lds
    buffer_load_dwordx4 v13, s[28:31], s66 offen offset:3072  lds
    s_mov_b32 m0, 36864
    s_add_u32 s66, s66, 16384
    buffer_load_dwordx4 v10, s[28:31], s66 offen offset:0  lds
    buffer_load_dwordx4 v11, s[28:31], s66 offen offset:1024  lds
    buffer_load_dwordx4 v12, s[28:31], s66 offen offset:2048  lds
    buffer_load_dwordx4 v13, s[28:31], s66 offen offset:3072  lds
    s_lshl_b32 s66, s65, 8
    s_add_u32 s66, s66, 32768
    s_mov_b32 m0, 40960
    s_nop 0
    buffer_load_dwordx4 v10, s[28:31], s66 offen offset:0  lds
    buffer_load_dwordx4 v11, s[28:31], s66 offen offset:1024  lds
    buffer_load_dwordx4 v12, s[28:31], s66 offen offset:2048  lds
    buffer_load_dwordx4 v13, s[28:31], s66 offen offset:3072  lds
    s_mov_b32 m0, 45056
    s_add_u32 s66, s66, 16384
    buffer_load_dwordx4 v10, s[28:31], s66 offen offset:0  lds
    buffer_load_dwordx4 v11, s[28:31], s66 offen offset:1024  lds
    buffer_load_dwordx4 v12, s[28:31], s66 offen offset:2048  lds
    buffer_load_dwordx4 v13, s[28:31], s66 offen offset:3072  lds
    s_lshl_b32 s66, s65, 8
    s_add_u32 s66, s66, 65536
    s_mov_b32 m0, 49152
    s_nop 0
    buffer_load_dwordx4 v10, s[28:31], s66 offen offset:0  lds
    buffer_load_dwordx4 v11, s[28:31], s66 offen offset:1024  lds
    buffer_load_dwordx4 v12, s[28:31], s66 offen offset:2048  lds
    buffer_load_dwordx4 v13, s[28:31], s66 offen offset:3072  lds
    s_mov_b32 m0, 53248
    s_add_u32 s66, s66, 16384
    buffer_load_dwordx4 v10, s[28:31], s66 offen offset:0  lds
    buffer_load_dwordx4 v11, s[28:31], s66 offen offset:1024  lds
    buffer_load_dwordx4 v12, s[28:31], s66 offen offset:2048  lds
    buffer_load_dwordx4 v13, s[28:31], s66 offen offset:3072  lds
    s_add_u32 s32, s10, s67
    s_addc_u32 s33, s11, 0
    s_sub_u32 s34, 0x400000, s67
    s_mov_b32 s35, 0x20000
    ds_write_b32 v6, v8
    ds_write_b32 v6, v8 offset:1536
    ds_write_b32 v6, v8 offset:1792
    s_waitcnt lgkmcnt(0)
    s_barrier
    s_lshl_b32 s66, s65, 20
    s_mov_b32 m0, 65536
    s_nop 0
    buffer_load_dwordx4 v14, s[32:35], s66 offen offset:0  lds
    buffer_load_dwordx4 v15, s[32:35], s66 offen offset:1024  lds
    buffer_load_dwordx4 v16, s[32:35], s66 offen offset:2048  lds
    buffer_load_dwordx4 v17, s[32:35], s66 offen offset:3072  lds
    s_mov_b32 m0, 69632
    s_add_u32 s66, s66, 131072
    buffer_load_dwordx4 v14, s[32:35], s66 offen offset:0  lds
    buffer_load_dwordx4 v15, s[32:35], s66 offen offset:1024  lds
    s_waitcnt vmcnt(30)
    buffer_load_dwordx4 v16, s[32:35], s66 offen offset:2048  lds
    buffer_load_dwordx4 v17, s[32:35], s66 offen offset:3072  lds
    s_lshl_b32 s66, s65, 20
    s_add_u32 s66, s66, 262144
    s_mov_b32 m0, 73728
    s_waitcnt vmcnt(30)
    buffer_load_dwordx4 v14, s[32:35], s66 offen offset:0  lds
    buffer_load_dwordx4 v15, s[32:35], s66 offen offset:1024  lds
    s_waitcnt vmcnt(30)
    buffer_load_dwordx4 v16, s[32:35], s66 offen offset:2048  lds
    buffer_load_dwordx4 v17, s[32:35], s66 offen offset:3072  lds
    s_mov_b32 m0, 77824
    s_add_u32 s66, s66, 131072
    s_waitcnt vmcnt(30)
    buffer_load_dwordx4 v14, s[32:35], s66 offen offset:0  lds
    buffer_load_dwordx4 v15, s[32:35], s66 offen offset:1024  lds
    s_waitcnt vmcnt(30)
    buffer_load_dwordx4 v16, s[32:35], s66 offen offset:2048  lds
    buffer_load_dwordx4 v17, s[32:35], s66 offen offset:3072  lds
    s_lshl_b32 s66, s65, 20
    s_add_u32 s66, s66, 524288
    s_mov_b32 m0, 81920
    s_waitcnt vmcnt(30)
    buffer_load_dwordx4 v14, s[32:35], s66 offen offset:0  lds
    buffer_load_dwordx4 v15, s[32:35], s66 offen offset:1024  lds
    s_waitcnt vmcnt(30)
    buffer_load_dwordx4 v16, s[32:35], s66 offen offset:2048  lds
    buffer_load_dwordx4 v17, s[32:35], s66 offen offset:3072  lds
    s_mov_b32 m0, 86016
    s_add_u32 s66, s66, 131072
    s_waitcnt vmcnt(30)
    buffer_load_dwordx4 v14, s[32:35], s66 offen offset:0  lds
    buffer_load_dwordx4 v15, s[32:35], s66 offen offset:1024  lds
    s_waitcnt vmcnt(30)
    buffer_load_dwordx4 v16, s[32:35], s66 offen offset:2048  lds
    buffer_load_dwordx4 v17, s[32:35], s66 offen offset:3072  lds
    s_lshl_b32 s66, s65, 20
    s_add_u32 s66, s66, 786432
    s_mov_b32 m0, 90112
    s_waitcnt vmcnt(30)
    buffer_load_dwordx4 v14, s[32:35], s66 offen offset:0  lds
    buffer_load_dwordx4 v15, s[32:35], s66 offen offset:1024  lds
    s_waitcnt vmcnt(30)
    buffer_load_dwordx4 v16, s[32:35], s66 offen offset:2048  lds
    buffer_load_dwordx4 v17, s[32:35], s66 offen offset:3072  lds
    s_mov_b32 m0, 94208
    s_add_u32 s66, s66, 131072
    s_waitcnt vmcnt(30)
    buffer_load_dwordx4 v14, s[32:35], s66 offen offset:0  lds
    buffer_load_dwordx4 v15, s[32:35], s66 offen offset:1024  lds
    s_waitcnt vmcnt(30)
    buffer_load_dwordx4 v16, s[32:35], s66 offen offset:2048  lds
    buffer_load_dwordx4 v17, s[32:35], s66 offen offset:3072  lds
    s_lshl_b32 s65, s2, 18
    s_add_u32 s20, s6, s65
    s_addc_u32 s21, s7, 0
    s_mov_b32 s22, 0x40000
    s_mov_b32 s23, 0x20000
    s_add_u32 s24, s8, s65
    s_addc_u32 s25, s9, 0
    s_mov_b32 s26, 0x40000
    s_mov_b32 s27, 0x20000
    s_lshl_b32 s65, s62, 17
    s_lshl_b32 s66, s63, 8
    s_add_u32 s65, s65, s66
    s_add_u32 s36, s12, s65
    s_addc_u32 s37, s13, 0
    s_sub_u32 s38, 0x400000, s65
    s_mov_b32 s39, 0x20000
    s_bitcmp1_b32 s2, 5
    s_cbranch_scc1 L_beta
    s_mov_b32 m0, 0
    s_mov_b32 s66, 0
    s_waitcnt vmcnt(30)
    buffer_load_dwordx4 v18, s[20:23], s66 offen offset:0 nt lds
    buffer_load_dwordx4 v19, s[20:23], s66 offen offset:1024 nt lds
    s_waitcnt vmcnt(30)
    buffer_load_dwordx4 v20, s[20:23], s66 offen offset:2048 nt lds
    buffer_load_dwordx4 v21, s[20:23], s66 offen offset:3072 nt lds
    s_mov_b32 m0, 4096
    s_mov_b32 s66, 4096
    s_waitcnt vmcnt(30)
    buffer_load_dwordx4 v18, s[20:23], s66 offen offset:0 nt lds
    buffer_load_dwordx4 v19, s[20:23], s66 offen offset:1024 nt lds
    s_waitcnt vmcnt(30)
    buffer_load_dwordx4 v20, s[20:23], s66 offen offset:2048 nt lds
    buffer_load_dwordx4 v21, s[20:23], s66 offen offset:3072 nt lds
    s_mov_b32 m0, 8192
    s_mov_b32 s66, 8192
    s_waitcnt vmcnt(30)
    buffer_load_dwordx4 v18, s[20:23], s66 offen offset:0 nt lds
    buffer_load_dwordx4 v19, s[20:23], s66 offen offset:1024 nt lds
    s_waitcnt vmcnt(30)
    buffer_load_dwordx4 v20, s[20:23], s66 offen offset:2048 nt lds
    buffer_load_dwordx4 v21, s[20:23], s66 offen offset:3072 nt lds
    s_mov_b32 m0, 12288
    s_mov_b32 s66, 12288
    s_waitcnt vmcnt(30)
    buffer_load_dwordx4 v18, s[20:23], s66 offen offset:0 nt lds
    buffer_load_dwordx4 v19, s[20:23], s66 offen offset:1024 nt lds
    s_waitcnt vmcnt(30)
    buffer_load_dwordx4 v20, s[20:23], s66 offen offset:2048 nt lds
    buffer_load_dwordx4 v21, s[20:23], s66 offen offset:3072 nt lds
    s_mov_b32 m0, 16384
    s_mov_b32 s66, 16384
    s_waitcnt vmcnt(30)
    buffer_load_dwordx4 v18, s[20:23], s66 offen offset:0 nt lds
    buffer_load_dwordx4 v19, s[20:23], s66 offen offset:1024 nt lds
    s_waitcnt vmcnt(30)
    buffer_load_dwordx4 v20, s[20:23], s66 offen offset:2048 nt lds
    buffer_load_dwordx4 v21, s[20:23], s66 offen offset:3072 nt lds
    s_mov_b32 m0, 20480
    s_mov_b32 s66, 20480
    s_waitcnt vmcnt(30)
    buffer_load_dwordx4 v18, s[20:23], s66 offen offset:0 nt lds
    buffer_load_dwordx4 v19, s[20:23], s66 offen offset:1024 nt lds
    s_waitcnt vmcnt(30)
    buffer_load_dwordx4 v20, s[20:23], s66 offen offset:2048 nt lds
    buffer_load_dwordx4 v21, s[20:23], s66 offen offset:3072 nt lds
    s_mov_b32 m0, 24576
    s_mov_b32 s66, 24576
    s_waitcnt vmcnt(30)
    buffer_load_dwordx4 v18, s[20:23], s66 offen offset:0 nt lds
    buffer_load_dwordx4 v19, s[20:23], s66 offen offset:1024 nt lds
    s_waitcnt vmcnt(30)
    buffer_load_dwordx4 v20, s[20:23], s66 offen offset:2048 nt lds
    buffer_load_dwordx4 v21, s[20:23], s66 offen offset:3072 nt lds
    s_mov_b32 m0, 28672
    s_mov_b32 s66, 28672
    s_waitcnt vmcnt(30)
    buffer_load_dwordx4 v18, s[20:23], s66 offen offset:0 nt lds
    buffer_load_dwordx4 v19, s[20:23], s66 offen offset:1024 nt lds
    s_waitcnt vmcnt(30)
    v_mov_b32 v8, 1
    ds_write_b32 v6, v8
    buffer_load_dwordx4 v20, s[20:23], s66 offen offset:2048 nt lds
    buffer_load_dwordx4 v21, s[20:23], s66 offen offset:3072 nt lds
    s_mov_b32 s40, s18
    s_mov_b32 s41, s19
    s_mov_b32 s42, 0x600000
    s_mov_b32 s43, 0x20000
    s_mov_b32 s65, 8388608
    s_add_u32 s44, s18, s65
    s_addc_u32 s45, s19, 0
    s_mov_b32 s46, 0x800000
    s_mov_b32 s47, 0x20000
    s_mov_b32 s65, 33554432
    s_add_u32 s48, s18, s65
    s_addc_u32 s49, s19, 0
    s_mov_b32 s50, 0x8000
    s_mov_b32 s51, 0x20000
    s_mov_b32 s52, s14
    s_mov_b32 s53, s15
    s_mov_b32 s54, 0xc0000
    s_mov_b32 s55, 0x20000
    v_lshlrev_b32 v250, 4, v0
    v_lshlrev_b32 v251, 2, v0
    v_bfe_u32 v4, v0, 2, 2
    v_bfe_u32 v30, v0, 4, 1
    v_lshrrev_b32 v1, 5, v0
    v_lshlrev_b32 v29, 5, v30
    v_and_b32 v31, 1, v0
    v_lshl_add_u32 v28, v31, 4, v29
    v_bfe_u32 v31, v0, 1, 1
    v_lshl_add_u32 v28, v31, 3, v28
    v_lshl_add_u32 v31, v1, 2, v4
    v_lshlrev_b32 v31, 8, v31
    v_xor_b32 v232, s3, v4
    v_lshlrev_b32 v232, 6, v232
    v_and_b32 v238, 3, v0
    v_lshl_add_u32 v232, v238, 4, v232
    v_lshl_add_u32 v238, v30, 2, v4
    v_lshl_add_u32 v238, v1, 4, v238
    v_lshl_add_u32 v232, v238, 8, v232
    v_add_u32 v232, 131072, v232
    v_add_u32 v254, 156928, v251
    v_lshrrev_b32 v238, 4, v0
    v_and_b32 v252, 0xf0, v250
    v_lshl_add_u32 v252, v238, 9, v252
    v_mov_b32 v237, 1
    v_mov_b32 v235, 0x7ffffff0
    v_mov_b32 v236, 0x7ffffff0
    v_mov_b32 v239, 0x7ffffff0
    v_mov_b32 v240, 0x7ffffff0
    v_mov_b32 v255, 0x7ffffff0
    s_lshl_b32 s69, s60, 5
    s_add_u32 s69, s69, s62
    s_lshl_b32 s9, s2, 7
    s_lshl_b32 s70, s3, 11
    s_add_u32 s65, s63, 1
    s_and_b32 s65, s65, 3
    s_lshl_b32 s65, s65, 3
    s_add_u32 s65, s65, s69
    s_mul_i32 s65, s65, 24576
    s_add_u32 s71, s65, s70
    s_add_u32 s65, s63, 2
    s_and_b32 s65, s65, 3
    s_lshl_b32 s65, s65, 3
    s_add_u32 s65, s65, s69
    s_mul_i32 s65, s65, 24576
    s_add_u32 s72, s65, s70
    s_add_u32 s65, s63, 3
    s_and_b32 s65, s65, 3
    s_lshl_b32 s65, s65, 3
    s_add_u32 s65, s65, s69
    s_mul_i32 s65, s65, 24576
    s_add_u32 s73, s65, s70
    v_add_u32 v234, s63, v4
    v_and_b32 v234, 3, v234
    v_and_b32 v238, 3, v0
    v_min_u32 v238, 2, v238
    v_lshl_add_u32 v234, v234, 2, v238
    v_lshlrev_b32 v234, 2, v234
    s_and_b32 s65, s2, 0xf8
    s_lshl_b32 s65, s65, 15
    s_lshl_b32 s66, s62, 12
    s_add_u32 s65, s65, s66
    s_lshl_b32 s66, s3, 8
    s_add_u32 s68, s65, s66
    s_lshl_b32 s66, s3, 5
    s_add_u32 s75, s65, s66
    s_add_u32 s65, s64, 1
    s_and_b32 s65, s65, 3
    s_lshl_b32 s66, s65, 8
    s_mov_b32 m0, 131072
    s_waitcnt vmcnt(30)
    buffer_load_dwordx4 v10, s[28:31], s66 offen offset:0  lds
    buffer_load_dwordx4 v11, s[28:31], s66 offen offset:1024  lds
    s_waitcnt vmcnt(30)
    buffer_load_dwordx4 v12, s[28:31], s66 offen offset:2048  lds
    buffer_load_dwordx4 v13, s[28:31], s66 offen offset:3072  lds
    s_mov_b32 m0, 135168
    s_add_u32 s66, s66, 16384
    s_waitcnt vmcnt(30)
    buffer_load_dwordx4 v10, s[28:31], s66 offen offset:0  lds
    buffer_load_dwordx4 v11, s[28:31], s66 offen offset:1024  lds
    s_waitcnt vmcnt(30)
    buffer_load_dwordx4 v12, s[28:31], s66 offen offset:2048  lds
    buffer_load_dwordx4 v13, s[28:31], s66 offen offset:3072  lds
    s_lshl_b32 s66, s65, 8
    s_add_u32 s66, s66, 32768
    s_mov_b32 m0, 139264
    s_waitcnt vmcnt(30)
    buffer_load_dwordx4 v10, s[28:31], s66 offen offset:0  lds
    buffer_load_dwordx4 v11, s[28:31], s66 offen offset:1024  lds
    s_waitcnt vmcnt(30)
    buffer_load_dwordx4 v12, s[28:31], s66 offen offset:2048  lds
    buffer_load_dwordx4 v13, s[28:31], s66 offen offset:3072  lds
    s_mov_b32 m0, 143360
    s_add_u32 s66, s66, 16384
    s_waitcnt vmcnt(30)
    buffer_load_dwordx4 v10, s[28:31], s66 offen offset:0  lds
    buffer_load_dwordx4 v11, s[28:31], s66 offen offset:1024  lds
    s_waitcnt vmcnt(30)
    buffer_load_dwordx4 v12, s[28:31], s66 offen offset:2048  lds
    buffer_load_dwordx4 v13, s[28:31], s66 offen offset:3072  lds
    s_lshl_b32 s66, s65, 8
    s_add_u32 s66, s66, 65536
    s_mov_b32 m0, 147456
    s_waitcnt vmcnt(30)
    buffer_load_dwordx4 v10, s[28:31], s66 offen offset:0  lds
    buffer_load_dwordx4 v11, s[28:31], s66 offen offset:1024  lds
    s_waitcnt vmcnt(30)
    buffer_load_dwordx4 v12, s[28:31], s66 offen offset:2048  lds
    buffer_load_dwordx4 v13, s[28:31], s66 offen offset:3072  lds
    s_mov_b32 m0, 151552
    s_add_u32 s66, s66, 16384
    s_waitcnt vmcnt(30)
    buffer_load_dwordx4 v10, s[28:31], s66 offen offset:0  lds
    buffer_load_dwordx4 v11, s[28:31], s66 offen offset:1024  lds
    s_waitcnt vmcnt(30)
    buffer_load_dwordx4 v12, s[28:31], s66 offen offset:2048  lds
    buffer_load_dwordx4 v13, s[28:31], s66 offen offset:3072  lds
    s_lshl_b32 s66, s65, 20
    s_mov_b32 m0, 98304
    s_waitcnt vmcnt(30)
    buffer_load_dwordx4 v14, s[32:35], s66 offen offset:0  lds
    buffer_load_dwordx4 v15, s[32:35], s66 offen offset:1024  lds
    s_waitcnt vmcnt(30)
    buffer_load_dwordx4 v16, s[32:35], s66 offen offset:2048  lds
    buffer_load_dwordx4 v17, s[32:35], s66 offen offset:3072  lds
    s_mov_b32 m0, 102400
    s_add_u32 s66, s66, 131072
    s_waitcnt vmcnt(30)
    buffer_load_dwordx4 v14, s[32:35], s66 offen offset:0  lds
    buffer_load_dwordx4 v15, s[32:35], s66 offen offset:1024  lds
    s_waitcnt vmcnt(30)
    buffer_load_dwordx4 v16, s[32:35], s66 offen offset:2048  lds
    buffer_load_dwordx4 v17, s[32:35], s66 offen offset:3072  lds
    s_lshl_b32 s66, s65, 20
    s_add_u32 s66, s66, 262144
    s_mov_b32 m0, 106496
    s_waitcnt vmcnt(30)
    buffer_load_dwordx4 v14, s[32:35], s66 offen offset:0  lds
    buffer_load_dwordx4 v15, s[32:35], s66 offen offset:1024  lds
    s_waitcnt vmcnt(30)
    buffer_load_dwordx4 v16, s[32:35], s66 offen offset:2048  lds
    buffer_load_dwordx4 v17, s[32:35], s66 offen offset:3072  lds
    s_mov_b32 m0, 110592
    s_add_u32 s66, s66, 131072
    s_waitcnt vmcnt(30)
    buffer_load_dwordx4 v14, s[32:35], s66 offen offset:0  lds
    buffer_load_dwordx4 v15, s[32:35], s66 offen offset:1024  lds
    s_waitcnt vmcnt(30)
    buffer_load_dwordx4 v16, s[32:35], s66 offen offset:2048  lds
    buffer_load_dwordx4 v17, s[32:35], s66 offen offset:3072  lds
    s_lshl_b32 s66, s65, 20
    s_add_u32 s66, s66, 524288
    s_mov_b32 m0, 114688
    s_waitcnt vmcnt(30)
    buffer_load_dwordx4 v14, s[32:35], s66 offen offset:0  lds
    buffer_load_dwordx4 v15, s[32:35], s66 offen offset:1024  lds
    s_waitcnt vmcnt(30)
    buffer_load_dwordx4 v16, s[32:35], s66 offen offset:2048  lds
    buffer_load_dwordx4 v17, s[32:35], s66 offen offset:3072  lds
    s_mov_b32 m0, 118784
    s_add_u32 s66, s66, 131072
    s_waitcnt vmcnt(30)
    buffer_load_dwordx4 v14, s[32:35], s66 offen offset:0  lds
    buffer_load_dwordx4 v15, s[32:35], s66 offen offset:1024  lds
    s_waitcnt vmcnt(30)
    buffer_load_dwordx4 v16, s[32:35], s66 offen offset:2048  lds
    buffer_load_dwordx4 v17, s[32:35], s66 offen offset:3072  lds
    s_lshl_b32 s66, s65, 20
    s_add_u32 s66, s66, 786432
    s_mov_b32 m0, 122880
    s_waitcnt vmcnt(30)
    buffer_load_dwordx4 v14, s[32:35], s66 offen offset:0  lds
    buffer_load_dwordx4 v15, s[32:35], s66 offen offset:1024  lds
    s_waitcnt vmcnt(30)
    buffer_load_dwordx4 v16, s[32:35], s66 offen offset:2048  lds
    buffer_load_dwordx4 v17, s[32:35], s66 offen offset:3072  lds
    s_mov_b32 m0, 126976
    s_add_u32 s66, s66, 131072
    s_waitcnt vmcnt(30)
    buffer_load_dwordx4 v14, s[32:35], s66 offen offset:0  lds
    buffer_load_dwordx4 v15, s[32:35], s66 offen offset:1024  lds
    s_waitcnt vmcnt(30)
    buffer_load_dwordx4 v16, s[32:35], s66 offen offset:2048  lds
    buffer_load_dwordx4 v17, s[32:35], s66 offen offset:3072  lds
    ds_read_b32 v9, v7
    s_waitcnt lgkmcnt(0)
    v_readlane_b32 s67, v9, 0
    v_readlane_b32 s76, v9, 1
    v_readlane_b32 s77, v9, 2
    s_min_u32 s67, s67, s76
    s_min_u32 s67, s67, s77
    s_cmp_ge_u32 s67, 1
    s_cbranch_scc0 L_lslow_1
L_lback_2:
    s_mov_b32 m0, 32768
    s_mov_b32 s66, 32768
    s_waitcnt vmcnt(30)
    buffer_load_dwordx4 v18, s[20:23], s66 offen offset:0 nt lds
    buffer_load_dwordx4 v19, s[20:23], s66 offen offset:1024 nt lds
    s_waitcnt vmcnt(30)
    buffer_load_dwordx4 v20, s[20:23], s66 offen offset:2048 nt lds
    buffer_load_dwordx4 v21, s[20:23], s66 offen offset:3072 nt lds
    s_mov_b32 m0, 36864
    s_mov_b32 s66, 36864
    s_waitcnt vmcnt(30)
    buffer_load_dwordx4 v18, s[20:23], s66 offen offset:0 nt lds
    buffer_load_dwordx4 v19, s[20:23], s66 offen offset:1024 nt lds
    s_waitcnt vmcnt(30)
    buffer_load_dwordx4 v20, s[20:23], s66 offen offset:2048 nt lds
    buffer_load_dwordx4 v21, s[20:23], s66 offen offset:3072 nt lds
    s_mov_b32 m0, 40960
    s_mov_b32 s66, 40960
    s_waitcnt vmcnt(30)
    buffer_load_dwordx4 v18, s[20:23], s66 offen offset:0 nt lds
    buffer_load_dwordx4 v19, s[20:23], s66 offen offset:1024 nt lds
    s_waitcnt vmcnt(30)
    buffer_load_dwordx4 v20, s[20:23], s66 offen offset:2048 nt lds
    buffer_load_dwordx4 v21, s[20:23], s66 offen offset:3072 nt lds
    s_mov_b32 m0, 45056
    s_mov_b32 s66, 45056
    s_waitcnt vmcnt(30)
    buffer_load_dwordx4 v18, s[20:23], s66 offen offset:0 nt lds
    buffer_load_dwordx4 v19, s[20:23], s66 offen offset:1024 nt lds
    s_waitcnt vmcnt(30)
    buffer_load_dwordx4 v20, s[20:23], s66 offen offset:2048 nt lds
    buffer_load_dwordx4 v21, s[20:23], s66 offen offset:3072 nt lds
    s_mov_b32 m0, 65536
    s_mov_b32 s66, 0
    s_waitcnt vmcnt(30)
    buffer_load_dwordx4 v22, s[24:27], s66 offen offset:0 nt lds
    buffer_load_dwordx4 v22, s[24:27], s66 offen offset:1024 nt lds
    s_waitcnt vmcnt(30)
    buffer_load_dwordx4 v22, s[24:27], s66 offen offset:2048 nt lds
    buffer_load_dwordx4 v22, s[24:27], s66 offen offset:3072 nt lds
    s_mov_b32 m0, 69632
    s_mov_b32 s66, 4096
    s_waitcnt vmcnt(30)
    buffer_load_dwordx4 v22, s[24:27], s66 offen offset:0 nt lds
    buffer_load_dwordx4 v22, s[24:27], s66 offen offset:1024 nt lds
    s_waitcnt vmcnt(30)
    buffer_load_dwordx4 v22, s[24:27], s66 offen offset:2048 nt lds
    buffer_load_dwordx4 v22, s[24:27], s66 offen offset:3072 nt lds
    s_mov_b32 m0, 73728
    s_mov_b32 s66, 8192
    s_waitcnt vmcnt(30)
    buffer_load_dwordx4 v22, s[24:27], s66 offen offset:0 nt lds
    buffer_load_dwordx4 v22, s[24:27], s66 offen offset:1024 nt lds
    s_waitcnt vmcnt(30)
    buffer_load_dwordx4 v22, s[24:27], s66 offen offset:2048 nt lds
    buffer_load_dwordx4 v22, s[24:27], s66 offen offset:3072 nt lds
    s_mov_b32 m0, 77824
    s_mov_b32 s66, 12288
    s_waitcnt vmcnt(30)
    buffer_load_dwordx4 v22, s[24:27], s66 offen offset:0 nt lds
    buffer_load_dwordx4 v22, s[24:27], s66 offen offset:1024 nt lds
    s_waitcnt vmcnt(30)
    v_mov_b32 v8, 2
    ds_write_b32 v6, v8
    buffer_load_dwordx4 v22, s[24:27], s66 offen offset:2048 nt lds
    buffer_load_dwordx4 v22, s[24:27], s66 offen offset:3072 nt lds
    ds_read_b32 v9, v7
    s_waitcnt lgkmcnt(0)
    v_readlane_b32 s67, v9, 0
    v_readlane_b32 s76, v9, 1
    v_readlane_b32 s77, v9, 2
    s_min_u32 s67, s67, s76
    s_min_u32 s67, s67, s77
    s_cmp_ge_u32 s67, 2
    s_cbranch_scc0 L_lslow_3
L_lback_4:
    s_add_u32 s65, s64, 2
    s_and_b32 s65, s65, 3
    s_lshl_b32 s66, s65, 8
    s_mov_b32 m0, 131072
    s_waitcnt vmcnt(30)
    buffer_load_dwordx4 v10, s[28:31], s66 offen offset:0  lds
    buffer_load_dwordx4 v11, s[28:31], s66 offen offset:1024  lds
    s_waitcnt vmcnt(30)
    buffer_load_dwordx4 v12, s[28:31], s66 offen offset:2048  lds
    buffer_load_dwordx4 v13, s[28:31], s66 offen offset:3072  lds
    s_mov_b32 m0, 135168
    s_add_u32 s66, s66, 16384
    s_waitcnt vmcnt(30)
    buffer_load_dwordx4 v10, s[28:31], s66 offen offset:0  lds
    buffer_load_dwordx4 v11, s[28:31], s66 offen offset:1024  lds
    s_waitcnt vmcnt(30)
    buffer_load_dwordx4 v12, s[28:31], s66 offen offset:2048  lds
    buffer_load_dwordx4 v13, s[28:31], s66 offen offset:3072  lds
    s_lshl_b32 s66, s65, 8
    s_add_u32 s66, s66, 32768
    s_mov_b32 m0, 139264
    s_waitcnt vmcnt(30)
    buffer_load_dwordx4 v10, s[28:31], s66 offen offset:0  lds
    buffer_load_dwordx4 v11, s[28:31], s66 offen offset:1024  lds
    s_waitcnt vmcnt(30)
    buffer_load_dwordx4 v12, s[28:31], s66 offen offset:2048  lds
    buffer_load_dwordx4 v13, s[28:31], s66 offen offset:3072  lds
    s_mov_b32 m0, 143360
    s_add_u32 s66, s66, 16384
    s_waitcnt vmcnt(30)
    buffer_load_dwordx4 v10, s[28:31], s66 offen offset:0  lds
    buffer_load_dwordx4 v11, s[28:31], s66 offen offset:1024  lds
    s_waitcnt vmcnt(30)
    buffer_load_dwordx4 v12, s[28:31], s66 offen offset:2048  lds
    buffer_load_dwordx4 v13, s[28:31], s66 offen offset:3072  lds
    s_lshl_b32 s66, s65, 8
    s_add_u32 s66, s66, 65536
    s_mov_b32 m0, 147456
    s_waitcnt vmcnt(30)
    buffer_load_dwordx4 v10, s[28:31], s66 offen offset:0  lds
    buffer_load_dwordx4 v11, s[28:31], s66 offen offset:1024  lds
    s_waitcnt vmcnt(30)
    buffer_load_dwordx4 v12, s[28:31], s66 offen offset:2048  lds
    buffer_load_dwordx4 v13, s[28:31], s66 offen offset:3072  lds
    s_mov_b32 m0, 151552
    s_add_u32 s66, s66, 16384
    s_waitcnt vmcnt(30)
    buffer_load_dwordx4 v10, s[28:31], s66 offen offset:0  lds
    buffer_load_dwordx4 v11, s[28:31], s66 offen offset:1024  lds
    s_waitcnt vmcnt(30)
    buffer_load_dwordx4 v12, s[28:31], s66 offen offset:2048  lds
    buffer_load_dwordx4 v13, s[28:31], s66 offen offset:3072  lds
    s_lshl_b32 s66, s65, 20
    s_mov_b32 m0, 98304
    s_waitcnt vmcnt(30)
    buffer_load_dwordx4 v14, s[32:35], s66 offen offset:0  lds
    buffer_load_dwordx4 v15, s[32:35], s66 offen offset:1024  lds
    s_waitcnt vmcnt(30)
    buffer_load_dwordx4 v16, s[32:35], s66 offen offset:2048  lds
    buffer_load_dwordx4 v17, s[32:35], s66 offen offset:3072  lds
    s_mov_b32 m0, 102400
    s_add_u32 s66, s66, 131072
    s_waitcnt vmcnt(30)
    buffer_load_dwordx4 v14, s[32:35], s66 offen offset:0  lds
    buffer_load_dwordx4 v15, s[32:35], s66 offen offset:1024  lds
    s_waitcnt vmcnt(30)
    buffer_load_dwordx4 v16, s[32:35], s66 offen offset:2048  lds
    buffer_load_dwordx4 v17, s[32:35], s66 offen offset:3072  lds
    s_lshl_b32 s66, s65, 20
    s_add_u32 s66, s66, 262144
    s_mov_b32 m0, 106496
    s_waitcnt vmcnt(30)
    buffer_load_dwordx4 v14, s[32:35], s66 offen offset:0  lds
    buffer_load_dwordx4 v15, s[32:35], s66 offen offset:1024  lds
    s_waitcnt vmcnt(30)
    buffer_load_dwordx4 v16, s[32:35], s66 offen offset:2048  lds
    buffer_load_dwordx4 v17, s[32:35], s66 offen offset:3072  lds
    s_mov_b32 m0, 110592
    s_add_u32 s66, s66, 131072
    s_waitcnt vmcnt(30)
    buffer_load_dwordx4 v14, s[32:35], s66 offen offset:0  lds
    buffer_load_dwordx4 v15, s[32:35], s66 offen offset:1024  lds
    s_waitcnt vmcnt(30)
    buffer_load_dwordx4 v16, s[32:35], s66 offen offset:2048  lds
    buffer_load_dwordx4 v17, s[32:35], s66 offen offset:3072  lds
    s_lshl_b32 s66, s65, 20
    s_add_u32 s66, s66, 524288
    s_mov_b32 m0, 114688
    s_waitcnt vmcnt(30)
    buffer_load_dwordx4 v14, s[32:35], s66 offen offset:0  lds
    buffer_load_dwordx4 v15, s[32:35], s66 offen offset:1024  lds
    s_waitcnt vmcnt(30)
    buffer_load_dwordx4 v16, s[32:35], s66 offen offset:2048  lds
    buffer_load_dwordx4 v17, s[32:35], s66 offen offset:3072  lds
    s_mov_b32 m0, 118784
    s_add_u32 s66, s66, 131072
    s_waitcnt vmcnt(30)
    buffer_load_dwordx4 v14, s[32:35], s66 offen offset:0  lds
    buffer_load_dwordx4 v15, s[32:35], s66 offen offset:1024  lds
    s_waitcnt vmcnt(30)
    buffer_load_dwordx4 v16, s[32:35], s66 offen offset:2048  lds
    buffer_load_dwordx4 v17, s[32:35], s66 offen offset:3072  lds
    s_lshl_b32 s66, s65, 20
    s_add_u32 s66, s66, 786432
    s_mov_b32 m0, 122880
    s_waitcnt vmcnt(30)
    buffer_load_dwordx4 v14, s[32:35], s66 offen offset:0  lds
    buffer_load_dwordx4 v15, s[32:35], s66 offen offset:1024  lds
    s_waitcnt vmcnt(30)
    buffer_load_dwordx4 v16, s[32:35], s66 offen offset:2048  lds
    buffer_load_dwordx4 v17, s[32:35], s66 offen offset:3072  lds
    s_mov_b32 m0, 126976
    s_add_u32 s66, s66, 131072
    s_waitcnt vmcnt(30)
    buffer_load_dwordx4 v14, s[32:35], s66 offen offset:0  lds
    buffer_load_dwordx4 v15, s[32:35], s66 offen offset:1024  lds
    s_waitcnt vmcnt(30)
    buffer_load_dwordx4 v16, s[32:35], s66 offen offset:2048  lds
    buffer_load_dwordx4 v17, s[32:35], s66 offen offset:3072  lds
    s_mov_b32 m0, 49152
    s_mov_b32 s66, 49152
    s_waitcnt vmcnt(30)
    buffer_load_dwordx4 v18, s[20:23], s66 offen offset:0 nt lds
    buffer_load_dwordx4 v19, s[20:23], s66 offen offset:1024 nt lds
    s_waitcnt vmcnt(30)
    buffer_load_dwordx4 v20, s[20:23], s66 offen offset:2048 nt lds
    buffer_load_dwordx4 v21, s[20:23], s66 offen offset:3072 nt lds
    s_mov_b32 m0, 53248
    s_mov_b32 s66, 53248
    s_waitcnt vmcnt(30)
    buffer_load_dwordx4 v18, s[20:23], s66 offen offset:0 nt lds
    buffer_load_dwordx4 v19, s[20:23], s66 offen offset:1024 nt lds
    s_waitcnt vmcnt(30)
    buffer_load_dwordx4 v20, s[20:23], s66 offen offset:2048 nt lds
    buffer_load_dwordx4 v21, s[20:23], s66 offen offset:3072 nt lds
    s_mov_b32 m0, 57344
    s_mov_b32 s66, 57344
    s_waitcnt vmcnt(30)
    buffer_load_dwordx4 v18, s[20:23], s66 offen offset:0 nt lds
    buffer_load_dwordx4 v19, s[20:23], s66 offen offset:1024 nt lds
    s_waitcnt vmcnt(30)
    buffer_load_dwordx4 v20, s[20:23], s66 offen offset:2048 nt lds
    buffer_load_dwordx4 v21, s[20:23], s66 offen offset:3072 nt lds
    s_mov_b32 m0, 61440
    s_mov_b32 s66, 61440
    s_waitcnt vmcnt(30)
    buffer_load_dwordx4 v18, s[20:23], s66 offen offset:0 nt lds
    buffer_load_dwordx4 v19, s[20:23], s66 offen offset:1024 nt lds
    s_waitcnt vmcnt(30)
    buffer_load_dwordx4 v20, s[20:23], s66 offen offset:2048 nt lds
    buffer_load_dwordx4 v21, s[20:23], s66 offen offset:3072 nt lds
    s_mov_b32 m0, 81920
    s_mov_b32 s66, 16384
    s_waitcnt vmcnt(30)
    buffer_load_dwordx4 v22, s[24:27], s66 offen offset:0 nt lds
    buffer_load_dwordx4 v22, s[24:27], s66 offen offset:1024 nt lds
    s_waitcnt vmcnt(30)
    buffer_load_dwordx4 v22, s[24:27], s66 offen offset:2048 nt lds
    buffer_load_dwordx4 v22, s[24:27], s66 offen offset:3072 nt lds
    s_mov_b32 m0, 86016
    s_mov_b32 s66, 20480
    s_waitcnt vmcnt(30)
    buffer_load_dwordx4 v22, s[24:27], s66 offen offset:0 nt lds
    buffer_load_dwordx4 v22, s[24:27], s66 offen offset:1024 nt lds
    s_waitcnt vmcnt(30)
    buffer_load_dwordx4 v22, s[24:27], s66 offen offset:2048 nt lds
    buffer_load_dwordx4 v22, s[24:27], s66 offen offset:3072 nt lds
    s_waitcnt vmcnt(24)
    v_mov_b32 v8, 3
    ds_write_b32 v6, v8
    ds_read_b32 v9, v7
    s_waitcnt lgkmcnt(0)
    v_readlane_b32 s67, v9, 0
    v_readlane_b32 s76, v9, 1
    v_readlane_b32 s77, v9, 2
    s_min_u32 s67, s67, s76
    s_min_u32 s67, s67, s77
    s_cmp_ge_u32 s67, 3
    s_cbranch_scc0 L_lslow_5
L_lback_6:
    s_add_u32 s65, s64, 3
    s_and_b32 s65, s65, 3
    s_lshl_b32 s66, s65, 8
    s_mov_b32 m0, 131072
    s_waitcnt vmcnt(30)
    buffer_load_dwordx4 v10, s[28:31], s66 offen offset:0  lds
    buffer_load_dwordx4 v11, s[28:31], s66 offen offset:1024  lds
    s_waitcnt vmcnt(30)
    buffer_load_dwordx4 v12, s[28:31], s66 offen offset:2048  lds
    buffer_load_dwordx4 v13, s[28:31], s66 offen offset:3072  lds
    s_mov_b32 m0, 135168
    s_add_u32 s66, s66, 16384
    s_waitcnt vmcnt(30)
    buffer_load_dwordx4 v10, s[28:31], s66 offen offset:0  lds
    buffer_load_dwordx4 v11, s[28:31], s66 offen offset:1024  lds
    s_waitcnt vmcnt(30)
    buffer_load_dwordx4 v12, s[28:31], s66 offen offset:2048  lds
    buffer_load_dwordx4 v13, s[28:31], s66 offen offset:3072  lds
    s_lshl_b32 s66, s65, 8
    s_add_u32 s66, s66, 32768
    s_mov_b32 m0, 139264
    s_waitcnt vmcnt(30)
    buffer_load_dwordx4 v10, s[28:31], s66 offen offset:0  lds
    buffer_load_dwordx4 v11, s[28:31], s66 offen offset:1024  lds
    s_waitcnt vmcnt(30)
    buffer_load_dwordx4 v12, s[28:31], s66 offen offset:2048  lds
    buffer_load_dwordx4 v13, s[28:31], s66 offen offset:3072  lds
    s_mov_b32 m0, 143360
    s_add_u32 s66, s66, 16384
    s_waitcnt vmcnt(30)
    buffer_load_dwordx4 v10, s[28:31], s66 offen offset:0  lds
    buffer_load_dwordx4 v11, s[28:31], s66 offen offset:1024  lds
    s_waitcnt vmcnt(30)
    buffer_load_dwordx4 v12, s[28:31], s66 offen offset:2048  lds
    buffer_load_dwordx4 v13, s[28:31], s66 offen offset:3072  lds
    s_lshl_b32 s66, s65, 8
    s_add_u32 s66, s66, 65536
    s_mov_b32 m0, 147456
    s_waitcnt vmcnt(30)
    buffer_load_dwordx4 v10, s[28:31], s66 offen offset:0  lds
    buffer_load_dwordx4 v11, s[28:31], s66 offen offset:1024  lds
    s_waitcnt vmcnt(30)
    buffer_load_dwordx4 v12, s[28:31], s66 offen offset:2048  lds
    buffer_load_dwordx4 v13, s[28:31], s66 offen offset:3072  lds
    s_mov_b32 m0, 151552
    s_add_u32 s66, s66, 16384
    s_waitcnt vmcnt(30)
    buffer_load_dwordx4 v10, s[28:31], s66 offen offset:0  lds
    buffer_load_dwordx4 v11, s[28:31], s66 offen offset:1024  lds
    s_waitcnt vmcnt(30)
    buffer_load_dwordx4 v12, s[28:31], s66 offen offset:2048  lds
    buffer_load_dwordx4 v13, s[28:31], s66 offen offset:3072  lds
    s_lshl_b32 s66, s65, 20
    s_mov_b32 m0, 98304
    s_waitcnt vmcnt(30)
    buffer_load_dwordx4 v14, s[32:35], s66 offen offset:0  lds
    buffer_load_dwordx4 v15, s[32:35], s66 offen offset:1024  lds
    s_waitcnt vmcnt(30)
    buffer_load_dwordx4 v16, s[32:35], s66 offen offset:2048  lds
    buffer_load_dwordx4 v17, s[32:35], s66 offen offset:3072  lds
    s_mov_b32 m0, 102400
    s_add_u32 s66, s66, 131072
    s_waitcnt vmcnt(30)
    buffer_load_dwordx4 v14, s[32:35], s66 offen offset:0  lds
    buffer_load_dwordx4 v15, s[32:35], s66 offen offset:1024  lds
    s_waitcnt vmcnt(30)
    buffer_load_dwordx4 v16, s[32:35], s66 offen offset:2048  lds
    buffer_load_dwordx4 v17, s[32:35], s66 offen offset:3072  lds
    s_lshl_b32 s66, s65, 20
    s_add_u32 s66, s66, 262144
    s_mov_b32 m0, 106496
    s_waitcnt vmcnt(30)
    buffer_load_dwordx4 v14, s[32:35], s66 offen offset:0  lds
    buffer_load_dwordx4 v15, s[32:35], s66 offen offset:1024  lds
    s_waitcnt vmcnt(30)
    buffer_load_dwordx4 v16, s[32:35], s66 offen offset:2048  lds
    buffer_load_dwordx4 v17, s[32:35], s66 offen offset:3072  lds
    s_mov_b32 m0, 110592
    s_add_u32 s66, s66, 131072
    s_waitcnt vmcnt(30)
    buffer_load_dwordx4 v14, s[32:35], s66 offen offset:0  lds
    buffer_load_dwordx4 v15, s[32:35], s66 offen offset:1024  lds
    s_waitcnt vmcnt(30)
    buffer_load_dwordx4 v16, s[32:35], s66 offen offset:2048  lds
    buffer_load_dwordx4 v17, s[32:35], s66 offen offset:3072  lds
    s_lshl_b32 s66, s65, 20
    s_add_u32 s66, s66, 524288
    s_mov_b32 m0, 114688
    s_waitcnt vmcnt(30)
    buffer_load_dwordx4 v14, s[32:35], s66 offen offset:0  lds
    buffer_load_dwordx4 v15, s[32:35], s66 offen offset:1024  lds
    s_waitcnt vmcnt(30)
    buffer_load_dwordx4 v16, s[32:35], s66 offen offset:2048  lds
    buffer_load_dwordx4 v17, s[32:35], s66 offen offset:3072  lds
    s_mov_b32 m0, 118784
    s_add_u32 s66, s66, 131072
    s_waitcnt vmcnt(30)
    buffer_load_dwordx4 v14, s[32:35], s66 offen offset:0  lds
    buffer_load_dwordx4 v15, s[32:35], s66 offen offset:1024  lds
    s_waitcnt vmcnt(30)
    buffer_load_dwordx4 v16, s[32:35], s66 offen offset:2048  lds
    buffer_load_dwordx4 v17, s[32:35], s66 offen offset:3072  lds
    s_lshl_b32 s66, s65, 20
    s_add_u32 s66, s66, 786432
    s_mov_b32 m0, 122880
    s_waitcnt vmcnt(30)
    buffer_load_dwordx4 v14, s[32:35], s66 offen offset:0  lds
    buffer_load_dwordx4 v15, s[32:35], s66 offen offset:1024  lds
    s_waitcnt vmcnt(30)
    buffer_load_dwordx4 v16, s[32:35], s66 offen offset:2048  lds
    buffer_load_dwordx4 v17, s[32:35], s66 offen offset:3072  lds
    s_mov_b32 m0, 126976
    s_add_u32 s66, s66, 131072
    s_waitcnt vmcnt(30)
    buffer_load_dwordx4 v14, s[32:35], s66 offen offset:0  lds
    buffer_load_dwordx4 v15, s[32:35], s66 offen offset:1024  lds
    s_waitcnt vmcnt(30)
    buffer_load_dwordx4 v16, s[32:35], s66 offen offset:2048  lds
    buffer_load_dwordx4 v17, s[32:35], s66 offen offset:3072  lds
    s_mov_b32 m0, 90112
    s_mov_b32 s66, 24576
    s_waitcnt vmcnt(30)
    buffer_load_dwordx4 v22, s[24:27], s66 offen offset:0 nt lds
    buffer_load_dwordx4 v22, s[24:27], s66 offen offset:1024 nt lds
    s_waitcnt vmcnt(30)
    buffer_load_dwordx4 v22, s[24:27], s66 offen offset:2048 nt lds
    buffer_load_dwordx4 v22, s[24:27], s66 offen offset:3072 nt lds
    s_mov_b32 m0, 94208
    s_mov_b32 s66, 28672
    s_waitcnt vmcnt(30)
    buffer_load_dwordx4 v22, s[24:27], s66 offen offset:0 nt lds
    buffer_load_dwordx4 v22, s[24:27], s66 offen offset:1024 nt lds
    s_waitcnt vmcnt(30)
    buffer_load_dwordx4 v22, s[24:27], s66 offen offset:2048 nt lds
    buffer_load_dwordx4 v22, s[24:27], s66 offen offset:3072 nt lds
    s_lshr_b32 s65, s60, 1
    s_lshl_b32 s65, s65, 20
    s_and_b32 s66, s60, 1
    s_lshl_b32 s66, s66, 16
    s_add_u32 s66, s66, s65
    s_waitcnt vmcnt(30)
    buffer_load_dwordx4 v[60:63], v24, s[36:39], s66 offen offset:0
    buffer_load_dwordx4 v[56:59], v25, s[36:39], s66 offen offset:1024
    s_waitcnt vmcnt(30)
    buffer_load_dwordx4 v[60:63], v26, s[36:39], s66 offen offset:2048
    buffer_load_dwordx4 v[56:59], v27, s[36:39], s66 offen offset:3072
    s_add_u32 s66, s66, 16384
    s_waitcnt vmcnt(30)
    buffer_load_dwordx4 v[60:63], v24, s[36:39], s66 offen offset:0
    buffer_load_dwordx4 v[56:59], v25, s[36:39], s66 offen offset:1024
    s_waitcnt vmcnt(30)
    buffer_load_dwordx4 v[60:63], v26, s[36:39], s66 offen offset:2048
    buffer_load_dwordx4 v[56:59], v27, s[36:39], s66 offen offset:3072
    s_lshr_b32 s65, s60, 1
    s_lshl_b32 s65, s65, 20
    s_and_b32 s66, s60, 1
    s_lshl_b32 s66, s66, 16
    s_add_u32 s66, s66, s65
    s_add_u32 s66, s66, 32768
    s_waitcnt vmcnt(30)
    buffer_load_dwordx4 v[60:63], v24, s[36:39], s66 offen offset:0
    buffer_load_dwordx4 v[56:59], v25, s[36:39], s66 offen offset:1024
    s_waitcnt vmcnt(30)
    buffer_load_dwordx4 v[60:63], v26, s[36:39], s66 offen offset:2048
    buffer_load_dwordx4 v[56:59], v27, s[36:39], s66 offen offset:3072
    s_add_u32 s66, s66, 16384
    s_waitcnt vmcnt(30)
    buffer_load_dwordx4 v[60:63], v24, s[36:39], s66 offen offset:0
    buffer_load_dwordx4 v[56:59], v25, s[36:39], s66 offen offset:1024
    s_waitcnt vmcnt(30)
    buffer_load_dwordx4 v[60:63], v26, s[36:39], s66 offen offset:2048
    buffer_load_dwordx4 v[56:59], v27, s[36:39], s66 offen offset:3072
    s_mov_b32 m0, 0
    s_mov_b32 s66, 65536
    s_waitcnt vmcnt(30)
    buffer_load_dwordx4 v18, s[20:23], s66 offen offset:0 nt lds
    buffer_load_dwordx4 v19, s[20:23], s66 offen offset:1024 nt lds
    s_waitcnt vmcnt(30)
    buffer_load_dwordx4 v20, s[20:23], s66 offen offset:2048 nt lds
    buffer_load_dwordx4 v21, s[20:23], s66 offen offset:3072 nt lds
    s_mov_b32 m0, 4096
    s_mov_b32 s66, 69632
    s_waitcnt vmcnt(30)
    buffer_load_dwordx4 v18, s[20:23], s66 offen offset:0 nt lds
    buffer_load_dwordx4 v19, s[20:23], s66 offen offset:1024 nt lds
    s_waitcnt vmcnt(30)
    v_mov_b32 v8, 15
    ds_write_b32 v6, v8
    buffer_load_dwordx4 v20, s[20:23], s66 offen offset:2048 nt lds
    buffer_load_dwordx4 v21, s[20:23], s66 offen offset:3072 nt lds
    s_mov_b32 m0, 8192
    s_mov_b32 s66, 73728
    s_waitcnt vmcnt(30)
    buffer_load_dwordx4 v18, s[20:23], s66 offen offset:0 nt lds
    buffer_load_dwordx4 v19, s[20:23], s66 offen offset:1024 nt lds
    s_waitcnt vmcnt(30)
    buffer_load_dwordx4 v20, s[20:23], s66 offen offset:2048 nt lds
    buffer_load_dwordx4 v21, s[20:23], s66 offen offset:3072 nt lds
    s_mov_b32 m0, 12288
    s_mov_b32 s66, 77824
    s_waitcnt vmcnt(30)
    buffer_load_dwordx4 v18, s[20:23], s66 offen offset:0 nt lds
    buffer_load_dwordx4 v19, s[20:23], s66 offen offset:1024 nt lds
    s_waitcnt vmcnt(30)
    buffer_load_dwordx4 v20, s[20:23], s66 offen offset:2048 nt lds
    buffer_load_dwordx4 v21, s[20:23], s66 offen offset:3072 nt lds
    s_waitcnt vmcnt(16)
    s_branch L_steady
L_beta:
    s_mov_b32 m0, 0
    s_mov_b32 s66, 0
    s_waitcnt vmcnt(30)
    buffer_load_dwordx4 v18, s[20:23], s66 offen offset:0 nt lds
    buffer_load_dwordx4 v19, s[20:23], s66 offen offset:1024 nt lds
    s_waitcnt vmcnt(30)
    buffer_load_dwordx4 v20, s[20:23], s66 offen offset:2048 nt lds
    buffer_load_dwordx4 v21, s[20:23], s66 offen offset:3072 nt lds
    s_mov_b32 m0, 4096
    s_mov_b32 s66, 4096
    s_waitcnt vmcnt(30)
    buffer_load_dwordx4 v18, s[20:23], s66 offen offset:0 nt lds
    buffer_load_dwordx4 v19, s[20:23], s66 offen offset:1024 nt lds
    s_waitcnt vmcnt(30)
    buffer_load_dwordx4 v20, s[20:23], s66 offen offset:2048 nt lds
    buffer_load_dwordx4 v21, s[20:23], s66 offen offset:3072 nt lds
    s_mov_b32 s40, s18
    s_mov_b32 s41, s19
    s_mov_b32 s42, 0x600000
    s_mov_b32 s43, 0x20000
    s_mov_b32 s65, 8388608
    s_add_u32 s44, s18, s65
    s_addc_u32 s45, s19, 0
    s_mov_b32 s46, 0x800000
    s_mov_b32 s47, 0x20000
    s_mov_b32 s65, 33554432
    s_add_u32 s48, s18, s65
    s_addc_u32 s49, s19, 0
    s_mov_b32 s50, 0x8000
    s_mov_b32 s51, 0x20000
    s_mov_b32 s52, s14
    s_mov_b32 s53, s15
    s_mov_b32 s54, 0xc0000
    s_mov_b32 s55, 0x20000
    v_lshlrev_b32 v250, 4, v0
    v_lshlrev_b32 v251, 2, v0
    v_bfe_u32 v4, v0, 2, 2
    v_bfe_u32 v30, v0, 4, 1
    v_lshrrev_b32 v1, 5, v0
    v_lshlrev_b32 v29, 5, v30
    v_and_b32 v31, 1, v0
    v_lshl_add_u32 v28, v31, 4, v29
    v_bfe_u32 v31, v0, 1, 1
    v_lshl_add_u32 v28, v31, 3, v28
    v_lshl_add_u32 v31, v1, 2, v4
    v_lshlrev_b32 v31, 8, v31
    v_xor_b32 v232, s3, v4
    v_lshlrev_b32 v232, 6, v232
    v_and_b32 v238, 3, v0
    v_lshl_add_u32 v232, v238, 4, v232
    v_lshl_add_u32 v238, v30, 2, v4
    v_lshl_add_u32 v238, v1, 4, v238
    v_lshl_add_u32 v232, v238, 8, v232
    v_add_u32 v232, 131072, v232
    v_add_u32 v254, 156928, v251
    v_lshrrev_b32 v238, 4, v0
    v_and_b32 v252, 0xf0, v250
    v_lshl_add_u32 v252, v238, 9, v252
    v_mov_b32 v237, 1
    v_mov_b32 v235, 0x7ffffff0
    v_mov_b32 v236, 0x7ffffff0
    v_mov_b32 v239, 0x7ffffff0
    v_mov_b32 v240, 0x7ffffff0
    v_mov_b32 v255, 0x7ffffff0
    s_lshl_b32 s69, s60, 5
    s_add_u32 s69, s69, s62
    s_lshl_b32 s9, s2, 7
    s_lshl_b32 s70, s3, 11
    s_add_u32 s65, s63, 1
    s_and_b32 s65, s65, 3
    s_lshl_b32 s65, s65, 3
    s_add_u32 s65, s65, s69
    s_mul_i32 s65, s65, 24576
    s_add_u32 s71, s65, s70
    s_add_u32 s65, s63, 2
    s_and_b32 s65, s65, 3
    s_lshl_b32 s65, s65, 3
    s_add_u32 s65, s65, s69
    s_mul_i32 s65, s65, 24576
    s_add_u32 s72, s65, s70
    s_add_u32 s65, s63, 3
    s_and_b32 s65, s65, 3
    s_lshl_b32 s65, s65, 3
    s_add_u32 s65, s65, s69
    s_mul_i32 s65, s65, 24576
    s_add_u32 s73, s65, s70
    v_add_u32 v234, s63, v4
    v_and_b32 v234, 3, v234
    v_and_b32 v238, 3, v0
    v_min_u32 v238, 2, v238
    v_lshl_add_u32 v234, v234, 2, v238
    v_lshlrev_b32 v234, 2, v234
    s_and_b32 s65, s2, 0xf8
    s_lshl_b32 s65, s65, 15
    s_lshl_b32 s66, s62, 12
    s_add_u32 s65, s65, s66
    s_lshl_b32 s66, s3, 8
    s_add_u32 s68, s65, s66
    s_lshl_b32 s66, s3, 5
    s_add_u32 s75, s65, s66
    s_add_u32 s65, s64, 1
    s_and_b32 s65, s65, 3
    s_lshl_b32 s66, s65, 8
    s_mov_b32 m0, 131072
    s_waitcnt vmcnt(30)
    buffer_load_dwordx4 v10, s[28:31], s66 offen offset:0  lds
    buffer_load_dwordx4 v11, s[28:31], s66 offen offset:1024  lds
    s_waitcnt vmcnt(30)
    buffer_load_dwordx4 v12, s[28:31], s66 offen offset:2048  lds
    buffer_load_dwordx4 v13, s[28:31], s66 offen offset:3072  lds
    s_mov_b32 m0, 135168
    s_add_u32 s66, s66, 16384
    s_waitcnt vmcnt(30)
    buffer_load_dwordx4 v10, s[28:31], s66 offen offset:0  lds
    buffer_load_dwordx4 v11, s[28:31], s66 offen offset:1024  lds
    s_waitcnt vmcnt(30)
    buffer_load_dwordx4 v12, s[28:31], s66 offen offset:2048  lds
    buffer_load_dwordx4 v13, s[28:31], s66 offen offset:3072  lds
    s_lshl_b32 s66, s65, 8
    s_add_u32 s66, s66, 32768
    s_mov_b32 m0, 139264
    s_waitcnt vmcnt(30)
    buffer_load_dwordx4 v10, s[28:31], s66 offen offset:0  lds
    buffer_load_dwordx4 v11, s[28:31], s66 offen offset:1024  lds
    s_waitcnt vmcnt(30)
    buffer_load_dwordx4 v12, s[28:31], s66 offen offset:2048  lds
    buffer_load_dwordx4 v13, s[28:31], s66 offen offset:3072  lds
    s_mov_b32 m0, 143360
    s_add_u32 s66, s66, 16384
    s_waitcnt vmcnt(30)
    buffer_load_dwordx4 v10, s[28:31], s66 offen offset:0  lds
    buffer_load_dwordx4 v11, s[28:31], s66 offen offset:1024  lds
    s_waitcnt vmcnt(30)
    buffer_load_dwordx4 v12, s[28:31], s66 offen offset:2048  lds
    buffer_load_dwordx4 v13, s[28:31], s66 offen offset:3072  lds
    s_lshl_b32 s66, s65, 8
    s_add_u32 s66, s66, 65536
    s_mov_b32 m0, 147456
    s_waitcnt vmcnt(30)
    buffer_load_dwordx4 v10, s[28:31], s66 offen offset:0  lds
    buffer_load_dwordx4 v11, s[28:31], s66 offen offset:1024  lds
    s_waitcnt vmcnt(30)
    buffer_load_dwordx4 v12, s[28:31], s66 offen offset:2048  lds
    buffer_load_dwordx4 v13, s[28:31], s66 offen offset:3072  lds
    s_mov_b32 m0, 151552
    s_add_u32 s66, s66, 16384
    s_waitcnt vmcnt(30)
    buffer_load_dwordx4 v10, s[28:31], s66 offen offset:0  lds
    buffer_load_dwordx4 v11, s[28:31], s66 offen offset:1024  lds
    s_waitcnt vmcnt(30)
    v_mov_b32 v8, 1
    ds_write_b32 v6, v8
    buffer_load_dwordx4 v12, s[28:31], s66 offen offset:2048  lds
    buffer_load_dwordx4 v13, s[28:31], s66 offen offset:3072  lds
    s_lshl_b32 s66, s65, 20
    s_mov_b32 m0, 98304
    s_waitcnt vmcnt(30)
    buffer_load_dwordx4 v14, s[32:35], s66 offen offset:0  lds
    buffer_load_dwordx4 v15, s[32:35], s66 offen offset:1024  lds
    s_waitcnt vmcnt(30)
    buffer_load_dwordx4 v16, s[32:35], s66 offen offset:2048  lds
    buffer_load_dwordx4 v17, s[32:35], s66 offen offset:3072  lds
    s_mov_b32 m0, 102400
    s_add_u32 s66, s66, 131072
    s_waitcnt vmcnt(30)
    buffer_load_dwordx4 v14, s[32:35], s66 offen offset:0  lds
    buffer_load_dwordx4 v15, s[32:35], s66 offen offset:1024  lds
    s_waitcnt vmcnt(30)
    buffer_load_dwordx4 v16, s[32:35], s66 offen offset:2048  lds
    buffer_load_dwordx4 v17, s[32:35], s66 offen offset:3072  lds
    s_lshl_b32 s66, s65, 20
    s_add_u32 s66, s66, 262144
    s_mov_b32 m0, 106496
    s_waitcnt vmcnt(30)
    buffer_load_dwordx4 v14, s[32:35], s66 offen offset:0  lds
    buffer_load_dwordx4 v15, s[32:35], s66 offen offset:1024  lds
    s_waitcnt vmcnt(30)
    buffer_load_dwordx4 v16, s[32:35], s66 offen offset:2048  lds
    buffer_load_dwordx4 v17, s[32:35], s66 offen offset:3072  lds
    s_mov_b32 m0, 110592
    s_add_u32 s66, s66, 131072
    s_waitcnt vmcnt(30)
    buffer_load_dwordx4 v14, s[32:35], s66 offen offset:0  lds
    buffer_load_dwordx4 v15, s[32:35], s66 offen offset:1024  lds
    s_waitcnt vmcnt(30)
    buffer_load_dwordx4 v16, s[32:35], s66 offen offset:2048  lds
    buffer_load_dwordx4 v17, s[32:35], s66 offen offset:3072  lds
    s_lshl_b32 s66, s65, 20
    s_add_u32 s66, s66, 524288
    s_mov_b32 m0, 114688
    s_waitcnt vmcnt(30)
    buffer_load_dwordx4 v14, s[32:35], s66 offen offset:0  lds
    buffer_load_dwordx4 v15, s[32:35], s66 offen offset:1024  lds
    s_waitcnt vmcnt(30)
    buffer_load_dwordx4 v16, s[32:35], s66 offen offset:2048  lds
    buffer_load_dwordx4 v17, s[32:35], s66 offen offset:3072  lds
    s_mov_b32 m0, 118784
    s_add_u32 s66, s66, 131072
    s_waitcnt vmcnt(30)
    buffer_load_dwordx4 v14, s[32:35], s66 offen offset:0  lds
    buffer_load_dwordx4 v15, s[32:35], s66 offen offset:1024  lds
    s_waitcnt vmcnt(30)
    buffer_load_dwordx4 v16, s[32:35], s66 offen offset:2048  lds
    buffer_load_dwordx4 v17, s[32:35], s66 offen offset:3072  lds
    s_lshl_b32 s66, s65, 20
    s_add_u32 s66, s66, 786432
    s_mov_b32 m0, 122880
    s_waitcnt vmcnt(30)
    buffer_load_dwordx4 v14, s[32:35], s66 offen offset:0  lds
    buffer_load_dwordx4 v15, s[32:35], s66 offen offset:1024  lds
    s_waitcnt vmcnt(30)
    buffer_load_dwordx4 v16, s[32:35], s66 offen offset:2048  lds
    buffer_load_dwordx4 v17, s[32:35], s66 offen offset:3072  lds
    s_mov_b32 m0, 126976
    s_add_u32 s66, s66, 131072
    s_waitcnt vmcnt(30)
    buffer_load_dwordx4 v14, s[32:35], s66 offen offset:0  lds
    buffer_load_dwordx4 v15, s[32:35], s66 offen offset:1024  lds
    s_waitcnt vmcnt(30)
    buffer_load_dwordx4 v16, s[32:35], s66 offen offset:2048  lds
    buffer_load_dwordx4 v17, s[32:35], s66 offen offset:3072  lds
    s_mov_b32 m0, 8192
    s_mov_b32 s66, 8192
    s_waitcnt vmcnt(30)
    buffer_load_dwordx4 v18, s[20:23], s66 offen offset:0 nt lds
    buffer_load_dwordx4 v19, s[20:23], s66 offen offset:1024 nt lds
    s_waitcnt vmcnt(30)
    buffer_load_dwordx4 v20, s[20:23], s66 offen offset:2048 nt lds
    buffer_load_dwordx4 v21, s[20:23], s66 offen offset:3072 nt lds
    s_mov_b32 m0, 12288
    s_mov_b32 s66, 12288
    s_waitcnt vmcnt(30)
    buffer_load_dwordx4 v18, s[20:23], s66 offen offset:0 nt lds
    buffer_load_dwordx4 v19, s[20:23], s66 offen offset:1024 nt lds
    s_waitcnt vmcnt(30)
    buffer_load_dwordx4 v20, s[20:23], s66 offen offset:2048 nt lds
    buffer_load_dwordx4 v21, s[20:23], s66 offen offset:3072 nt lds
    s_mov_b32 m0, 16384
    s_mov_b32 s66, 16384
    s_waitcnt vmcnt(30)
    buffer_load_dwordx4 v18, s[20:23], s66 offen offset:0 nt lds
    buffer_load_dwordx4 v19, s[20:23], s66 offen offset:1024 nt lds
    s_waitcnt vmcnt(30)
    buffer_load_dwordx4 v20, s[20:23], s66 offen offset:2048 nt lds
    buffer_load_dwordx4 v21, s[20:23], s66 offen offset:3072 nt lds
    s_mov_b32 m0, 20480
    s_mov_b32 s66, 20480
    s_waitcnt vmcnt(30)
    buffer_load_dwordx4 v18, s[20:23], s66 offen offset:0 nt lds
    buffer_load_dwordx4 v19, s[20:23], s66 offen offset:1024 nt lds
    s_waitcnt vmcnt(30)
    buffer_load_dwordx4 v20, s[20:23], s66 offen offset:2048 nt lds
    buffer_load_dwordx4 v21, s[20:23], s66 offen offset:3072 nt lds
    s_mov_b32 m0, 24576
    s_mov_b32 s66, 24576
    s_waitcnt vmcnt(30)
    buffer_load_dwordx4 v18, s[20:23], s66 offen offset:0 nt lds
    buffer_load_dwordx4 v19, s[20:23], s66 offen offset:1024 nt lds
    s_waitcnt vmcnt(30)
    buffer_load_dwordx4 v20, s[20:23], s66 offen offset:2048 nt lds
    buffer_load_dwordx4 v21, s[20:23], s66 offen offset:3072 nt lds
    s_mov_b32 m0, 28672
    s_mov_b32 s66, 28672
    s_waitcnt vmcnt(30)
    buffer_load_dwordx4 v18, s[20:23], s66 offen offset:0 nt lds
    buffer_load_dwordx4 v19, s[20:23], s66 offen offset:1024 nt lds
    s_waitcnt vmcnt(30)
    buffer_load_dwordx4 v20, s[20:23], s66 offen offset:2048 nt lds
    buffer_load_dwordx4 v21, s[20:23], s66 offen offset:3072 nt lds
    ds_read_b32 v9, v7
    s_waitcnt lgkmcnt(0)
    v_readlane_b32 s67, v9, 0
    v_readlane_b32 s76, v9, 1
    v_readlane_b32 s77, v9, 2
    s_min_u32 s67, s67, s76
    s_min_u32 s67, s67, s77
    s_cmp_ge_u32 s67, 1
    s_cbranch_scc0 L_lslow_7
L_lback_8:
    s_mov_b32 m0, 32768
    s_mov_b32 s66, 32768
    s_waitcnt vmcnt(30)
    buffer_load_dwordx4 v18, s[20:23], s66 offen offset:0 nt lds
    buffer_load_dwordx4 v19, s[20:23], s66 offen offset:1024 nt lds
    s_waitcnt vmcnt(30)
    buffer_load_dwordx4 v20, s[20:23], s66 offen offset:2048 nt lds
    buffer_load_dwordx4 v21, s[20:23], s66 offen offset:3072 nt lds
    s_mov_b32 m0, 36864
    s_mov_b32 s66, 36864
    s_waitcnt vmcnt(30)
    buffer_load_dwordx4 v18, s[20:23], s66 offen offset:0 nt lds
    buffer_load_dwordx4 v19, s[20:23], s66 offen offset:1024 nt lds
    s_waitcnt vmcnt(30)
    v_mov_b32 v8, 2
    ds_write_b32 v6, v8
    buffer_load_dwordx4 v20, s[20:23], s66 offen offset:2048 nt lds
    buffer_load_dwordx4 v21, s[20:23], s66 offen offset:3072 nt lds
    s_mov_b32 m0, 40960
    s_mov_b32 s66, 40960
    s_waitcnt vmcnt(30)
    buffer_load_dwordx4 v18, s[20:23], s66 offen offset:0 nt lds
    buffer_load_dwordx4 v19, s[20:23], s66 offen offset:1024 nt lds
    s_waitcnt vmcnt(30)
    buffer_load_dwordx4 v20, s[20:23], s66 offen offset:2048 nt lds
    buffer_load_dwordx4 v21, s[20:23], s66 offen offset:3072 nt lds
    s_mov_b32 m0, 45056
    s_mov_b32 s66, 45056
    s_waitcnt vmcnt(30)
    buffer_load_dwordx4 v18, s[20:23], s66 offen offset:0 nt lds
    buffer_load_dwordx4 v19, s[20:23], s66 offen offset:1024 nt lds
    s_waitcnt vmcnt(30)
    buffer_load_dwordx4 v20, s[20:23], s66 offen offset:2048 nt lds
    buffer_load_dwordx4 v21, s[20:23], s66 offen offset:3072 nt lds
    ds_read_b32 v9, v7
    s_waitcnt lgkmcnt(0)
    v_readlane_b32 s67, v9, 0
    v_readlane_b32 s76, v9, 1
    v_readlane_b32 s77, v9, 2
    s_min_u32 s67, s67, s76
    s_min_u32 s67, s67, s77
    s_cmp_ge_u32 s67, 2
    s_cbranch_scc0 L_lslow_9
L_lback_10:
    s_add_u32 s65, s64, 2
    s_and_b32 s65, s65, 3
    s_lshl_b32 s66, s65, 8
    s_mov_b32 m0, 131072
    s_waitcnt vmcnt(30)
    buffer_load_dwordx4 v10, s[28:31], s66 offen offset:0  lds
    buffer_load_dwordx4 v11, s[28:31], s66 offen offset:1024  lds
    s_waitcnt vmcnt(30)
    buffer_load_dwordx4 v12, s[28:31], s66 offen offset:2048  lds
    buffer_load_dwordx4 v13, s[28:31], s66 offen offset:3072  lds
    s_mov_b32 m0, 135168
    s_add_u32 s66, s66, 16384
    s_waitcnt vmcnt(30)
    buffer_load_dwordx4 v10, s[28:31], s66 offen offset:0  lds
    buffer_load_dwordx4 v11, s[28:31], s66 offen offset:1024  lds
    s_waitcnt vmcnt(30)
    buffer_load_dwordx4 v12, s[28:31], s66 offen offset:2048  lds
    buffer_load_dwordx4 v13, s[28:31], s66 offen offset:3072  lds
    s_lshl_b32 s66, s65, 8
    s_add_u32 s66, s66, 32768
    s_mov_b32 m0, 139264
    s_waitcnt vmcnt(30)
    buffer_load_dwordx4 v10, s[28:31], s66 offen offset:0  lds
    buffer_load_dwordx4 v11, s[28:31], s66 offen offset:1024  lds
    s_waitcnt vmcnt(30)
    buffer_load_dwordx4 v12, s[28:31], s66 offen offset:2048  lds
    buffer_load_dwordx4 v13, s[28:31], s66 offen offset:3072  lds
    s_mov_b32 m0, 143360
    s_add_u32 s66, s66, 16384
    s_waitcnt vmcnt(30)
    buffer_load_dwordx4 v10, s[28:31], s66 offen offset:0  lds
    buffer_load_dwordx4 v11, s[28:31], s66 offen offset:1024  lds
    s_waitcnt vmcnt(30)
    buffer_load_dwordx4 v12, s[28:31], s66 offen offset:2048  lds
    buffer_load_dwordx4 v13, s[28:31], s66 offen offset:3072  lds
    s_lshl_b32 s66, s65, 8
    s_add_u32 s66, s66, 65536
    s_mov_b32 m0, 147456
    s_waitcnt vmcnt(30)
    buffer_load_dwordx4 v10, s[28:31], s66 offen offset:0  lds
    buffer_load_dwordx4 v11, s[28:31], s66 offen offset:1024  lds
    s_waitcnt vmcnt(30)
    buffer_load_dwordx4 v12, s[28:31], s66 offen offset:2048  lds
    buffer_load_dwordx4 v13, s[28:31], s66 offen offset:3072  lds
    s_mov_b32 m0, 151552
    s_add_u32 s66, s66, 16384
    s_waitcnt vmcnt(30)
    buffer_load_dwordx4 v10, s[28:31], s66 offen offset:0  lds
    buffer_load_dwordx4 v11, s[28:31], s66 offen offset:1024  lds
    s_waitcnt vmcnt(30)
    buffer_load_dwordx4 v12, s[28:31], s66 offen offset:2048  lds
    buffer_load_dwordx4 v13, s[28:31], s66 offen offset:3072  lds
    s_lshl_b32 s66, s65, 20
    s_mov_b32 m0, 98304
    s_waitcnt vmcnt(30)
    buffer_load_dwordx4 v14, s[32:35], s66 offen offset:0  lds
    buffer_load_dwordx4 v15, s[32:35], s66 offen offset:1024  lds
    s_waitcnt vmcnt(30)
    buffer_load_dwordx4 v16, s[32:35], s66 offen offset:2048  lds
    buffer_load_dwordx4 v17, s[32:35], s66 offen offset:3072  lds
    s_mov_b32 m0, 102400
    s_add_u32 s66, s66, 131072
    s_waitcnt vmcnt(30)
    buffer_load_dwordx4 v14, s[32:35], s66 offen offset:0  lds
    buffer_load_dwordx4 v15, s[32:35], s66 offen offset:1024  lds
    s_waitcnt vmcnt(30)
    buffer_load_dwordx4 v16, s[32:35], s66 offen offset:2048  lds
    buffer_load_dwordx4 v17, s[32:35], s66 offen offset:3072  lds
    s_lshl_b32 s66, s65, 20
    s_add_u32 s66, s66, 262144
    s_mov_b32 m0, 106496
    s_waitcnt vmcnt(30)
    buffer_load_dwordx4 v14, s[32:35], s66 offen offset:0  lds
    buffer_load_dwordx4 v15, s[32:35], s66 offen offset:1024  lds
    s_waitcnt vmcnt(30)
    buffer_load_dwordx4 v16, s[32:35], s66 offen offset:2048  lds
    buffer_load_dwordx4 v17, s[32:35], s66 offen offset:3072  lds
    s_mov_b32 m0, 110592
    s_add_u32 s66, s66, 131072
    s_waitcnt vmcnt(30)
    buffer_load_dwordx4 v14, s[32:35], s66 offen offset:0  lds
    buffer_load_dwordx4 v15, s[32:35], s66 offen offset:1024  lds
    s_waitcnt vmcnt(30)
    buffer_load_dwordx4 v16, s[32:35], s66 offen offset:2048  lds
    buffer_load_dwordx4 v17, s[32:35], s66 offen offset:3072  lds
    s_lshl_b32 s66, s65, 20
    s_add_u32 s66, s66, 524288
    s_mov_b32 m0, 114688
    s_waitcnt vmcnt(30)
    buffer_load_dwordx4 v14, s[32:35], s66 offen offset:0  lds
    buffer_load_dwordx4 v15, s[32:35], s66 offen offset:1024  lds
    s_waitcnt vmcnt(30)
    buffer_load_dwordx4 v16, s[32:35], s66 offen offset:2048  lds
    buffer_load_dwordx4 v17, s[32:35], s66 offen offset:3072  lds
    s_mov_b32 m0, 118784
    s_add_u32 s66, s66, 131072
    s_waitcnt vmcnt(30)
    buffer_load_dwordx4 v14, s[32:35], s66 offen offset:0  lds
    buffer_load_dwordx4 v15, s[32:35], s66 offen offset:1024  lds
    s_waitcnt vmcnt(30)
    buffer_load_dwordx4 v16, s[32:35], s66 offen offset:2048  lds
    buffer_load_dwordx4 v17, s[32:35], s66 offen offset:3072  lds
    s_lshl_b32 s66, s65, 20
    s_add_u32 s66, s66, 786432
    s_mov_b32 m0, 122880
    s_waitcnt vmcnt(30)
    buffer_load_dwordx4 v14, s[32:35], s66 offen offset:0  lds
    buffer_load_dwordx4 v15, s[32:35], s66 offen offset:1024  lds
    s_waitcnt vmcnt(30)
    buffer_load_dwordx4 v16, s[32:35], s66 offen offset:2048  lds
    buffer_load_dwordx4 v17, s[32:35], s66 offen offset:3072  lds
    s_mov_b32 m0, 126976
    s_add_u32 s66, s66, 131072
    s_waitcnt vmcnt(30)
    buffer_load_dwordx4 v14, s[32:35], s66 offen offset:0  lds
    buffer_load_dwordx4 v15, s[32:35], s66 offen offset:1024  lds
    s_waitcnt vmcnt(30)
    buffer_load_dwordx4 v16, s[32:35], s66 offen offset:2048  lds
    buffer_load_dwordx4 v17, s[32:35], s66 offen offset:3072  lds
    s_mov_b32 m0, 65536
    s_mov_b32 s66, 0
    s_waitcnt vmcnt(30)
    buffer_load_dwordx4 v22, s[24:27], s66 offen offset:0 nt lds
    buffer_load_dwordx4 v22, s[24:27], s66 offen offset:1024 nt lds
    s_waitcnt vmcnt(30)
    buffer_load_dwordx4 v22, s[24:27], s66 offen offset:2048 nt lds
    buffer_load_dwordx4 v22, s[24:27], s66 offen offset:3072 nt lds
    s_mov_b32 m0, 69632
    s_mov_b32 s66, 4096
    s_waitcnt vmcnt(30)
    buffer_load_dwordx4 v22, s[24:27], s66 offen offset:0 nt lds
    buffer_load_dwordx4 v22, s[24:27], s66 offen offset:1024 nt lds
    s_waitcnt vmcnt(30)
    buffer_load_dwordx4 v22, s[24:27], s66 offen offset:2048 nt lds
    buffer_load_dwordx4 v22, s[24:27], s66 offen offset:3072 nt lds
    s_mov_b32 m0, 73728
    s_mov_b32 s66, 8192
    s_waitcnt vmcnt(30)
    buffer_load_dwordx4 v22, s[24:27], s66 offen offset:0 nt lds
    buffer_load_dwordx4 v22, s[24:27], s66 offen offset:1024 nt lds
    s_waitcnt vmcnt(30)
    buffer_load_dwordx4 v22, s[24:27], s66 offen offset:2048 nt lds
    buffer_load_dwordx4 v22, s[24:27], s66 offen offset:3072 nt lds
    s_mov_b32 m0, 77824
    s_mov_b32 s66, 12288
    s_waitcnt vmcnt(30)
    buffer_load_dwordx4 v22, s[24:27], s66 offen offset:0 nt lds
    buffer_load_dwordx4 v22, s[24:27], s66 offen offset:1024 nt lds
    s_waitcnt vmcnt(30)
    buffer_load_dwordx4 v22, s[24:27], s66 offen offset:2048 nt lds
    buffer_load_dwordx4 v22, s[24:27], s66 offen offset:3072 nt lds
    s_mov_b32 m0, 49152
    s_mov_b32 s66, 49152
    s_waitcnt vmcnt(30)
    buffer_load_dwordx4 v18, s[20:23], s66 offen offset:0 nt lds
    buffer_load_dwordx4 v19, s[20:23], s66 offen offset:1024 nt lds
    s_waitcnt vmcnt(30)
    buffer_load_dwordx4 v20, s[20:23], s66 offen offset:2048 nt lds
    buffer_load_dwordx4 v21, s[20:23], s66 offen offset:3072 nt lds
    s_mov_b32 m0, 53248
    s_mov_b32 s66, 53248
    s_waitcnt vmcnt(30)
    buffer_load_dwordx4 v18, s[20:23], s66 offen offset:0 nt lds
    buffer_load_dwordx4 v19, s[20:23], s66 offen offset:1024 nt lds
    s_waitcnt vmcnt(30)
    buffer_load_dwordx4 v20, s[20:23], s66 offen offset:2048 nt lds
    buffer_load_dwordx4 v21, s[20:23], s66 offen offset:3072 nt lds
    s_mov_b32 m0, 57344
    s_mov_b32 s66, 57344
    s_waitcnt vmcnt(30)
    buffer_load_dwordx4 v18, s[20:23], s66 offen offset:0 nt lds
    buffer_load_dwordx4 v19, s[20:23], s66 offen offset:1024 nt lds
    s_waitcnt vmcnt(30)
    buffer_load_dwordx4 v20, s[20:23], s66 offen offset:2048 nt lds
    buffer_load_dwordx4 v21, s[20:23], s66 offen offset:3072 nt lds
    s_mov_b32 m0, 61440
    s_mov_b32 s66, 61440
    s_waitcnt vmcnt(30)
    buffer_load_dwordx4 v18, s[20:23], s66 offen offset:0 nt lds
    buffer_load_dwordx4 v19, s[20:23], s66 offen offset:1024 nt lds
    s_waitcnt vmcnt(30)
    v_mov_b32 v8, 3
    ds_write_b32 v6, v8
    buffer_load_dwordx4 v20, s[20:23], s66 offen offset:2048 nt lds
    buffer_load_dwordx4 v21, s[20:23], s66 offen offset:3072 nt lds
    s_mov_b32 m0, 81920
    s_mov_b32 s66, 16384
    s_waitcnt vmcnt(30)
    buffer_load_dwordx4 v22, s[24:27], s66 offen offset:0 nt lds
    buffer_load_dwordx4 v22, s[24:27], s66 offen offset:1024 nt lds
    s_waitcnt vmcnt(30)
    buffer_load_dwordx4 v22, s[24:27], s66 offen offset:2048 nt lds
    buffer_load_dwordx4 v22, s[24:27], s66 offen offset:3072 nt lds
    s_mov_b32 m0, 86016
    s_mov_b32 s66, 20480
    s_waitcnt vmcnt(30)
    buffer_load_dwordx4 v22, s[24:27], s66 offen offset:0 nt lds
    buffer_load_dwordx4 v22, s[24:27], s66 offen offset:1024 nt lds
    s_waitcnt vmcnt(30)
    buffer_load_dwordx4 v22, s[24:27], s66 offen offset:2048 nt lds
    buffer_load_dwordx4 v22, s[24:27], s66 offen offset:3072 nt lds
    ds_read_b32 v9, v7
    s_waitcnt lgkmcnt(0)
    v_readlane_b32 s67, v9, 0
    v_readlane_b32 s76, v9, 1
    v_readlane_b32 s77, v9, 2
    s_min_u32 s67, s67, s76
    s_min_u32 s67, s67, s77
    s_cmp_ge_u32 s67, 3
    s_cbranch_scc0 L_lslow_11
L_lback_12:
    s_add_u32 s65, s64, 3
    s_and_b32 s65, s65, 3
    s_lshl_b32 s66, s65, 8
    s_mov_b32 m0, 131072
    s_waitcnt vmcnt(30)
    buffer_load_dwordx4 v10, s[28:31], s66 offen offset:0  lds
    buffer_load_dwordx4 v11, s[28:31], s66 offen offset:1024  lds
    s_waitcnt vmcnt(30)
    buffer_load_dwordx4 v12, s[28:31], s66 offen offset:2048  lds
    buffer_load_dwordx4 v13, s[28:31], s66 offen offset:3072  lds
    s_mov_b32 m0, 135168
    s_add_u32 s66, s66, 16384
    s_waitcnt vmcnt(30)
    buffer_load_dwordx4 v10, s[28:31], s66 offen offset:0  lds
    buffer_load_dwordx4 v11, s[28:31], s66 offen offset:1024  lds
    s_waitcnt vmcnt(30)
    buffer_load_dwordx4 v12, s[28:31], s66 offen offset:2048  lds
    buffer_load_dwordx4 v13, s[28:31], s66 offen offset:3072  lds
    s_lshl_b32 s66, s65, 8
    s_add_u32 s66, s66, 32768
    s_mov_b32 m0, 139264
    s_waitcnt vmcnt(30)
    buffer_load_dwordx4 v10, s[28:31], s66 offen offset:0  lds
    buffer_load_dwordx4 v11, s[28:31], s66 offen offset:1024  lds
    s_waitcnt vmcnt(30)
    buffer_load_dwordx4 v12, s[28:31], s66 offen offset:2048  lds
    buffer_load_dwordx4 v13, s[28:31], s66 offen offset:3072  lds
    s_mov_b32 m0, 143360
    s_add_u32 s66, s66, 16384
    s_waitcnt vmcnt(30)
    buffer_load_dwordx4 v10, s[28:31], s66 offen offset:0  lds
    buffer_load_dwordx4 v11, s[28:31], s66 offen offset:1024  lds
    s_waitcnt vmcnt(30)
    buffer_load_dwordx4 v12, s[28:31], s66 offen offset:2048  lds
    buffer_load_dwordx4 v13, s[28:31], s66 offen offset:3072  lds
    s_lshl_b32 s66, s65, 8
    s_add_u32 s66, s66, 65536
    s_mov_b32 m0, 147456
    s_waitcnt vmcnt(30)
    buffer_load_dwordx4 v10, s[28:31], s66 offen offset:0  lds
    buffer_load_dwordx4 v11, s[28:31], s66 offen offset:1024  lds
    s_waitcnt vmcnt(30)
    buffer_load_dwordx4 v12, s[28:31], s66 offen offset:2048  lds
    buffer_load_dwordx4 v13, s[28:31], s66 offen offset:3072  lds
    s_mov_b32 m0, 151552
    s_add_u32 s66, s66, 16384
    s_waitcnt vmcnt(30)
    buffer_load_dwordx4 v10, s[28:31], s66 offen offset:0  lds
    buffer_load_dwordx4 v11, s[28:31], s66 offen offset:1024  lds
    s_waitcnt vmcnt(30)
    buffer_load_dwordx4 v12, s[28:31], s66 offen offset:2048  lds
    buffer_load_dwordx4 v13, s[28:31], s66 offen offset:3072  lds
    s_lshl_b32 s66, s65, 20
    s_mov_b32 m0, 98304
    s_waitcnt vmcnt(30)
    buffer_load_dwordx4 v14, s[32:35], s66 offen offset:0  lds
    buffer_load_dwordx4 v15, s[32:35], s66 offen offset:1024  lds
    s_waitcnt vmcnt(30)
    buffer_load_dwordx4 v16, s[32:35], s66 offen offset:2048  lds
    buffer_load_dwordx4 v17, s[32:35], s66 offen offset:3072  lds
    s_mov_b32 m0, 102400
    s_add_u32 s66, s66, 131072
    s_waitcnt vmcnt(30)
    buffer_load_dwordx4 v14, s[32:35], s66 offen offset:0  lds
    buffer_load_dwordx4 v15, s[32:35], s66 offen offset:1024  lds
    s_waitcnt vmcnt(30)
    buffer_load_dwordx4 v16, s[32:35], s66 offen offset:2048  lds
    buffer_load_dwordx4 v17, s[32:35], s66 offen offset:3072  lds
    s_lshl_b32 s66, s65, 20
    s_add_u32 s66, s66, 262144
    s_mov_b32 m0, 106496
    s_waitcnt vmcnt(30)
    buffer_load_dwordx4 v14, s[32:35], s66 offen offset:0  lds
    buffer_load_dwordx4 v15, s[32:35], s66 offen offset:1024  lds
    s_waitcnt vmcnt(30)
    buffer_load_dwordx4 v16, s[32:35], s66 offen offset:2048  lds
    buffer_load_dwordx4 v17, s[32:35], s66 offen offset:3072  lds
    s_mov_b32 m0, 110592
    s_add_u32 s66, s66, 131072
    s_waitcnt vmcnt(30)
    buffer_load_dwordx4 v14, s[32:35], s66 offen offset:0  lds
    buffer_load_dwordx4 v15, s[32:35], s66 offen offset:1024  lds
    s_waitcnt vmcnt(30)
    buffer_load_dwordx4 v16, s[32:35], s66 offen offset:2048  lds
    buffer_load_dwordx4 v17, s[32:35], s66 offen offset:3072  lds
    s_lshl_b32 s66, s65, 20
    s_add_u32 s66, s66, 524288
    s_mov_b32 m0, 114688
    s_waitcnt vmcnt(30)
    buffer_load_dwordx4 v14, s[32:35], s66 offen offset:0  lds
    buffer_load_dwordx4 v15, s[32:35], s66 offen offset:1024  lds
    s_waitcnt vmcnt(30)
    buffer_load_dwordx4 v16, s[32:35], s66 offen offset:2048  lds
    buffer_load_dwordx4 v17, s[32:35], s66 offen offset:3072  lds
    s_mov_b32 m0, 118784
    s_add_u32 s66, s66, 131072
    s_waitcnt vmcnt(30)
    buffer_load_dwordx4 v14, s[32:35], s66 offen offset:0  lds
    buffer_load_dwordx4 v15, s[32:35], s66 offen offset:1024  lds
    s_waitcnt vmcnt(30)
    buffer_load_dwordx4 v16, s[32:35], s66 offen offset:2048  lds
    buffer_load_dwordx4 v17, s[32:35], s66 offen offset:3072  lds
    s_lshl_b32 s66, s65, 20
    s_add_u32 s66, s66, 786432
    s_mov_b32 m0, 122880
    s_waitcnt vmcnt(30)
    buffer_load_dwordx4 v14, s[32:35], s66 offen offset:0  lds
    buffer_load_dwordx4 v15, s[32:35], s66 offen offset:1024  lds
    s_waitcnt vmcnt(30)
    buffer_load_dwordx4 v16, s[32:35], s66 offen offset:2048  lds
    buffer_load_dwordx4 v17, s[32:35], s66 offen offset:3072  lds
    s_mov_b32 m0, 126976
    s_add_u32 s66, s66, 131072
    s_waitcnt vmcnt(30)
    buffer_load_dwordx4 v14, s[32:35], s66 offen offset:0  lds
    buffer_load_dwordx4 v15, s[32:35], s66 offen offset:1024  lds
    s_waitcnt vmcnt(30)
    buffer_load_dwordx4 v16, s[32:35], s66 offen offset:2048  lds
    buffer_load_dwordx4 v17, s[32:35], s66 offen offset:3072  lds
    s_mov_b32 m0, 90112
    s_mov_b32 s66, 24576
    s_waitcnt vmcnt(30)
    buffer_load_dwordx4 v22, s[24:27], s66 offen offset:0 nt lds
    buffer_load_dwordx4 v22, s[24:27], s66 offen offset:1024 nt lds
    s_waitcnt vmcnt(30)
    buffer_load_dwordx4 v22, s[24:27], s66 offen offset:2048 nt lds
    buffer_load_dwordx4 v22, s[24:27], s66 offen offset:3072 nt lds
    s_mov_b32 m0, 94208
    s_mov_b32 s66, 28672
    s_waitcnt vmcnt(30)
    buffer_load_dwordx4 v22, s[24:27], s66 offen offset:0 nt lds
    buffer_load_dwordx4 v22, s[24:27], s66 offen offset:1024 nt lds
    s_waitcnt vmcnt(30)
    buffer_load_dwordx4 v22, s[24:27], s66 offen offset:2048 nt lds
    buffer_load_dwordx4 v22, s[24:27], s66 offen offset:3072 nt lds
    s_lshr_b32 s65, s60, 1
    s_lshl_b32 s65, s65, 20
    s_and_b32 s66, s60, 1
    s_lshl_b32 s66, s66, 16
    s_add_u32 s66, s66, s65
    s_waitcnt vmcnt(30)
    buffer_load_dwordx4 v[60:63], v24, s[36:39], s66 offen offset:0
    buffer_load_dwordx4 v[56:59], v25, s[36:39], s66 offen offset:1024
    s_waitcnt vmcnt(30)
    buffer_load_dwordx4 v[60:63], v26, s[36:39], s66 offen offset:2048
    buffer_load_dwordx4 v[56:59], v27, s[36:39], s66 offen offset:3072
    s_add_u32 s66, s66, 16384
    s_waitcnt vmcnt(30)
    buffer_load_dwordx4 v[60:63], v24, s[36:39], s66 offen offset:0
    buffer_load_dwordx4 v[56:59], v25, s[36:39], s66 offen offset:1024
    s_waitcnt vmcnt(30)
    buffer_load_dwordx4 v[60:63], v26, s[36:39], s66 offen offset:2048
    buffer_load_dwordx4 v[56:59], v27, s[36:39], s66 offen offset:3072
    s_lshr_b32 s65, s60, 1
    s_lshl_b32 s65, s65, 20
    s_and_b32 s66, s60, 1
    s_lshl_b32 s66, s66, 16
    s_add_u32 s66, s66, s65
    s_add_u32 s66, s66, 32768
    s_waitcnt vmcnt(30)
    buffer_load_dwordx4 v[60:63], v24, s[36:39], s66 offen offset:0
    buffer_load_dwordx4 v[56:59], v25, s[36:39], s66 offen offset:1024
    s_waitcnt vmcnt(30)
    buffer_load_dwordx4 v[60:63], v26, s[36:39], s66 offen offset:2048
    buffer_load_dwordx4 v[56:59], v27, s[36:39], s66 offen offset:3072
    s_add_u32 s66, s66, 16384
    s_waitcnt vmcnt(30)
    buffer_load_dwordx4 v[60:63], v24, s[36:39], s66 offen offset:0
    buffer_load_dwordx4 v[56:59], v25, s[36:39], s66 offen offset:1024
    s_waitcnt vmcnt(30)
    buffer_load_dwordx4 v[60:63], v26, s[36:39], s66 offen offset:2048
    buffer_load_dwordx4 v[56:59], v27, s[36:39], s66 offen offset:3072
    s_mov_b32 m0, 0
    s_mov_b32 s66, 65536
    s_waitcnt vmcnt(30)
    buffer_load_dwordx4 v18, s[20:23], s66 offen offset:0 nt lds
    buffer_load_dwordx4 v19, s[20:23], s66 offen offset:1024 nt lds
    s_waitcnt vmcnt(30)
    buffer_load_dwordx4 v20, s[20:23], s66 offen offset:2048 nt lds
    buffer_load_dwordx4 v21, s[20:23], s66 offen offset:3072 nt lds
    s_mov_b32 m0, 4096
    s_mov_b32 s66, 69632
    s_waitcnt vmcnt(30)
    buffer_load_dwordx4 v18, s[20:23], s66 offen offset:0 nt lds
    buffer_load_dwordx4 v19, s[20:23], s66 offen offset:1024 nt lds
    s_waitcnt vmcnt(30)
    v_mov_b32 v8, 15
    ds_write_b32 v6, v8
    buffer_load_dwordx4 v20, s[20:23], s66 offen offset:2048 nt lds
    buffer_load_dwordx4 v21, s[20:23], s66 offen offset:3072 nt lds
    s_mov_b32 m0, 8192
    s_mov_b32 s66, 73728
    s_waitcnt vmcnt(30)
    buffer_load_dwordx4 v18, s[20:23], s66 offen offset:0 nt lds
    buffer_load_dwordx4 v19, s[20:23], s66 offen offset:1024 nt lds
    s_waitcnt vmcnt(30)
    buffer_load_dwordx4 v20, s[20:23], s66 offen offset:2048 nt lds
    buffer_load_dwordx4 v21, s[20:23], s66 offen offset:3072 nt lds
    s_mov_b32 m0, 12288
    s_mov_b32 s66, 77824
    s_waitcnt vmcnt(30)
    buffer_load_dwordx4 v18, s[20:23], s66 offen offset:0 nt lds
    buffer_load_dwordx4 v19, s[20:23], s66 offen offset:1024 nt lds
    s_waitcnt vmcnt(30)
    buffer_load_dwordx4 v20, s[20:23], s66 offen offset:2048 nt lds
    buffer_load_dwordx4 v21, s[20:23], s66 offen offset:3072 nt lds
    s_waitcnt vmcnt(16)
L_steady:
    ds_read_b32 v9, v7
    s_waitcnt lgkmcnt(0)
    v_readlane_b32 s67, v9, 0
    v_readlane_b32 s76, v9, 1
    v_readlane_b32 s77, v9, 2
    s_min_u32 s67, s67, s76
    s_min_u32 s67, s67, s77
    s_cmp_ge_u32 s67, 5
    s_cbranch_scc0 L_lslow_13
L_lback_14:
    s_add_u32 s66, s63, 0
    s_and_b32 s66, s66, 3
    s_lshl_b32 s66, s66, 20
    s_mov_b32 m0, 131072
    s_waitcnt vmcnt(22)
    buffer_load_dwordx4 v24, s[36:39], s66 offen offset:0  lds
    buffer_load_dwordx4 v25, s[36:39], s66 offen offset:1024  lds
    s_waitcnt vmcnt(22)
    buffer_load_dwordx4 v26, s[36:39], s66 offen offset:2048  lds
    buffer_load_dwordx4 v27, s[36:39], s66 offen offset:3072  lds
    s_mov_b32 m0, 135168
    s_add_u32 s66, s66, 16384
    s_waitcnt vmcnt(22)
    buffer_load_dwordx4 v24, s[36:39], s66 offen offset:0  lds
    buffer_load_dwordx4 v25, s[36:39], s66 offen offset:1024  lds
    s_waitcnt vmcnt(22)
    buffer_load_dwordx4 v26, s[36:39], s66 offen offset:2048  lds
    buffer_load_dwordx4 v27, s[36:39], s66 offen offset:3072  lds
    s_add_u32 s66, s63, 0
    s_and_b32 s66, s66, 3
    s_lshl_b32 s66, s66, 20
    s_add_u32 s66, s66, 32768
    s_mov_b32 m0, 139264
    s_waitcnt vmcnt(22)
    buffer_load_dwordx4 v24, s[36:39], s66 offen offset:0  lds
    buffer_load_dwordx4 v25, s[36:39], s66 offen offset:1024  lds
    s_waitcnt vmcnt(22)
    buffer_load_dwordx4 v26, s[36:39], s66 offen offset:2048  lds
    buffer_load_dwordx4 v27, s[36:39], s66 offen offset:3072  lds
    s_mov_b32 m0, 143360
    s_add_u32 s66, s66, 16384
    s_waitcnt vmcnt(22)
    buffer_load_dwordx4 v24, s[36:39], s66 offen offset:0  lds
    buffer_load_dwordx4 v25, s[36:39], s66 offen offset:1024  lds
    s_waitcnt vmcnt(22)
    buffer_load_dwordx4 v26, s[36:39], s66 offen offset:2048  lds
    buffer_load_dwordx4 v27, s[36:39], s66 offen offset:3072  lds
    s_mov_b32 m0, 98304
    s_mov_b32 s66, 32768
    s_waitcnt vmcnt(22)
    buffer_load_dwordx4 v22, s[24:27], s66 offen offset:0 nt lds
    buffer_load_dwordx4 v22, s[24:27], s66 offen offset:1024 nt lds
    s_waitcnt vmcnt(22)
    buffer_load_dwordx4 v22, s[24:27], s66 offen offset:2048 nt lds
    buffer_load_dwordx4 v22, s[24:27], s66 offen offset:3072 nt lds
    s_mov_b32 m0, 102400
    s_mov_b32 s66, 36864
    s_waitcnt vmcnt(22)
    buffer_load_dwordx4 v22, s[24:27], s66 offen offset:0 nt lds
    buffer_load_dwordx4 v22, s[24:27], s66 offen offset:1024 nt lds
    s_waitcnt vmcnt(22)
    buffer_load_dwordx4 v22, s[24:27], s66 offen offset:2048 nt lds
    buffer_load_dwordx4 v22, s[24:27], s66 offen offset:3072 nt lds
    s_mov_b32 m0, 106496
    s_mov_b32 s66, 40960
    s_waitcnt vmcnt(22)
    buffer_load_dwordx4 v22, s[24:27], s66 offen offset:0 nt lds
    buffer_load_dwordx4 v22, s[24:27], s66 offen offset:1024 nt lds
    s_waitcnt vmcnt(22)
    buffer_load_dwordx4 v22, s[24:27], s66 offen offset:2048 nt lds
    buffer_load_dwordx4 v22, s[24:27], s66 offen offset:3072 nt lds
    s_mov_b32 m0, 110592
    s_mov_b32 s66, 45056
    s_waitcnt vmcnt(22)
    buffer_load_dwordx4 v22, s[24:27], s66 offen offset:0 nt lds
    buffer_load_dwordx4 v22, s[24:27], s66 offen offset:1024 nt lds
    s_waitcnt vmcnt(22)
    v_mov_b32 v8, 20
    ds_write_b32 v6, v8
    ds_read_b64_tr_b16 a[128:129], v232 offset:0
    ds_read_b64_tr_b16 a[130:131], v232 offset:2048
    ds_read_b64_tr_b16 a[132:133], v232 offset:8
    ds_read_b64_tr_b16 a[134:135], v232 offset:2056
    buffer_load_dwordx4 v22, s[24:27], s66 offen offset:2048 nt lds
    buffer_load_dwordx4 v22, s[24:27], s66 offen offset:3072 nt lds
    s_mov_b32 m0, 16384
    s_mov_b32 s66, 81920
    s_waitcnt vmcnt(22)
    buffer_load_dwordx4 v18, s[20:23], s66 offen offset:0 nt lds
    buffer_load_dwordx4 v19, s[20:23], s66 offen offset:1024 nt lds
    s_waitcnt vmcnt(22)
    buffer_load_dwordx4 v20, s[20:23], s66 offen offset:2048 nt lds
    buffer_load_dwordx4 v21, s[20:23], s66 offen offset:3072 nt lds
    s_mov_b32 m0, 20480
    s_mov_b32 s66, 86016
    s_waitcnt vmcnt(22)
    buffer_load_dwordx4 v18, s[20:23], s66 offen offset:0 nt lds
    buffer_load_dwordx4 v19, s[20:23], s66 offen offset:1024 nt lds
    s_waitcnt vmcnt(22)
    v_mov_b32 v8, 21
    ds_write_b32 v6, v8
    ds_read_b64_tr_b16 a[136:137], v232 offset:8192
    ds_read_b64_tr_b16 a[138:139], v232 offset:10240
    ds_read_b64_tr_b16 a[140:141], v232 offset:8200
    ds_read_b64_tr_b16 a[142:143], v232 offset:10248
    buffer_load_dwordx4 v20, s[20:23], s66 offen offset:2048 nt lds
    buffer_load_dwordx4 v21, s[20:23], s66 offen offset:3072 nt lds
    ds_read_b32 v9, v7
    s_mov_b32 m0, 24576
    s_mov_b32 s66, 90112
    s_waitcnt vmcnt(22)
    buffer_load_dwordx4 v18, s[20:23], s66 offen offset:0 nt lds
    buffer_load_dwordx4 v19, s[20:23], s66 offen offset:1024 nt lds
    s_waitcnt vmcnt(22)
    buffer_load_dwordx4 v20, s[20:23], s66 offen offset:2048 nt lds
    buffer_load_dwordx4 v21, s[20:23], s66 offen offset:3072 nt lds
    s_mov_b32 m0, 28672
    s_mov_b32 s66, 94208
    s_waitcnt vmcnt(22)
    buffer_load_dwordx4 v18, s[20:23], s66 offen offset:0 nt lds
    buffer_load_dwordx4 v19, s[20:23], s66 offen offset:1024 nt lds
    s_waitcnt vmcnt(22)
    v_mov_b32 v8, 22
    ds_write_b32 v6, v8
    buffer_load_dwordx4 v20, s[20:23], s66 offen offset:2048 nt lds
    buffer_load_dwordx4 v21, s[20:23], s66 offen offset:3072 nt lds
    s_mov_b32 m0, 114688
    s_mov_b32 s66, 49152
    s_waitcnt vmcnt(22)
    buffer_load_dwordx4 v22, s[24:27], s66 offen offset:0 nt lds
    buffer_load_dwordx4 v22, s[24:27], s66 offen offset:1024 nt lds
    s_waitcnt vmcnt(22)
    buffer_load_dwordx4 v22, s[24:27], s66 offen offset:2048 nt lds
    buffer_load_dwordx4 v22, s[24:27], s66 offen offset:3072 nt lds
    s_mov_b32 m0, 118784
    s_mov_b32 s66, 53248
    s_waitcnt vmcnt(22)
    buffer_load_dwordx4 v22, s[24:27], s66 offen offset:0 nt lds
    buffer_load_dwordx4 v22, s[24:27], s66 offen offset:1024 nt lds
    s_waitcnt vmcnt(22)
    v_mov_b32 v8, 23
    ds_write_b32 v6, v8
    buffer_load_dwordx4 v22, s[24:27], s66 offen offset:2048 nt lds
    buffer_load_dwordx4 v22, s[24:27], s66 offen offset:3072 nt lds
    s_waitcnt lgkmcnt(2)
    ds_read_b32 v9, v7
    s_mov_b32 m0, 122880
    s_mov_b32 s66, 57344
    s_waitcnt vmcnt(22)
    buffer_load_dwordx4 v22, s[24:27], s66 offen offset:0 nt lds
    buffer_load_dwordx4 v22, s[24:27], s66 offen offset:1024 nt lds
    s_waitcnt vmcnt(22)
    buffer_load_dwordx4 v22, s[24:27], s66 offen offset:2048 nt lds
    buffer_load_dwordx4 v22, s[24:27], s66 offen offset:3072 nt lds
    s_mov_b32 m0, 126976
    s_mov_b32 s66, 61440
    s_waitcnt vmcnt(22)
    buffer_load_dwordx4 v22, s[24:27], s66 offen offset:0 nt lds
    buffer_load_dwordx4 v22, s[24:27], s66 offen offset:1024 nt lds
    s_waitcnt vmcnt(22)
    v_mov_b32 v8, 24
    ds_write_b32 v6, v8
    buffer_load_dwordx4 v22, s[24:27], s66 offen offset:2048 nt lds
    buffer_load_dwordx4 v22, s[24:27], s66 offen offset:3072 nt lds
    s_waitcnt lgkmcnt(0)
    v_readlane_b32 s67, v9, 0
    v_readlane_b32 s76, v9, 1
    v_readlane_b32 s77, v9, 2
    s_min_u32 s67, s67, s76
    s_min_u32 s67, s67, s77
    s_cmp_ge_u32 s67, 6
    s_cbranch_scc0 L_lslow_15
L_lback_16:
    s_add_u32 s66, s63, 0
    s_and_b32 s66, s66, 3
    s_lshl_b32 s66, s66, 20
    s_add_u32 s66, s66, 65536
    s_mov_b32 m0, 147456
    s_waitcnt vmcnt(22)
    buffer_load_dwordx4 v24, s[36:39], s66 offen offset:0  lds
    buffer_load_dwordx4 v25, s[36:39], s66 offen offset:1024  lds
    s_waitcnt vmcnt(22)
    buffer_load_dwordx4 v26, s[36:39], s66 offen offset:2048  lds
    buffer_load_dwordx4 v27, s[36:39], s66 offen offset:3072  lds
    s_mov_b32 m0, 151552
    s_add_u32 s66, s66, 16384
    s_waitcnt vmcnt(22)
    buffer_load_dwordx4 v24, s[36:39], s66 offen offset:0  lds
    buffer_load_dwordx4 v25, s[36:39], s66 offen offset:1024  lds
    s_waitcnt vmcnt(22)
    v_mov_b32 v8, 25
    ds_write_b32 v6, v8
    buffer_load_dwordx4 v26, s[36:39], s66 offen offset:2048  lds
    buffer_load_dwordx4 v27, s[36:39], s66 offen offset:3072  lds
    s_mov_b32 m0, 32768
    s_mov_b32 s66, 98304
    s_waitcnt vmcnt(22)
    buffer_load_dwordx4 v18, s[20:23], s66 offen offset:0 nt lds
    buffer_load_dwordx4 v19, s[20:23], s66 offen offset:1024 nt lds
    s_waitcnt vmcnt(22)
    buffer_load_dwordx4 v20, s[20:23], s66 offen offset:2048 nt lds
    buffer_load_dwordx4 v21, s[20:23], s66 offen offset:3072 nt lds
    s_mov_b32 m0, 36864
    s_mov_b32 s66, 102400
    s_waitcnt vmcnt(22)
    buffer_load_dwordx4 v18, s[20:23], s66 offen offset:0 nt lds
    buffer_load_dwordx4 v19, s[20:23], s66 offen offset:1024 nt lds
    s_waitcnt vmcnt(22)
    v_mov_b32 v8, 26
    ds_write_b32 v6, v8
    buffer_load_dwordx4 v20, s[20:23], s66 offen offset:2048 nt lds
    buffer_load_dwordx4 v21, s[20:23], s66 offen offset:3072 nt lds
    ds_read_b32 v9, v7
    s_mov_b32 m0, 40960
    s_mov_b32 s66, 106496
    s_waitcnt vmcnt(22)
    buffer_load_dwordx4 v18, s[20:23], s66 offen offset:0 nt lds
    buffer_load_dwordx4 v19, s[20:23], s66 offen offset:1024 nt lds
    s_waitcnt vmcnt(22)
    buffer_load_dwordx4 v20, s[20:23], s66 offen offset:2048 nt lds
    buffer_load_dwordx4 v21, s[20:23], s66 offen offset:3072 nt lds
    s_mov_b32 m0, 45056
    s_mov_b32 s66, 110592
    s_waitcnt vmcnt(22)
    buffer_load_dwordx4 v18, s[20:23], s66 offen offset:0 nt lds
    buffer_load_dwordx4 v19, s[20:23], s66 offen offset:1024 nt lds
    s_waitcnt vmcnt(22)
    v_mov_b32 v8, 27
    ds_write_b32 v6, v8
    buffer_load_dwordx4 v20, s[20:23], s66 offen offset:2048 nt lds
    buffer_load_dwordx4 v21, s[20:23], s66 offen offset:3072 nt lds
    s_mov_b32 m0, 65536
    s_mov_b32 s66, 65536
    s_waitcnt vmcnt(22)
    buffer_load_dwordx4 v22, s[24:27], s66 offen offset:0 nt lds
    buffer_load_dwordx4 v22, s[24:27], s66 offen offset:1024 nt lds
    s_waitcnt vmcnt(22)
    buffer_load_dwordx4 v22, s[24:27], s66 offen offset:2048 nt lds
    buffer_load_dwordx4 v22, s[24:27], s66 offen offset:3072 nt lds
    s_mov_b32 m0, 69632
    s_mov_b32 s66, 69632
    s_waitcnt vmcnt(22)
    buffer_load_dwordx4 v22, s[24:27], s66 offen offset:0 nt lds
    buffer_load_dwordx4 v22, s[24:27], s66 offen offset:1024 nt lds
    s_waitcnt vmcnt(22)
    v_mov_b32 v8, 28
    ds_write_b32 v6, v8
    ds_read_b64_tr_b16 a[144:145], v232 offset:16384
    ds_read_b64_tr_b16 a[146:147], v232 offset:18432
    ds_read_b64_tr_b16 a[148:149], v232 offset:16392
    ds_read_b64_tr_b16 a[150:151], v232 offset:18440
    buffer_load_dwordx4 v22, s[24:27], s66 offen offset:2048 nt lds
    buffer_load_dwordx4 v22, s[24:27], s66 offen offset:3072 nt lds
    s_waitcnt lgkmcnt(6)
    ds_read_b32 v9, v7
    s_mov_b32 m0, 73728
    s_mov_b32 s66, 73728
    s_waitcnt vmcnt(22)
    buffer_load_dwordx4 v22, s[24:27], s66 offen offset:0 nt lds
    buffer_load_dwordx4 v22, s[24:27], s66 offen offset:1024 nt lds
    s_waitcnt vmcnt(22)
    buffer_load_dwordx4 v22, s[24:27], s66 offen offset:2048 nt lds
    buffer_load_dwordx4 v22, s[24:27], s66 offen offset:3072 nt lds
    s_mov_b32 m0, 77824
    s_mov_b32 s66, 77824
    s_waitcnt vmcnt(22)
    buffer_load_dwordx4 v22, s[24:27], s66 offen offset:0 nt lds
    buffer_load_dwordx4 v22, s[24:27], s66 offen offset:1024 nt lds
    s_waitcnt vmcnt(22)
    v_mov_b32 v8, 29
    ds_write_b32 v6, v8
    buffer_load_dwordx4 v22, s[24:27], s66 offen offset:2048 nt lds
    buffer_load_dwordx4 v22, s[24:27], s66 offen offset:3072 nt lds
    s_waitcnt lgkmcnt(0)
    v_readlane_b32 s67, v9, 0
    v_readlane_b32 s76, v9, 1
    v_readlane_b32 s77, v9, 2
    s_min_u32 s67, s67, s76
    s_min_u32 s67, s67, s77
    s_cmp_ge_u32 s67, 7
    s_cbranch_scc0 L_lslow_17
L_lback_18:
    s_add_u32 s66, s63, 0
    s_and_b32 s66, s66, 3
    s_lshl_b32 s66, s66, 20
    s_add_u32 s66, s66, 98304
    s_mov_b32 m0, 131072
    s_waitcnt vmcnt(22)
    buffer_load_dwordx4 v24, s[36:39], s66 offen offset:0  lds
    buffer_load_dwordx4 v25, s[36:39], s66 offen offset:1024  lds
    s_waitcnt vmcnt(22)
    buffer_load_dwordx4 v26, s[36:39], s66 offen offset:2048  lds
    buffer_load_dwordx4 v27, s[36:39], s66 offen offset:3072  lds
    s_mov_b32 m0, 135168
    s_add_u32 s66, s66, 16384
    s_waitcnt vmcnt(22)
    buffer_load_dwordx4 v24, s[36:39], s66 offen offset:0  lds
    buffer_load_dwordx4 v25, s[36:39], s66 offen offset:1024  lds
    s_waitcnt vmcnt(22)
    v_mov_b32 v8, 30
    ds_write_b32 v6, v8
    buffer_load_dwordx4 v26, s[36:39], s66 offen offset:2048  lds
    buffer_load_dwordx4 v27, s[36:39], s66 offen offset:3072  lds
    s_mov_b32 m0, 49152
    s_mov_b32 s66, 114688
    s_waitcnt vmcnt(22)
    buffer_load_dwordx4 v18, s[20:23], s66 offen offset:0 nt lds
    buffer_load_dwordx4 v19, s[20:23], s66 offen offset:1024 nt lds
    s_waitcnt vmcnt(22)
    buffer_load_dwordx4 v20, s[20:23], s66 offen offset:2048 nt lds
    buffer_load_dwordx4 v21, s[20:23], s66 offen offset:3072 nt lds
    s_mov_b32 m0, 53248
    s_mov_b32 s66, 118784
    s_waitcnt vmcnt(22)
    buffer_load_dwordx4 v18, s[20:23], s66 offen offset:0 nt lds
    buffer_load_dwordx4 v19, s[20:23], s66 offen offset:1024 nt lds
    s_waitcnt vmcnt(22)
    v_mov_b32 v8, 31
    ds_write_b32 v6, v8
    buffer_load_dwordx4 v20, s[20:23], s66 offen offset:2048 nt lds
    buffer_load_dwordx4 v21, s[20:23], s66 offen offset:3072 nt lds
    ds_read_b32 v9, v7
    s_mov_b32 m0, 57344
    s_mov_b32 s66, 122880
    s_waitcnt vmcnt(22)
    buffer_load_dwordx4 v18, s[20:23], s66 offen offset:0 nt lds
    buffer_load_dwordx4 v19, s[20:23], s66 offen offset:1024 nt lds
    s_waitcnt vmcnt(22)
    buffer_load_dwordx4 v20, s[20:23], s66 offen offset:2048 nt lds
    buffer_load_dwordx4 v21, s[20:23], s66 offen offset:3072 nt lds
    s_mov_b32 m0, 61440
    s_mov_b32 s66, 126976
    s_waitcnt vmcnt(22)
    buffer_load_dwordx4 v18, s[20:23], s66 offen offset:0 nt lds
    buffer_load_dwordx4 v19, s[20:23], s66 offen offset:1024 nt lds
    s_waitcnt vmcnt(22)
    v_mov_b32 v8, 32
    ds_write_b32 v6, v8
    buffer_load_dwordx4 v20, s[20:23], s66 offen offset:2048 nt lds
    buffer_load_dwordx4 v21, s[20:23], s66 offen offset:3072 nt lds
    s_mov_b32 m0, 81920
    s_mov_b32 s66, 81920
    s_waitcnt vmcnt(22)
    buffer_load_dwordx4 v22, s[24:27], s66 offen offset:0 nt lds
    buffer_load_dwordx4 v22, s[24:27], s66 offen offset:1024 nt lds
    s_waitcnt vmcnt(22)
    buffer_load_dwordx4 v22, s[24:27], s66 offen offset:2048 nt lds
    buffer_load_dwordx4 v22, s[24:27], s66 offen offset:3072 nt lds
    s_mov_b32 m0, 86016
    s_mov_b32 s66, 86016
    s_waitcnt vmcnt(22)
    buffer_load_dwordx4 v22, s[24:27], s66 offen offset:0 nt lds
    buffer_load_dwordx4 v22, s[24:27], s66 offen offset:1024 nt lds
    s_waitcnt vmcnt(22)
    v_mov_b32 v8, 33
    ds_write_b32 v6, v8
    ds_read_b64_tr_b16 a[152:153], v232 offset:0
    ds_read_b64_tr_b16 a[154:155], v232 offset:2048
    ds_read_b64_tr_b16 a[156:157], v232 offset:8
    ds_read_b64_tr_b16 a[158:159], v232 offset:2056
    buffer_load_dwordx4 v22, s[24:27], s66 offen offset:2048 nt lds
    buffer_load_dwordx4 v22, s[24:27], s66 offen offset:3072 nt lds
    s_waitcnt lgkmcnt(6)
    ds_read_b32 v9, v7
    s_mov_b32 m0, 90112
    s_mov_b32 s66, 90112
    s_waitcnt vmcnt(22)
    buffer_load_dwordx4 v22, s[24:27], s66 offen offset:0 nt lds
    buffer_load_dwordx4 v22, s[24:27], s66 offen offset:1024 nt lds
    s_waitcnt vmcnt(22)
    buffer_load_dwordx4 v22, s[24:27], s66 offen offset:2048 nt lds
    buffer_load_dwordx4 v22, s[24:27], s66 offen offset:3072 nt lds
    s_mov_b32 m0, 94208
    s_mov_b32 s66, 94208
    s_waitcnt vmcnt(22)
    buffer_load_dwordx4 v22, s[24:27], s66 offen offset:0 nt lds
    buffer_load_dwordx4 v22, s[24:27], s66 offen offset:1024 nt lds
    s_waitcnt vmcnt(22)
    v_mov_b32 v8, 34
    ds_write_b32 v6, v8
    buffer_load_dwordx4 v22, s[24:27], s66 offen offset:2048 nt lds
    buffer_load_dwordx4 v22, s[24:27], s66 offen offset:3072 nt lds
    s_waitcnt lgkmcnt(0)
    v_readlane_b32 s67, v9, 0
    v_readlane_b32 s76, v9, 1
    v_readlane_b32 s77, v9, 2
    s_min_u32 s67, s67, s76
    s_min_u32 s67, s67, s77
    s_cmp_ge_u32 s67, 8
    s_cbranch_scc0 L_lslow_19
L_lback_20:
    s_add_u32 s66, s63, 1
    s_and_b32 s66, s66, 3
    s_lshl_b32 s66, s66, 20
    s_mov_b32 m0, 139264
    s_waitcnt vmcnt(22)
    buffer_load_dwordx4 v24, s[36:39], s66 offen offset:0  lds
    buffer_load_dwordx4 v25, s[36:39], s66 offen offset:1024  lds
    s_waitcnt vmcnt(22)
    buffer_load_dwordx4 v26, s[36:39], s66 offen offset:2048  lds
    buffer_load_dwordx4 v27, s[36:39], s66 offen offset:3072  lds
    s_mov_b32 m0, 143360
    s_add_u32 s66, s66, 16384
    s_waitcnt vmcnt(22)
    buffer_load_dwordx4 v24, s[36:39], s66 offen offset:0  lds
    buffer_load_dwordx4 v25, s[36:39], s66 offen offset:1024  lds
    s_waitcnt vmcnt(22)
    v_mov_b32 v8, 35
    ds_write_b32 v6, v8
    buffer_load_dwordx4 v26, s[36:39], s66 offen offset:2048  lds
    buffer_load_dwordx4 v27, s[36:39], s66 offen offset:3072  lds
    s_mov_b32 m0, 0
    s_mov_b32 s66, 131072
    s_waitcnt vmcnt(22)
    buffer_load_dwordx4 v18, s[20:23], s66 offen offset:0 nt lds
    buffer_load_dwordx4 v19, s[20:23], s66 offen offset:1024 nt lds
    s_waitcnt vmcnt(22)
    buffer_load_dwordx4 v20, s[20:23], s66 offen offset:2048 nt lds
    buffer_load_dwordx4 v21, s[20:23], s66 offen offset:3072 nt lds
    s_mov_b32 m0, 4096
    s_mov_b32 s66, 135168
    s_waitcnt vmcnt(22)
    buffer_load_dwordx4 v18, s[20:23], s66 offen offset:0 nt lds
    buffer_load_dwordx4 v19, s[20:23], s66 offen offset:1024 nt lds
    s_waitcnt vmcnt(22)
    v_mov_b32 v8, 36
    ds_write_b32 v6, v8
    buffer_load_dwordx4 v20, s[20:23], s66 offen offset:2048 nt lds
    buffer_load_dwordx4 v21, s[20:23], s66 offen offset:3072 nt lds
    ds_read_b32 v9, v7
    s_mov_b32 m0, 8192
    s_mov_b32 s66, 139264
    s_waitcnt vmcnt(22)
    buffer_load_dwordx4 v18, s[20:23], s66 offen offset:0 nt lds
    buffer_load_dwordx4 v19, s[20:23], s66 offen offset:1024 nt lds
    s_waitcnt vmcnt(22)
    buffer_load_dwordx4 v20, s[20:23], s66 offen offset:2048 nt lds
    buffer_load_dwordx4 v21, s[20:23], s66 offen offset:3072 nt lds
    s_mov_b32 m0, 12288
    s_mov_b32 s66, 143360
    s_waitcnt vmcnt(22)
    buffer_load_dwordx4 v18, s[20:23], s66 offen offset:0 nt lds
    buffer_load_dwordx4 v19, s[20:23], s66 offen offset:1024 nt lds
    s_waitcnt vmcnt(22)
    v_mov_b32 v8, 37
    ds_write_b32 v6, v8
    buffer_load_dwordx4 v20, s[20:23], s66 offen offset:2048 nt lds
    buffer_load_dwordx4 v21, s[20:23], s66 offen offset:3072 nt lds
    s_mov_b32 m0, 98304
    s_mov_b32 s66, 98304
    s_waitcnt vmcnt(22)
    buffer_load_dwordx4 v22, s[24:27], s66 offen offset:0 nt lds
    buffer_load_dwordx4 v22, s[24:27], s66 offen offset:1024 nt lds
    s_waitcnt vmcnt(22)
    buffer_load_dwordx4 v22, s[24:27], s66 offen offset:2048 nt lds
    buffer_load_dwordx4 v22, s[24:27], s66 offen offset:3072 nt lds
    s_mov_b32 m0, 102400
    s_mov_b32 s66, 102400
    s_waitcnt vmcnt(22)
    buffer_load_dwordx4 v22, s[24:27], s66 offen offset:0 nt lds
    buffer_load_dwordx4 v22, s[24:27], s66 offen offset:1024 nt lds
    s_waitcnt vmcnt(22)
    v_mov_b32 v8, 38
    ds_write_b32 v6, v8
    ds_read_b64_tr_b16 a[160:161], v232 offset:8192
    ds_read_b64_tr_b16 a[162:163], v232 offset:10240
    ds_read_b64_tr_b16 a[164:165], v232 offset:8200
    ds_read_b64_tr_b16 a[166:167], v232 offset:10248
    buffer_load_dwordx4 v22, s[24:27], s66 offen offset:2048 nt lds
    buffer_load_dwordx4 v22, s[24:27], s66 offen offset:3072 nt lds
    s_waitcnt lgkmcnt(6)
    ds_read_b32 v9, v7
    s_mov_b32 m0, 106496
    s_mov_b32 s66, 106496
    s_waitcnt vmcnt(22)
    buffer_load_dwordx4 v22, s[24:27], s66 offen offset:0 nt lds
    buffer_load_dwordx4 v22, s[24:27], s66 offen offset:1024 nt lds
    s_waitcnt vmcnt(22)
    buffer_load_dwordx4 v22, s[24:27], s66 offen offset:2048 nt lds
    buffer_load_dwordx4 v22, s[24:27], s66 offen offset:3072 nt lds
    s_mov_b32 m0, 110592
    s_mov_b32 s66, 110592
    s_waitcnt vmcnt(22)
    buffer_load_dwordx4 v22, s[24:27], s66 offen offset:0 nt lds
    buffer_load_dwordx4 v22, s[24:27], s66 offen offset:1024 nt lds
    s_waitcnt vmcnt(22)
    v_mov_b32 v8, 39
    ds_write_b32 v6, v8
    buffer_load_dwordx4 v22, s[24:27], s66 offen offset:2048 nt lds
    buffer_load_dwordx4 v22, s[24:27], s66 offen offset:3072 nt lds
    s_waitcnt lgkmcnt(0)
    v_readlane_b32 s67, v9, 0
    v_readlane_b32 s76, v9, 1
    v_readlane_b32 s77, v9, 2
    s_min_u32 s67, s67, s76
    s_min_u32 s67, s67, s77
    s_cmp_ge_u32 s67, 9
    s_cbranch_scc0 L_lslow_21
L_lback_22:
    s_add_u32 s66, s63, 1
    s_and_b32 s66, s66, 3
    s_lshl_b32 s66, s66, 20
    s_add_u32 s66, s66, 32768
    s_mov_b32 m0, 147456
    s_waitcnt vmcnt(22)
    buffer_load_dwordx4 v24, s[36:39], s66 offen offset:0  lds
    buffer_load_dwordx4 v25, s[36:39], s66 offen offset:1024  lds
    s_waitcnt vmcnt(22)
    buffer_load_dwordx4 v26, s[36:39], s66 offen offset:2048  lds
    buffer_load_dwordx4 v27, s[36:39], s66 offen offset:3072  lds
    s_mov_b32 m0, 151552
    s_add_u32 s66, s66, 16384
    s_waitcnt vmcnt(22)
    buffer_load_dwordx4 v24, s[36:39], s66 offen offset:0  lds
    buffer_load_dwordx4 v25, s[36:39], s66 offen offset:1024  lds
    s_waitcnt vmcnt(22)
    v_mov_b32 v8, 40
    ds_write_b32 v6, v8
    buffer_load_dwordx4 v26, s[36:39], s66 offen offset:2048  lds
    buffer_load_dwordx4 v27, s[36:39], s66 offen offset:3072  lds
    s_mov_b32 m0, 16384
    s_mov_b32 s66, 147456
    s_waitcnt vmcnt(22)
    buffer_load_dwordx4 v18, s[20:23], s66 offen offset:0 nt lds
    buffer_load_dwordx4 v19, s[20:23], s66 offen offset:1024 nt lds
    s_waitcnt vmcnt(22)
    buffer_load_dwordx4 v20, s[20:23], s66 offen offset:2048 nt lds
    buffer_load_dwordx4 v21, s[20:23], s66 offen offset:3072 nt lds
    s_mov_b32 m0, 20480
    s_mov_b32 s66, 151552
    s_waitcnt vmcnt(22)
    buffer_load_dwordx4 v18, s[20:23], s66 offen offset:0 nt lds
    buffer_load_dwordx4 v19, s[20:23], s66 offen offset:1024 nt lds
    s_waitcnt vmcnt(22)
    v_mov_b32 v8, 41
    ds_write_b32 v6, v8
    buffer_load_dwordx4 v20, s[20:23], s66 offen offset:2048 nt lds
    buffer_load_dwordx4 v21, s[20:23], s66 offen offset:3072 nt lds
    ds_read_b32 v9, v7
    s_mov_b32 m0, 24576
    s_mov_b32 s66, 155648
    s_waitcnt vmcnt(22)
    buffer_load_dwordx4 v18, s[20:23], s66 offen offset:0 nt lds
    buffer_load_dwordx4 v19, s[20:23], s66 offen offset:1024 nt lds
    s_waitcnt vmcnt(22)
    buffer_load_dwordx4 v20, s[20:23], s66 offen offset:2048 nt lds
    buffer_load_dwordx4 v21, s[20:23], s66 offen offset:3072 nt lds
    s_mov_b32 m0, 28672
    s_mov_b32 s66, 159744
    s_waitcnt vmcnt(22)
    buffer_load_dwordx4 v18, s[20:23], s66 offen offset:0 nt lds
    buffer_load_dwordx4 v19, s[20:23], s66 offen offset:1024 nt lds
    s_waitcnt vmcnt(22)
    v_mov_b32 v8, 42
    ds_write_b32 v6, v8
    buffer_load_dwordx4 v20, s[20:23], s66 offen offset:2048 nt lds
    buffer_load_dwordx4 v21, s[20:23], s66 offen offset:3072 nt lds
    s_mov_b32 m0, 114688
    s_mov_b32 s66, 114688
    s_waitcnt vmcnt(22)
    buffer_load_dwordx4 v22, s[24:27], s66 offen offset:0 nt lds
    buffer_load_dwordx4 v22, s[24:27], s66 offen offset:1024 nt lds
    s_waitcnt vmcnt(22)
    buffer_load_dwordx4 v22, s[24:27], s66 offen offset:2048 nt lds
    buffer_load_dwordx4 v22, s[24:27], s66 offen offset:3072 nt lds
    s_mov_b32 m0, 118784
    s_mov_b32 s66, 118784
    s_waitcnt vmcnt(22)
    buffer_load_dwordx4 v22, s[24:27], s66 offen offset:0 nt lds
    buffer_load_dwordx4 v22, s[24:27], s66 offen offset:1024 nt lds
    s_waitcnt vmcnt(22)
    v_mov_b32 v8, 43
    ds_write_b32 v6, v8
    ds_read_b64_tr_b16 a[168:169], v232 offset:16384
    ds_read_b64_tr_b16 a[170:171], v232 offset:18432
    ds_read_b64_tr_b16 a[172:173], v232 offset:16392
    ds_read_b64_tr_b16 a[174:175], v232 offset:18440
    buffer_load_dwordx4 v22, s[24:27], s66 offen offset:2048 nt lds
    buffer_load_dwordx4 v22, s[24:27], s66 offen offset:3072 nt lds
    s_waitcnt lgkmcnt(6)
    ds_read_b32 v9, v7
    s_mov_b32 m0, 122880
    s_mov_b32 s66, 122880
    s_waitcnt vmcnt(22)
    buffer_load_dwordx4 v22, s[24:27], s66 offen offset:0 nt lds
    buffer_load_dwordx4 v22, s[24:27], s66 offen offset:1024 nt lds
    s_waitcnt vmcnt(22)
    buffer_load_dwordx4 v22, s[24:27], s66 offen offset:2048 nt lds
    buffer_load_dwordx4 v22, s[24:27], s66 offen offset:3072 nt lds
    s_mov_b32 m0, 126976
    s_mov_b32 s66, 126976
    s_waitcnt vmcnt(22)
    buffer_load_dwordx4 v22, s[24:27], s66 offen offset:0 nt lds
    buffer_load_dwordx4 v22, s[24:27], s66 offen offset:1024 nt lds
    s_waitcnt vmcnt(22)
    v_mov_b32 v8, 44
    ds_write_b32 v6, v8
    buffer_load_dwordx4 v22, s[24:27], s66 offen offset:2048 nt lds
    buffer_load_dwordx4 v22, s[24:27], s66 offen offset:3072 nt lds
    s_waitcnt lgkmcnt(0)
    v_readlane_b32 s67, v9, 0
    v_readlane_b32 s76, v9, 1
    v_readlane_b32 s77, v9, 2
    s_min_u32 s67, s67, s76
    s_min_u32 s67, s67, s77
    s_cmp_ge_u32 s67, 10
    s_cbranch_scc0 L_lslow_23
L_lback_24:
    s_add_u32 s66, s63, 1
    s_and_b32 s66, s66, 3
    s_lshl_b32 s66, s66, 20
    s_add_u32 s66, s66, 65536
    s_mov_b32 m0, 131072
    s_waitcnt vmcnt(22)
    buffer_load_dwordx4 v24, s[36:39], s66 offen offset:0  lds
    buffer_load_dwordx4 v25, s[36:39], s66 offen offset:1024  lds
    s_waitcnt vmcnt(22)
    buffer_load_dwordx4 v26, s[36:39], s66 offen offset:2048  lds
    buffer_load_dwordx4 v27, s[36:39], s66 offen offset:3072  lds
    s_mov_b32 m0, 135168
    s_add_u32 s66, s66, 16384
    s_waitcnt vmcnt(22)
    buffer_load_dwordx4 v24, s[36:39], s66 offen offset:0  lds
    buffer_load_dwordx4 v25, s[36:39], s66 offen offset:1024  lds
    s_waitcnt vmcnt(22)
    v_mov_b32 v8, 45
    ds_write_b32 v6, v8
    buffer_load_dwordx4 v26, s[36:39], s66 offen offset:2048  lds
    buffer_load_dwordx4 v27, s[36:39], s66 offen offset:3072  lds
    s_mov_b32 m0, 32768
    s_mov_b32 s66, 163840
    s_waitcnt vmcnt(22)
    buffer_load_dwordx4 v18, s[20:23], s66 offen offset:0 nt lds
    buffer_load_dwordx4 v19, s[20:23], s66 offen offset:1024 nt lds
    s_waitcnt vmcnt(22)
    buffer_load_dwordx4 v20, s[20:23], s66 offen offset:2048 nt lds
    buffer_load_dwordx4 v21, s[20:23], s66 offen offset:3072 nt lds
    s_mov_b32 m0, 36864
    s_mov_b32 s66, 167936
    s_waitcnt vmcnt(22)
    buffer_load_dwordx4 v18, s[20:23], s66 offen offset:0 nt lds
    buffer_load_dwordx4 v19, s[20:23], s66 offen offset:1024 nt lds
    s_waitcnt vmcnt(22)
    v_mov_b32 v8, 46
    ds_write_b32 v6, v8
    buffer_load_dwordx4 v20, s[20:23], s66 offen offset:2048 nt lds
    buffer_load_dwordx4 v21, s[20:23], s66 offen offset:3072 nt lds
    ds_read_b32 v9, v7
    s_mov_b32 m0, 40960
    s_mov_b32 s66, 172032
    s_waitcnt vmcnt(22)
    buffer_load_dwordx4 v18, s[20:23], s66 offen offset:0 nt lds
    buffer_load_dwordx4 v19, s[20:23], s66 offen offset:1024 nt lds
    s_waitcnt vmcnt(22)
    buffer_load_dwordx4 v20, s[20:23], s66 offen offset:2048 nt lds
    buffer_load_dwordx4 v21, s[20:23], s66 offen offset:3072 nt lds
    s_mov_b32 m0, 45056
    s_mov_b32 s66, 176128
    s_waitcnt vmcnt(22)
    buffer_load_dwordx4 v18, s[20:23], s66 offen offset:0 nt lds
    buffer_load_dwordx4 v19, s[20:23], s66 offen offset:1024 nt lds
    s_waitcnt vmcnt(22)
    v_mov_b32 v8, 47
    ds_write_b32 v6, v8
    buffer_load_dwordx4 v20, s[20:23], s66 offen offset:2048 nt lds
    buffer_load_dwordx4 v21, s[20:23], s66 offen offset:3072 nt lds
    s_mov_b32 m0, 65536
    s_mov_b32 s66, 131072
    s_waitcnt vmcnt(22)
    buffer_load_dwordx4 v22, s[24:27], s66 offen offset:0 nt lds
    buffer_load_dwordx4 v22, s[24:27], s66 offen offset:1024 nt lds
    s_waitcnt vmcnt(22)
    buffer_load_dwordx4 v22, s[24:27], s66 offen offset:2048 nt lds
    buffer_load_dwordx4 v22, s[24:27], s66 offen offset:3072 nt lds
    s_mov_b32 m0, 69632
    s_mov_b32 s66, 135168
    s_waitcnt vmcnt(22)
    buffer_load_dwordx4 v22, s[24:27], s66 offen offset:0 nt lds
    buffer_load_dwordx4 v22, s[24:27], s66 offen offset:1024 nt lds
    s_waitcnt vmcnt(22)
    v_mov_b32 v8, 48
    ds_write_b32 v6, v8
    ds_read_b64_tr_b16 a[176:177], v232 offset:0
    ds_read_b64_tr_b16 a[178:179], v232 offset:2048
    ds_read_b64_tr_b16 a[180:181], v232 offset:8
    ds_read_b64_tr_b16 a[182:183], v232 offset:2056
    buffer_load_dwordx4 v22, s[24:27], s66 offen offset:2048 nt lds
    buffer_load_dwordx4 v22, s[24:27], s66 offen offset:3072 nt lds
    s_waitcnt lgkmcnt(6)
    ds_read_b32 v9, v7
    s_mov_b32 m0, 73728
    s_mov_b32 s66, 139264
    s_waitcnt vmcnt(22)
    buffer_load_dwordx4 v22, s[24:27], s66 offen offset:0 nt lds
    buffer_load_dwordx4 v22, s[24:27], s66 offen offset:1024 nt lds
    s_waitcnt vmcnt(22)
    buffer_load_dwordx4 v22, s[24:27], s66 offen offset:2048 nt lds
    buffer_load_dwordx4 v22, s[24:27], s66 offen offset:3072 nt lds
    s_mov_b32 m0, 77824
    s_mov_b32 s66, 143360
    s_waitcnt vmcnt(22)
    buffer_load_dwordx4 v22, s[24:27], s66 offen offset:0 nt lds
    buffer_load_dwordx4 v22, s[24:27], s66 offen offset:1024 nt lds
    s_waitcnt vmcnt(22)
    v_mov_b32 v8, 49
    ds_write_b32 v6, v8
    buffer_load_dwordx4 v22, s[24:27], s66 offen offset:2048 nt lds
    buffer_load_dwordx4 v22, s[24:27], s66 offen offset:3072 nt lds
    s_waitcnt lgkmcnt(0)
    v_readlane_b32 s67, v9, 0
    v_readlane_b32 s76, v9, 1
    v_readlane_b32 s77, v9, 2
    s_min_u32 s67, s67, s76
    s_min_u32 s67, s67, s77
    s_cmp_ge_u32 s67, 11
    s_cbranch_scc0 L_lslow_25
L_lback_26:
    s_add_u32 s66, s63, 1
    s_and_b32 s66, s66, 3
    s_lshl_b32 s66, s66, 20
    s_add_u32 s66, s66, 98304
    s_mov_b32 m0, 139264
    s_waitcnt vmcnt(22)
    buffer_load_dwordx4 v24, s[36:39], s66 offen offset:0  lds
    buffer_load_dwordx4 v25, s[36:39], s66 offen offset:1024  lds
    s_waitcnt vmcnt(22)
    buffer_load_dwordx4 v26, s[36:39], s66 offen offset:2048  lds
    buffer_load_dwordx4 v27, s[36:39], s66 offen offset:3072  lds
    s_mov_b32 m0, 143360
    s_add_u32 s66, s66, 16384
    s_waitcnt vmcnt(22)
    buffer_load_dwordx4 v24, s[36:39], s66 offen offset:0  lds
    buffer_load_dwordx4 v25, s[36:39], s66 offen offset:1024  lds
    s_waitcnt vmcnt(22)
    v_mov_b32 v8, 50
    ds_write_b32 v6, v8
    buffer_load_dwordx4 v26, s[36:39], s66 offen offset:2048  lds
    buffer_load_dwordx4 v27, s[36:39], s66 offen offset:3072  lds
    s_mov_b32 m0, 49152
    s_mov_b32 s66, 180224
    s_waitcnt vmcnt(22)
    buffer_load_dwordx4 v18, s[20:23], s66 offen offset:0 nt lds
    buffer_load_dwordx4 v19, s[20:23], s66 offen offset:1024 nt lds
    s_waitcnt vmcnt(22)
    buffer_load_dwordx4 v20, s[20:23], s66 offen offset:2048 nt lds
    buffer_load_dwordx4 v21, s[20:23], s66 offen offset:3072 nt lds
    s_mov_b32 m0, 53248
    s_mov_b32 s66, 184320
    s_waitcnt vmcnt(22)
    buffer_load_dwordx4 v18, s[20:23], s66 offen offset:0 nt lds
    buffer_load_dwordx4 v19, s[20:23], s66 offen offset:1024 nt lds
    s_waitcnt vmcnt(22)
    v_mov_b32 v8, 51
    ds_write_b32 v6, v8
    buffer_load_dwordx4 v20, s[20:23], s66 offen offset:2048 nt lds
    buffer_load_dwordx4 v21, s[20:23], s66 offen offset:3072 nt lds
    ds_read_b32 v9, v7
    s_mov_b32 m0, 57344
    s_mov_b32 s66, 188416
    s_waitcnt vmcnt(22)
    buffer_load_dwordx4 v18, s[20:23], s66 offen offset:0 nt lds
    buffer_load_dwordx4 v19, s[20:23], s66 offen offset:1024 nt lds
    s_waitcnt vmcnt(22)
    buffer_load_dwordx4 v20, s[20:23], s66 offen offset:2048 nt lds
    buffer_load_dwordx4 v21, s[20:23], s66 offen offset:3072 nt lds
    s_mov_b32 m0, 61440
    s_mov_b32 s66, 192512
    s_waitcnt vmcnt(22)
    buffer_load_dwordx4 v18, s[20:23], s66 offen offset:0 nt lds
    buffer_load_dwordx4 v19, s[20:23], s66 offen offset:1024 nt lds
    s_waitcnt vmcnt(22)
    v_mov_b32 v8, 52
    ds_write_b32 v6, v8
    buffer_load_dwordx4 v20, s[20:23], s66 offen offset:2048 nt lds
    buffer_load_dwordx4 v21, s[20:23], s66 offen offset:3072 nt lds
    s_waitcnt lgkmcnt(0)
    v_readlane_b32 s67, v9, 0
    v_readlane_b32 s76, v9, 1
    v_readlane_b32 s77, v9, 2
    s_min_u32 s67, s67, s76
    s_min_u32 s67, s67, s77
    s_cmp_ge_u32 s67, 12
    s_cbranch_scc0 L_lslow_27
L_lback_28:
    s_add_u32 s66, s63, 2
    s_and_b32 s66, s66, 3
    s_lshl_b32 s66, s66, 20
    s_mov_b32 m0, 147456
    s_waitcnt vmcnt(22)
    buffer_load_dwordx4 v24, s[36:39], s66 offen offset:0  lds
    buffer_load_dwordx4 v25, s[36:39], s66 offen offset:1024  lds
    s_waitcnt vmcnt(22)
    buffer_load_dwordx4 v26, s[36:39], s66 offen offset:2048  lds
    buffer_load_dwordx4 v27, s[36:39], s66 offen offset:3072  lds
    s_mov_b32 m0, 151552
    s_add_u32 s66, s66, 16384
    s_waitcnt vmcnt(22)
    buffer_load_dwordx4 v24, s[36:39], s66 offen offset:0  lds
    buffer_load_dwordx4 v25, s[36:39], s66 offen offset:1024  lds
    s_waitcnt vmcnt(22)
    v_mov_b32 v8, 53
    ds_write_b32 v6, v8
    ds_read_b64_tr_b16 a[184:185], v232 offset:8192
    ds_read_b64_tr_b16 a[186:187], v232 offset:10240
    ds_read_b64_tr_b16 a[188:189], v232 offset:8200
    ds_read_b64_tr_b16 a[190:191], v232 offset:10248
    buffer_load_dwordx4 v26, s[36:39], s66 offen offset:2048  lds
    buffer_load_dwordx4 v27, s[36:39], s66 offen offset:3072  lds
    s_mov_b32 m0, 81920
    s_mov_b32 s66, 147456
    s_waitcnt vmcnt(22)
    buffer_load_dwordx4 v22, s[24:27], s66 offen offset:0 nt lds
    buffer_load_dwordx4 v22, s[24:27], s66 offen offset:1024 nt lds
    s_waitcnt vmcnt(22)
    buffer_load_dwordx4 v22, s[24:27], s66 offen offset:2048 nt lds
    buffer_load_dwordx4 v22, s[24:27], s66 offen offset:3072 nt lds
    s_mov_b32 m0, 86016
    s_mov_b32 s66, 151552
    s_waitcnt vmcnt(22)
    buffer_load_dwordx4 v22, s[24:27], s66 offen offset:0 nt lds
    buffer_load_dwordx4 v22, s[24:27], s66 offen offset:1024 nt lds
    s_waitcnt vmcnt(22)
    v_mov_b32 v8, 54
    ds_write_b32 v6, v8
    buffer_load_dwordx4 v22, s[24:27], s66 offen offset:2048 nt lds
    buffer_load_dwordx4 v22, s[24:27], s66 offen offset:3072 nt lds
    s_mov_b32 m0, 90112
    s_mov_b32 s66, 155648
    s_waitcnt vmcnt(22)
    buffer_load_dwordx4 v22, s[24:27], s66 offen offset:0 nt lds
    buffer_load_dwordx4 v22, s[24:27], s66 offen offset:1024 nt lds
    s_waitcnt vmcnt(22)
    buffer_load_dwordx4 v22, s[24:27], s66 offen offset:2048 nt lds
    buffer_load_dwordx4 v22, s[24:27], s66 offen offset:3072 nt lds
    s_mov_b32 m0, 94208
    s_mov_b32 s66, 159744
    s_waitcnt vmcnt(22)
    buffer_load_dwordx4 v22, s[24:27], s66 offen offset:0 nt lds
    buffer_load_dwordx4 v22, s[24:27], s66 offen offset:1024 nt lds
    s_waitcnt vmcnt(22)
    v_mov_b32 v8, 55
    ds_write_b32 v6, v8
    buffer_load_dwordx4 v22, s[24:27], s66 offen offset:2048 nt lds
    buffer_load_dwordx4 v22, s[24:27], s66 offen offset:3072 nt lds
    s_mov_b32 m0, 0
    s_mov_b32 s66, 196608
    s_waitcnt vmcnt(22)
    buffer_load_dwordx4 v18, s[20:23], s66 offen offset:0 nt lds
    buffer_load_dwordx4 v19, s[20:23], s66 offen offset:1024 nt lds
    s_waitcnt vmcnt(22)
    buffer_load_dwordx4 v20, s[20:23], s66 offen offset:2048 nt lds
    buffer_load_dwordx4 v21, s[20:23], s66 offen offset:3072 nt lds
    s_mov_b32 m0, 4096
    s_mov_b32 s66, 200704
    s_waitcnt vmcnt(22)
    buffer_load_dwordx4 v18, s[20:23], s66 offen offset:0 nt lds
    buffer_load_dwordx4 v19, s[20:23], s66 offen offset:1024 nt lds
    s_waitcnt vmcnt(22)
    v_mov_b32 v8, 56
    ds_write_b32 v6, v8
    ds_read_b64_tr_b16 a[192:193], v232 offset:16384
    ds_read_b64_tr_b16 a[194:195], v232 offset:18432
    ds_read_b64_tr_b16 a[196:197], v232 offset:16392
    ds_read_b64_tr_b16 a[198:199], v232 offset:18440
    buffer_load_dwordx4 v20, s[20:23], s66 offen offset:2048 nt lds
    buffer_load_dwordx4 v21, s[20:23], s66 offen offset:3072 nt lds
    ds_read_b32 v9, v7
    s_mov_b32 m0, 8192
    s_mov_b32 s66, 204800
    s_waitcnt vmcnt(22)
    buffer_load_dwordx4 v18, s[20:23], s66 offen offset:0 nt lds
    buffer_load_dwordx4 v19, s[20:23], s66 offen offset:1024 nt lds
    s_waitcnt vmcnt(22)
    buffer_load_dwordx4 v20, s[20:23], s66 offen offset:2048 nt lds
    buffer_load_dwordx4 v21, s[20:23], s66 offen offset:3072 nt lds
    s_mov_b32 m0, 12288
    s_mov_b32 s66, 208896
    s_waitcnt vmcnt(22)
    buffer_load_dwordx4 v18, s[20:23], s66 offen offset:0 nt lds
    buffer_load_dwordx4 v19, s[20:23], s66 offen offset:1024 nt lds
    s_waitcnt vmcnt(22)
    v_mov_b32 v8, 57
    ds_write_b32 v6, v8
    buffer_load_dwordx4 v20, s[20:23], s66 offen offset:2048 nt lds
    buffer_load_dwordx4 v21, s[20:23], s66 offen offset:3072 nt lds
    s_waitcnt lgkmcnt(0)
    v_readlane_b32 s67, v9, 0
    v_readlane_b32 s76, v9, 1
    v_readlane_b32 s77, v9, 2
    s_min_u32 s67, s67, s76
    s_min_u32 s67, s67, s77
    s_cmp_ge_u32 s67, 13
    s_cbranch_scc0 L_lslow_29
L_lback_30:
    s_add_u32 s66, s63, 2
    s_and_b32 s66, s66, 3
    s_lshl_b32 s66, s66, 20
    s_add_u32 s66, s66, 32768
    s_mov_b32 m0, 131072
    s_waitcnt vmcnt(22)
    buffer_load_dwordx4 v24, s[36:39], s66 offen offset:0  lds
    buffer_load_dwordx4 v25, s[36:39], s66 offen offset:1024  lds
    s_waitcnt vmcnt(22)
    buffer_load_dwordx4 v26, s[36:39], s66 offen offset:2048  lds
    buffer_load_dwordx4 v27, s[36:39], s66 offen offset:3072  lds
    s_mov_b32 m0, 135168
    s_add_u32 s66, s66, 16384
    s_waitcnt vmcnt(22)
    buffer_load_dwordx4 v24, s[36:39], s66 offen offset:0  lds
    buffer_load_dwordx4 v25, s[36:39], s66 offen offset:1024  lds
    s_waitcnt vmcnt(22)
    v_mov_b32 v8, 58
    ds_write_b32 v6, v8
    buffer_load_dwordx4 v26, s[36:39], s66 offen offset:2048  lds
    buffer_load_dwordx4 v27, s[36:39], s66 offen offset:3072  lds
    s_mov_b32 m0, 98304
    s_mov_b32 s66, 163840
    s_waitcnt vmcnt(22)
    buffer_load_dwordx4 v22, s[24:27], s66 offen offset:0 nt lds
    buffer_load_dwordx4 v22, s[24:27], s66 offen offset:1024 nt lds
    s_waitcnt vmcnt(22)
    buffer_load_dwordx4 v22, s[24:27], s66 offen offset:2048 nt lds
    buffer_load_dwordx4 v22, s[24:27], s66 offen offset:3072 nt lds
    s_mov_b32 m0, 102400
    s_mov_b32 s66, 167936
    s_waitcnt vmcnt(22)
    buffer_load_dwordx4 v22, s[24:27], s66 offen offset:0 nt lds
    buffer_load_dwordx4 v22, s[24:27], s66 offen offset:1024 nt lds
    s_waitcnt vmcnt(22)
    v_mov_b32 v8, 59
    ds_write_b32 v6, v8
    buffer_load_dwordx4 v22, s[24:27], s66 offen offset:2048 nt lds
    buffer_load_dwordx4 v22, s[24:27], s66 offen offset:3072 nt lds
    s_mov_b32 m0, 106496
    s_mov_b32 s66, 172032
    s_waitcnt vmcnt(22)
    buffer_load_dwordx4 v22, s[24:27], s66 offen offset:0 nt lds
    buffer_load_dwordx4 v22, s[24:27], s66 offen offset:1024 nt lds
    s_waitcnt vmcnt(22)
    buffer_load_dwordx4 v22, s[24:27], s66 offen offset:2048 nt lds
    buffer_load_dwordx4 v22, s[24:27], s66 offen offset:3072 nt lds
    s_mov_b32 m0, 110592
    s_mov_b32 s66, 176128
    s_waitcnt vmcnt(22)
    buffer_load_dwordx4 v22, s[24:27], s66 offen offset:0 nt lds
    buffer_load_dwordx4 v22, s[24:27], s66 offen offset:1024 nt lds
    s_waitcnt vmcnt(22)
    v_mov_b32 v8, 60
    ds_write_b32 v6, v8
    buffer_load_dwordx4 v22, s[24:27], s66 offen offset:2048 nt lds
    buffer_load_dwordx4 v22, s[24:27], s66 offen offset:3072 nt lds
    s_mov_b32 m0, 16384
    s_mov_b32 s66, 212992
    s_waitcnt vmcnt(22)
    buffer_load_dwordx4 v18, s[20:23], s66 offen offset:0 nt lds
    buffer_load_dwordx4 v19, s[20:23], s66 offen offset:1024 nt lds
    s_waitcnt vmcnt(22)
    buffer_load_dwordx4 v20, s[20:23], s66 offen offset:2048 nt lds
    buffer_load_dwordx4 v21, s[20:23], s66 offen offset:3072 nt lds
    s_mov_b32 m0, 20480
    s_mov_b32 s66, 217088
    s_waitcnt vmcnt(22)
    buffer_load_dwordx4 v18, s[20:23], s66 offen offset:0 nt lds
    buffer_load_dwordx4 v19, s[20:23], s66 offen offset:1024 nt lds
    s_waitcnt vmcnt(22)
    v_mov_b32 v8, 61
    ds_write_b32 v6, v8
    ds_read_b64_tr_b16 a[200:201], v232 offset:0
    ds_read_b64_tr_b16 a[202:203], v232 offset:2048
    ds_read_b64_tr_b16 a[204:205], v232 offset:8
    ds_read_b64_tr_b16 a[206:207], v232 offset:2056
    buffer_load_dwordx4 v20, s[20:23], s66 offen offset:2048 nt lds
    buffer_load_dwordx4 v21, s[20:23], s66 offen offset:3072 nt lds
    ds_read_b32 v9, v7
    s_mov_b32 m0, 24576
    s_mov_b32 s66, 221184
    s_waitcnt vmcnt(22)
    buffer_load_dwordx4 v18, s[20:23], s66 offen offset:0 nt lds
    buffer_load_dwordx4 v19, s[20:23], s66 offen offset:1024 nt lds
    s_waitcnt vmcnt(22)
    buffer_load_dwordx4 v20, s[20:23], s66 offen offset:2048 nt lds
    buffer_load_dwordx4 v21, s[20:23], s66 offen offset:3072 nt lds
    s_mov_b32 m0, 28672
    s_mov_b32 s66, 225280
    s_waitcnt vmcnt(22)
    buffer_load_dwordx4 v18, s[20:23], s66 offen offset:0 nt lds
    buffer_load_dwordx4 v19, s[20:23], s66 offen offset:1024 nt lds
    s_waitcnt vmcnt(22)
    v_mov_b32 v8, 62
    ds_write_b32 v6, v8
    buffer_load_dwordx4 v20, s[20:23], s66 offen offset:2048 nt lds
    buffer_load_dwordx4 v21, s[20:23], s66 offen offset:3072 nt lds
    s_waitcnt lgkmcnt(0)
    v_readlane_b32 s67, v9, 0
    v_readlane_b32 s76, v9, 1
    v_readlane_b32 s77, v9, 2
    s_min_u32 s67, s67, s76
    s_min_u32 s67, s67, s77
    s_cmp_ge_u32 s67, 14
    s_cbranch_scc0 L_lslow_31
L_lback_32:
    s_add_u32 s66, s63, 2
    s_and_b32 s66, s66, 3
    s_lshl_b32 s66, s66, 20
    s_add_u32 s66, s66, 65536
    s_mov_b32 m0, 139264
    s_waitcnt vmcnt(22)
    buffer_load_dwordx4 v24, s[36:39], s66 offen offset:0  lds
    buffer_load_dwordx4 v25, s[36:39], s66 offen offset:1024  lds
    s_waitcnt vmcnt(22)
    buffer_load_dwordx4 v26, s[36:39], s66 offen offset:2048  lds
    buffer_load_dwordx4 v27, s[36:39], s66 offen offset:3072  lds
    s_mov_b32 m0, 143360
    s_add_u32 s66, s66, 16384
    s_waitcnt vmcnt(22)
    buffer_load_dwordx4 v24, s[36:39], s66 offen offset:0  lds
    buffer_load_dwordx4 v25, s[36:39], s66 offen offset:1024  lds
    s_waitcnt vmcnt(22)
    v_mov_b32 v8, 63
    ds_write_b32 v6, v8
    buffer_load_dwordx4 v26, s[36:39], s66 offen offset:2048  lds
    buffer_load_dwordx4 v27, s[36:39], s66 offen offset:3072  lds
    s_mov_b32 m0, 114688
    s_mov_b32 s66, 180224
    s_waitcnt vmcnt(22)
    buffer_load_dwordx4 v22, s[24:27], s66 offen offset:0 nt lds
    buffer_load_dwordx4 v22, s[24:27], s66 offen offset:1024 nt lds
    s_waitcnt vmcnt(22)
    buffer_load_dwordx4 v22, s[24:27], s66 offen offset:2048 nt lds
    buffer_load_dwordx4 v22, s[24:27], s66 offen offset:3072 nt lds
    s_mov_b32 m0, 118784
    s_mov_b32 s66, 184320
    s_waitcnt vmcnt(22)
    buffer_load_dwordx4 v22, s[24:27], s66 offen offset:0 nt lds
    buffer_load_dwordx4 v22, s[24:27], s66 offen offset:1024 nt lds
    s_waitcnt vmcnt(22)
    v_mov_b32 v8, 64
    ds_write_b32 v6, v8
    buffer_load_dwordx4 v22, s[24:27], s66 offen offset:2048 nt lds
    buffer_load_dwordx4 v22, s[24:27], s66 offen offset:3072 nt lds
    s_mov_b32 m0, 122880
    s_mov_b32 s66, 188416
    s_waitcnt vmcnt(22)
    buffer_load_dwordx4 v22, s[24:27], s66 offen offset:0 nt lds
    buffer_load_dwordx4 v22, s[24:27], s66 offen offset:1024 nt lds
    s_waitcnt vmcnt(22)
    buffer_load_dwordx4 v22, s[24:27], s66 offen offset:2048 nt lds
    buffer_load_dwordx4 v22, s[24:27], s66 offen offset:3072 nt lds
    s_mov_b32 m0, 126976
    s_mov_b32 s66, 192512
    s_waitcnt vmcnt(22)
    buffer_load_dwordx4 v22, s[24:27], s66 offen offset:0 nt lds
    buffer_load_dwordx4 v22, s[24:27], s66 offen offset:1024 nt lds
    s_waitcnt vmcnt(22)
    v_mov_b32 v8, 65
    ds_write_b32 v6, v8
    buffer_load_dwordx4 v22, s[24:27], s66 offen offset:2048 nt lds
    buffer_load_dwordx4 v22, s[24:27], s66 offen offset:3072 nt lds
    s_mov_b32 m0, 32768
    s_mov_b32 s66, 229376
    s_waitcnt vmcnt(22)
    buffer_load_dwordx4 v18, s[20:23], s66 offen offset:0 nt lds
    buffer_load_dwordx4 v19, s[20:23], s66 offen offset:1024 nt lds
    s_waitcnt vmcnt(22)
    buffer_load_dwordx4 v20, s[20:23], s66 offen offset:2048 nt lds
    buffer_load_dwordx4 v21, s[20:23], s66 offen offset:3072 nt lds
    s_mov_b32 m0, 36864
    s_mov_b32 s66, 233472
    s_waitcnt vmcnt(22)
    buffer_load_dwordx4 v18, s[20:23], s66 offen offset:0 nt lds
    buffer_load_dwordx4 v19, s[20:23], s66 offen offset:1024 nt lds
    s_waitcnt vmcnt(22)
    v_mov_b32 v8, 66
    ds_write_b32 v6, v8
    ds_read_b64_tr_b16 a[208:209], v232 offset:8192
    ds_read_b64_tr_b16 a[210:211], v232 offset:10240
    ds_read_b64_tr_b16 a[212:213], v232 offset:8200
    ds_read_b64_tr_b16 a[214:215], v232 offset:10248
    buffer_load_dwordx4 v20, s[20:23], s66 offen offset:2048 nt lds
    buffer_load_dwordx4 v21, s[20:23], s66 offen offset:3072 nt lds
    ds_read_b32 v9, v7
    s_mov_b32 m0, 40960
    s_mov_b32 s66, 237568
    s_waitcnt vmcnt(22)
    buffer_load_dwordx4 v18, s[20:23], s66 offen offset:0 nt lds
    buffer_load_dwordx4 v19, s[20:23], s66 offen offset:1024 nt lds
    s_waitcnt vmcnt(22)
    buffer_load_dwordx4 v20, s[20:23], s66 offen offset:2048 nt lds
    buffer_load_dwordx4 v21, s[20:23], s66 offen offset:3072 nt lds
    s_mov_b32 m0, 45056
    s_mov_b32 s66, 241664
    s_waitcnt vmcnt(22)
    buffer_load_dwordx4 v18, s[20:23], s66 offen offset:0 nt lds
    buffer_load_dwordx4 v19, s[20:23], s66 offen offset:1024 nt lds
    s_waitcnt vmcnt(22)
    v_mov_b32 v8, 67
    ds_write_b32 v6, v8
    buffer_load_dwordx4 v20, s[20:23], s66 offen offset:2048 nt lds
    buffer_load_dwordx4 v21, s[20:23], s66 offen offset:3072 nt lds
    s_waitcnt lgkmcnt(0)
    v_readlane_b32 s67, v9, 0
    v_readlane_b32 s76, v9, 1
    v_readlane_b32 s77, v9, 2
    s_min_u32 s67, s67, s76
    s_min_u32 s67, s67, s77
    s_cmp_ge_u32 s67, 15
    s_cbranch_scc0 L_lslow_33
L_lback_34:
    s_add_u32 s66, s63, 2
    s_and_b32 s66, s66, 3
    s_lshl_b32 s66, s66, 20
    s_add_u32 s66, s66, 98304
    s_mov_b32 m0, 147456
    s_waitcnt vmcnt(22)
    buffer_load_dwordx4 v24, s[36:39], s66 offen offset:0  lds
    buffer_load_dwordx4 v25, s[36:39], s66 offen offset:1024  lds
    s_waitcnt vmcnt(22)
    buffer_load_dwordx4 v26, s[36:39], s66 offen offset:2048  lds
    buffer_load_dwordx4 v27, s[36:39], s66 offen offset:3072  lds
    s_mov_b32 m0, 151552
    s_add_u32 s66, s66, 16384
    s_waitcnt vmcnt(22)
    buffer_load_dwordx4 v24, s[36:39], s66 offen offset:0  lds
    buffer_load_dwordx4 v25, s[36:39], s66 offen offset:1024  lds
    s_waitcnt vmcnt(22)
    v_mov_b32 v8, 68
    ds_write_b32 v6, v8
    buffer_load_dwordx4 v26, s[36:39], s66 offen offset:2048  lds
    buffer_load_dwordx4 v27, s[36:39], s66 offen offset:3072  lds
    s_mov_b32 m0, 65536
    s_mov_b32 s66, 196608
    s_waitcnt vmcnt(22)
    buffer_load_dwordx4 v22, s[24:27], s66 offen offset:0 nt lds
    buffer_load_dwordx4 v22, s[24:27], s66 offen offset:1024 nt lds
    s_waitcnt vmcnt(22)
    buffer_load_dwordx4 v22, s[24:27], s66 offen offset:2048 nt lds
    buffer_load_dwordx4 v22, s[24:27], s66 offen offset:3072 nt lds
    s_mov_b32 m0, 69632
    s_mov_b32 s66, 200704
    s_waitcnt vmcnt(22)
    buffer_load_dwordx4 v22, s[24:27], s66 offen offset:0 nt lds
    buffer_load_dwordx4 v22, s[24:27], s66 offen offset:1024 nt lds
    s_waitcnt vmcnt(22)
    v_mov_b32 v8, 69
    ds_write_b32 v6, v8
    buffer_load_dwordx4 v22, s[24:27], s66 offen offset:2048 nt lds
    buffer_load_dwordx4 v22, s[24:27], s66 offen offset:3072 nt lds
    s_mov_b32 m0, 73728
    s_mov_b32 s66, 204800
    s_waitcnt vmcnt(22)
    buffer_load_dwordx4 v22, s[24:27], s66 offen offset:0 nt lds
    buffer_load_dwordx4 v22, s[24:27], s66 offen offset:1024 nt lds
    s_waitcnt vmcnt(22)
    buffer_load_dwordx4 v22, s[24:27], s66 offen offset:2048 nt lds
    buffer_load_dwordx4 v22, s[24:27], s66 offen offset:3072 nt lds
    s_mov_b32 m0, 77824
    s_mov_b32 s66, 208896
    s_waitcnt vmcnt(22)
    buffer_load_dwordx4 v22, s[24:27], s66 offen offset:0 nt lds
    buffer_load_dwordx4 v22, s[24:27], s66 offen offset:1024 nt lds
    s_waitcnt vmcnt(22)
    v_mov_b32 v8, 70
    ds_write_b32 v6, v8
    buffer_load_dwordx4 v22, s[24:27], s66 offen offset:2048 nt lds
    buffer_load_dwordx4 v22, s[24:27], s66 offen offset:3072 nt lds
    s_mov_b32 m0, 49152
    s_mov_b32 s66, 245760
    s_waitcnt vmcnt(22)
    buffer_load_dwordx4 v18, s[20:23], s66 offen offset:0 nt lds
    buffer_load_dwordx4 v19, s[20:23], s66 offen offset:1024 nt lds
    s_waitcnt vmcnt(22)
    buffer_load_dwordx4 v20, s[20:23], s66 offen offset:2048 nt lds
    buffer_load_dwordx4 v21, s[20:23], s66 offen offset:3072 nt lds
    s_mov_b32 m0, 53248
    s_mov_b32 s66, 249856
    s_waitcnt vmcnt(22)
    buffer_load_dwordx4 v18, s[20:23], s66 offen offset:0 nt lds
    buffer_load_dwordx4 v19, s[20:23], s66 offen offset:1024 nt lds
    s_waitcnt vmcnt(22)
    v_mov_b32 v8, 71
    ds_write_b32 v6, v8
    ds_read_b64_tr_b16 a[216:217], v232 offset:16384
    ds_read_b64_tr_b16 a[218:219], v232 offset:18432
    ds_read_b64_tr_b16 a[220:221], v232 offset:16392
    ds_read_b64_tr_b16 a[222:223], v232 offset:18440
    buffer_load_dwordx4 v20, s[20:23], s66 offen offset:2048 nt lds
    buffer_load_dwordx4 v21, s[20:23], s66 offen offset:3072 nt lds
    ds_read_b32 v9, v7
    s_mov_b32 m0, 57344
    s_mov_b32 s66, 253952
    s_waitcnt vmcnt(22)
    buffer_load_dwordx4 v18, s[20:23], s66 offen offset:0 nt lds
    buffer_load_dwordx4 v19, s[20:23], s66 offen offset:1024 nt lds
    s_waitcnt vmcnt(22)
    buffer_load_dwordx4 v20, s[20:23], s66 offen offset:2048 nt lds
    buffer_load_dwordx4 v21, s[20:23], s66 offen offset:3072 nt lds
    s_mov_b32 m0, 61440
    s_mov_b32 s66, 258048
    s_waitcnt vmcnt(22)
    buffer_load_dwordx4 v18, s[20:23], s66 offen offset:0 nt lds
    buffer_load_dwordx4 v19, s[20:23], s66 offen offset:1024 nt lds
    s_waitcnt vmcnt(22)
    v_mov_b32 v8, 72
    ds_write_b32 v6, v8
    buffer_load_dwordx4 v20, s[20:23], s66 offen offset:2048 nt lds
    buffer_load_dwordx4 v21, s[20:23], s66 offen offset:3072 nt lds
    s_waitcnt lgkmcnt(0)
    v_readlane_b32 s67, v9, 0
    v_readlane_b32 s76, v9, 1
    v_readlane_b32 s77, v9, 2
    s_min_u32 s67, s67, s76
    s_min_u32 s67, s67, s77
    s_cmp_ge_u32 s67, 16
    s_cbranch_scc0 L_lslow_35
L_lback_36:
    s_add_u32 s66, s63, 3
    s_and_b32 s66, s66, 3
    s_lshl_b32 s66, s66, 20
    s_mov_b32 m0, 131072
    s_waitcnt vmcnt(30)
    buffer_load_dwordx4 v24, s[36:39], s66 offen offset:0  lds
    buffer_load_dwordx4 v25, s[36:39], s66 offen offset:1024  lds
    s_waitcnt vmcnt(30)
    buffer_load_dwordx4 v26, s[36:39], s66 offen offset:2048  lds
    buffer_load_dwordx4 v27, s[36:39], s66 offen offset:3072  lds
    s_mov_b32 m0, 135168
    s_add_u32 s66, s66, 16384
    s_waitcnt vmcnt(30)
    buffer_load_dwordx4 v24, s[36:39], s66 offen offset:0  lds
    buffer_load_dwordx4 v25, s[36:39], s66 offen offset:1024  lds
    s_waitcnt vmcnt(30)
    buffer_load_dwordx4 v26, s[36:39], s66 offen offset:2048  lds
    buffer_load_dwordx4 v27, s[36:39], s66 offen offset:3072  lds
    s_mov_b32 m0, 81920
    s_mov_b32 s66, 212992
    s_waitcnt vmcnt(30)
    buffer_load_dwordx4 v22, s[24:27], s66 offen offset:0 nt lds
    buffer_load_dwordx4 v22, s[24:27], s66 offen offset:1024 nt lds
    s_waitcnt vmcnt(30)
    buffer_load_dwordx4 v22, s[24:27], s66 offen offset:2048 nt lds
    buffer_load_dwordx4 v22, s[24:27], s66 offen offset:3072 nt lds
    s_mov_b32 m0, 86016
    s_mov_b32 s66, 217088
    s_waitcnt vmcnt(30)
    buffer_load_dwordx4 v22, s[24:27], s66 offen offset:0 nt lds
    buffer_load_dwordx4 v22, s[24:27], s66 offen offset:1024 nt lds
    s_waitcnt vmcnt(30)
    v_mov_b32 v8, 73
    ds_write_b32 v6, v8
    buffer_load_dwordx4 v22, s[24:27], s66 offen offset:2048 nt lds
    buffer_load_dwordx4 v22, s[24:27], s66 offen offset:3072 nt lds
    ds_read_b32 v9, v7
    s_mov_b32 m0, 90112
    s_mov_b32 s66, 221184
    s_waitcnt vmcnt(30)
    buffer_load_dwordx4 v22, s[24:27], s66 offen offset:0 nt lds
    buffer_load_dwordx4 v22, s[24:27], s66 offen offset:1024 nt lds
    s_waitcnt vmcnt(30)
    buffer_load_dwordx4 v22, s[24:27], s66 offen offset:2048 nt lds
    buffer_load_dwordx4 v22, s[24:27], s66 offen offset:3072 nt lds
    s_mov_b32 m0, 94208
    s_mov_b32 s66, 225280
    s_waitcnt vmcnt(30)
    buffer_load_dwordx4 v22, s[24:27], s66 offen offset:0 nt lds
    buffer_load_dwordx4 v22, s[24:27], s66 offen offset:1024 nt lds
    s_waitcnt vmcnt(30)
    v_mov_b32 v8, 74
    ds_write_b32 v6, v8
    buffer_load_dwordx4 v22, s[24:27], s66 offen offset:2048 nt lds
    buffer_load_dwordx4 v22, s[24:27], s66 offen offset:3072 nt lds
    s_waitcnt lgkmcnt(0)
    v_readlane_b32 s67, v9, 0
    v_readlane_b32 s76, v9, 1
    v_readlane_b32 s77, v9, 2
    s_min_u32 s67, s67, s76
    s_min_u32 s67, s67, s77
    s_cmp_ge_u32 s67, 17
    s_cbranch_scc0 L_lslow_37
L_lback_38:
    s_add_u32 s66, s63, 3
    s_and_b32 s66, s66, 3
    s_lshl_b32 s66, s66, 20
    s_add_u32 s66, s66, 32768
    s_mov_b32 m0, 139264
    s_waitcnt vmcnt(30)
    buffer_load_dwordx4 v24, s[36:39], s66 offen offset:0  lds
    buffer_load_dwordx4 v25, s[36:39], s66 offen offset:1024  lds
    s_waitcnt vmcnt(30)
    buffer_load_dwordx4 v26, s[36:39], s66 offen offset:2048  lds
    buffer_load_dwordx4 v27, s[36:39], s66 offen offset:3072  lds
    s_mov_b32 m0, 143360
    s_add_u32 s66, s66, 16384
    s_waitcnt vmcnt(30)
    buffer_load_dwordx4 v24, s[36:39], s66 offen offset:0  lds
    buffer_load_dwordx4 v25, s[36:39], s66 offen offset:1024  lds
    s_waitcnt vmcnt(30)
    v_mov_b32 v8, 75
    ds_write_b32 v6, v8
    buffer_load_dwordx4 v26, s[36:39], s66 offen offset:2048  lds
    buffer_load_dwordx4 v27, s[36:39], s66 offen offset:3072  lds
    s_mov_b32 m0, 98304
    s_mov_b32 s66, 229376
    s_waitcnt vmcnt(30)
    buffer_load_dwordx4 v22, s[24:27], s66 offen offset:0 nt lds
    buffer_load_dwordx4 v22, s[24:27], s66 offen offset:1024 nt lds
    s_waitcnt vmcnt(30)
    buffer_load_dwordx4 v22, s[24:27], s66 offen offset:2048 nt lds
    buffer_load_dwordx4 v22, s[24:27], s66 offen offset:3072 nt lds
    s_mov_b32 m0, 102400
    s_mov_b32 s66, 233472
    s_waitcnt vmcnt(30)
    buffer_load_dwordx4 v22, s[24:27], s66 offen offset:0 nt lds
    buffer_load_dwordx4 v22, s[24:27], s66 offen offset:1024 nt lds
    s_waitcnt vmcnt(30)
    v_mov_b32 v8, 76
    ds_write_b32 v6, v8
    ds_read_b64_tr_b16 a[224:225], v232 offset:0
    ds_read_b64_tr_b16 a[226:227], v232 offset:2048
    ds_read_b64_tr_b16 a[228:229], v232 offset:8
    ds_read_b64_tr_b16 a[230:231], v232 offset:2056
    buffer_load_dwordx4 v22, s[24:27], s66 offen offset:2048 nt lds
    buffer_load_dwordx4 v22, s[24:27], s66 offen offset:3072 nt lds
    ds_read_b32 v9, v7
    s_mov_b32 m0, 106496
    s_mov_b32 s66, 237568
    s_waitcnt vmcnt(30)
    buffer_load_dwordx4 v22, s[24:27], s66 offen offset:0 nt lds
    buffer_load_dwordx4 v22, s[24:27], s66 offen offset:1024 nt lds
    s_waitcnt vmcnt(30)
    buffer_load_dwordx4 v22, s[24:27], s66 offen offset:2048 nt lds
    buffer_load_dwordx4 v22, s[24:27], s66 offen offset:3072 nt lds
    s_mov_b32 m0, 110592
    s_mov_b32 s66, 241664
    s_waitcnt vmcnt(30)
    buffer_load_dwordx4 v22, s[24:27], s66 offen offset:0 nt lds
    buffer_load_dwordx4 v22, s[24:27], s66 offen offset:1024 nt lds
    s_waitcnt vmcnt(30)
    v_mov_b32 v8, 77
    ds_write_b32 v6, v8
    buffer_load_dwordx4 v22, s[24:27], s66 offen offset:2048 nt lds
    buffer_load_dwordx4 v22, s[24:27], s66 offen offset:3072 nt lds
    s_waitcnt lgkmcnt(0)
    v_readlane_b32 s67, v9, 0
    v_readlane_b32 s76, v9, 1
    v_readlane_b32 s77, v9, 2
    s_min_u32 s67, s67, s76
    s_min_u32 s67, s67, s77
    s_cmp_ge_u32 s67, 18
    s_cbranch_scc0 L_lslow_39
L_lback_40:
    s_add_u32 s66, s63, 3
    s_and_b32 s66, s66, 3
    s_lshl_b32 s66, s66, 20
    s_add_u32 s66, s66, 65536
    s_mov_b32 m0, 147456
    s_waitcnt vmcnt(30)
    buffer_load_dwordx4 v24, s[36:39], s66 offen offset:0  lds
    buffer_load_dwordx4 v25, s[36:39], s66 offen offset:1024  lds
    s_waitcnt vmcnt(30)
    buffer_load_dwordx4 v26, s[36:39], s66 offen offset:2048  lds
    buffer_load_dwordx4 v27, s[36:39], s66 offen offset:3072  lds
    s_mov_b32 m0, 151552
    s_add_u32 s66, s66, 16384
    s_waitcnt vmcnt(30)
    buffer_load_dwordx4 v24, s[36:39], s66 offen offset:0  lds
    buffer_load_dwordx4 v25, s[36:39], s66 offen offset:1024  lds
    s_waitcnt vmcnt(30)
    v_mov_b32 v8, 78
    ds_write_b32 v6, v8
    buffer_load_dwordx4 v26, s[36:39], s66 offen offset:2048  lds
    buffer_load_dwordx4 v27, s[36:39], s66 offen offset:3072  lds
    v_and_b32 v2, 7, v0
    v_bfe_u32 v3, v0, 4, 1
    v_lshlrev_b32 v3, 2, v3
    v_xor_b32 v2, v2, v3
    v_lshlrev_b32 v2, 4, v2
    v_lshrrev_b32 v3, 3, v0
    v_lshl_add_u32 v23, v3, 8, v2
    s_mov_b32 m0, 114688
    s_mov_b32 s66, 245760
    s_waitcnt vmcnt(30)
    buffer_load_dwordx4 v23, s[24:27], s66 offen nt lds
    s_mov_b32 m0, 115712
    s_mov_b32 s66, 247808
    buffer_load_dwordx4 v23, s[24:27], s66 offen nt lds
    s_mov_b32 m0, 116736
    s_mov_b32 s66, 249856
    s_waitcnt vmcnt(30)
    buffer_load_dwordx4 v23, s[24:27], s66 offen nt lds
    s_mov_b32 m0, 117760
    s_mov_b32 s66, 251904
    buffer_load_dwordx4 v23, s[24:27], s66 offen nt lds
    s_mov_b32 m0, 118784
    s_mov_b32 s66, 253952
    s_waitcnt vmcnt(30)
    buffer_load_dwordx4 v23, s[24:27], s66 offen nt lds
    s_mov_b32 m0, 119808
    s_mov_b32 s66, 256000
    buffer_load_dwordx4 v23, s[24:27], s66 offen nt lds
    s_mov_b32 m0, 120832
    s_mov_b32 s66, 258048
    s_waitcnt vmcnt(30)
    ds_read_b64_tr_b16 a[232:233], v232 offset:8192
    ds_read_b64_tr_b16 a[234:235], v232 offset:10240
    ds_read_b64_tr_b16 a[236:237], v232 offset:8200
    ds_read_b64_tr_b16 a[238:239], v232 offset:10248
    buffer_load_dwordx4 v23, s[24:27], s66 offen nt lds
    s_mov_b32 m0, 121856
    s_mov_b32 s66, 260096
    buffer_load_dwordx4 v23, s[24:27], s66 offen nt lds
    s_mov_b32 m0, 122880
    s_mov_b32 s66, 245888
    s_waitcnt vmcnt(30)
    buffer_load_dwordx4 v23, s[24:27], s66 offen nt lds
    s_mov_b32 m0, 123904
    s_mov_b32 s66, 247936
    buffer_load_dwordx4 v23, s[24:27], s66 offen nt lds
    s_mov_b32 m0, 124928
    s_mov_b32 s66, 249984
    s_waitcnt vmcnt(30)
    buffer_load_dwordx4 v23, s[24:27], s66 offen nt lds
    s_mov_b32 m0, 125952
    s_mov_b32 s66, 252032
    buffer_load_dwordx4 v23, s[24:27], s66 offen nt lds
    s_mov_b32 m0, 126976
    s_mov_b32 s66, 254080
    s_waitcnt vmcnt(30)
    buffer_load_dwordx4 v23, s[24:27], s66 offen nt lds
    s_mov_b32 m0, 128000
    s_mov_b32 s66, 256128
    buffer_load_dwordx4 v23, s[24:27], s66 offen nt lds
    s_mov_b32 m0, 129024
    s_mov_b32 s66, 258176
    s_waitcnt vmcnt(30)
    v_mov_b32 v8, 82
    ds_write_b32 v6, v8
    buffer_load_dwordx4 v23, s[24:27], s66 offen nt lds
    s_mov_b32 m0, 130048
    s_mov_b32 s66, 260224
    buffer_load_dwordx4 v23, s[24:27], s66 offen nt lds
    s_waitcnt vmcnt(24)
    v_mov_b32 v8, 83
    ds_write_b32 v6, v8
    ds_read_b32 v9, v7
    s_waitcnt lgkmcnt(0)
    v_readlane_b32 s67, v9, 0
    v_readlane_b32 s76, v9, 1
    v_readlane_b32 s77, v9, 2
    s_min_u32 s67, s67, s76
    s_min_u32 s67, s67, s77
    s_cmp_ge_u32 s67, 19
    s_cbranch_scc0 L_lslow_41
L_lback_42:
    s_add_u32 s66, s63, 3
    s_and_b32 s66, s66, 3
    s_lshl_b32 s66, s66, 20
    s_add_u32 s66, s66, 98304
    s_mov_b32 m0, 131072
    s_waitcnt vmcnt(32)
    buffer_load_dwordx4 v24, s[36:39], s66 offen offset:0  lds
    buffer_load_dwordx4 v25, s[36:39], s66 offen offset:1024  lds
    s_waitcnt vmcnt(32)
    buffer_load_dwordx4 v26, s[36:39], s66 offen offset:2048  lds
    buffer_load_dwordx4 v27, s[36:39], s66 offen offset:3072  lds
    s_mov_b32 m0, 135168
    s_add_u32 s66, s66, 16384
    s_waitcnt vmcnt(32)
    buffer_load_dwordx4 v24, s[36:39], s66 offen offset:0  lds
    buffer_load_dwordx4 v25, s[36:39], s66 offen offset:1024  lds
    s_waitcnt vmcnt(32)
    buffer_load_dwordx4 v26, s[36:39], s66 offen offset:2048  lds
    buffer_load_dwordx4 v27, s[36:39], s66 offen offset:3072  lds
    s_lshl_b32 s66, s63, 3
    s_lshl_b32 s67, s60, 12
    v_add_u32 v2, s66, v0
    v_lshlrev_b32 v2, 7, v2
    v_add_u32 v2, 4, v2
    v_and_b32 v3, 3, v0
    v_lshl_add_u32 v3, v3, 3, s62
    v_lshlrev_b32 v3, 7, v3
    v_cmp_gt_u32 vcc, 8, v0
    s_nop 1
    v_cndmask_b32 v3, v3, v2, vcc
    buffer_load_dword v233, v3, s[48:51], s67 offen offset:64 sc1
    s_mov_b32 s10, 0
    s_mov_b32 s11, 0
    s_mov_b32 s74, 1
    s_mul_i32 s66, s2, 24576
    s_waitcnt vmcnt(32)
    buffer_load_dwordx4 v[60:63], v250, s[40:43], s66 offen offset:0
    buffer_load_dwordx4 v[56:59], v250, s[40:43], s66 offen offset:1024
    s_waitcnt vmcnt(32)
    buffer_load_dwordx4 v[60:63], v250, s[40:43], s66 offen offset:2048
    buffer_load_dwordx4 v[56:59], v250, s[40:43], s66 offen offset:3072
    s_add_u32 s66, s66, 4096
    s_waitcnt vmcnt(32)
    buffer_load_dwordx4 v[60:63], v250, s[40:43], s66 offen offset:0
    buffer_load_dwordx4 v[56:59], v250, s[40:43], s66 offen offset:1024
    s_waitcnt vmcnt(32)
    buffer_load_dwordx4 v[60:63], v250, s[40:43], s66 offen offset:2048
    buffer_load_dwordx4 v[56:59], v250, s[40:43], s66 offen offset:3072
    s_mul_i32 s66, s2, 24576
    s_add_u32 s66, s66, 8192
    s_waitcnt vmcnt(32)
    ds_read_b64_tr_b16 a[240:241], v232 offset:16384
    ds_read_b64_tr_b16 a[242:243], v232 offset:18432
    ds_read_b64_tr_b16 a[244:245], v232 offset:16392
    ds_read_b64_tr_b16 a[246:247], v232 offset:18440
    buffer_load_dwordx4 v[60:63], v250, s[40:43], s66 offen offset:0
    buffer_load_dwordx4 v[56:59], v250, s[40:43], s66 offen offset:1024
    s_waitcnt vmcnt(32)
    buffer_load_dwordx4 v[60:63], v250, s[40:43], s66 offen offset:2048
    buffer_load_dwordx4 v[56:59], v250, s[40:43], s66 offen offset:3072
    s_add_u32 s66, s66, 4096
    s_waitcnt vmcnt(32)
    buffer_load_dwordx4 v[60:63], v250, s[40:43], s66 offen offset:0
    buffer_load_dwordx4 v[56:59], v250, s[40:43], s66 offen offset:1024
    s_waitcnt vmcnt(32)
    buffer_load_dwordx4 v[60:63], v250, s[40:43], s66 offen offset:2048
    buffer_load_dwordx4 v[56:59], v250, s[40:43], s66 offen offset:3072
    s_mul_i32 s66, s2, 24576
    s_add_u32 s66, s66, 16384
    s_waitcnt vmcnt(32)
    v_mov_b32 v8, 87
    ds_write_b32 v6, v8
    buffer_load_dwordx4 v[60:63], v250, s[40:43], s66 offen offset:0
    buffer_load_dwordx4 v[56:59], v250, s[40:43], s66 offen offset:1024
    s_waitcnt vmcnt(32)
    buffer_load_dwordx4 v[60:63], v250, s[40:43], s66 offen offset:2048
    buffer_load_dwordx4 v[56:59], v250, s[40:43], s66 offen offset:3072
    s_add_u32 s66, s66, 4096
    s_waitcnt vmcnt(32)
    buffer_load_dwordx4 v[60:63], v250, s[40:43], s66 offen offset:0
    buffer_load_dwordx4 v[56:59], v250, s[40:43], s66 offen offset:1024
    s_waitcnt vmcnt(32)
    buffer_load_dwordx4 v[60:63], v250, s[40:43], s66 offen offset:2048
    buffer_load_dwordx4 v[56:59], v250, s[40:43], s66 offen offset:3072
    s_waitcnt vmcnt(33)
    v_mov_b32 v8, 90
    ds_write_b32 v6, v8
    s_waitcnt vmcnt(24)
    v_readlane_b32 s22, v233, s62
    s_nop 0
    s_mul_i32 s23, s22, -8
    s_branch L_tail
L_lslow_1:
    s_mov_b32 s74, 4194304
L_sp_43:
    ds_read_b32 v9, v7
    s_waitcnt lgkmcnt(0)
    v_readlane_b32 s67, v9, 0
    v_readlane_b32 s76, v9, 1
    v_readlane_b32 s77, v9, 2
    s_min_u32 s67, s67, s76
    s_min_u32 s67, s67, s77
    s_cmp_ge_u32 s67, 1
    s_cbranch_scc1 L_lback_2
    s_sub_u32 s74, s74, 1
    s_cmp_eq_u32 s74, 0
    s_cbranch_scc0 L_sp_43
    s_branch L_lback_2
L_lslow_3:
    s_mov_b32 s74, 4194304
L_sp_44:
    ds_read_b32 v9, v7
    s_waitcnt lgkmcnt(0)
    v_readlane_b32 s67, v9, 0
    v_readlane_b32 s76, v9, 1
    v_readlane_b32 s77, v9, 2
    s_min_u32 s67, s67, s76
    s_min_u32 s67, s67, s77
    s_cmp_ge_u32 s67, 2
    s_cbranch_scc1 L_lback_4
    s_sub_u32 s74, s74, 1
    s_cmp_eq_u32 s74, 0
    s_cbranch_scc0 L_sp_44
    s_branch L_lback_4
L_lslow_5:
    s_mov_b32 s74, 4194304
L_sp_45:
    ds_read_b32 v9, v7
    s_waitcnt lgkmcnt(0)
    v_readlane_b32 s67, v9, 0
    v_readlane_b32 s76, v9, 1
    v_readlane_b32 s77, v9, 2
    s_min_u32 s67, s67, s76
    s_min_u32 s67, s67, s77
    s_cmp_ge_u32 s67, 3
    s_cbranch_scc1 L_lback_6
    s_sub_u32 s74, s74, 1
    s_cmp_eq_u32 s74, 0
    s_cbranch_scc0 L_sp_45
    s_branch L_lback_6
L_lslow_7:
    s_mov_b32 s74, 4194304
L_sp_46:
    ds_read_b32 v9, v7
    s_waitcnt lgkmcnt(0)
    v_readlane_b32 s67, v9, 0
    v_readlane_b32 s76, v9, 1
    v_readlane_b32 s77, v9, 2
    s_min_u32 s67, s67, s76
    s_min_u32 s67, s67, s77
    s_cmp_ge_u32 s67, 1
    s_cbranch_scc1 L_lback_8
    s_sub_u32 s74, s74, 1
    s_cmp_eq_u32 s74, 0
    s_cbranch_scc0 L_sp_46
    s_branch L_lback_8
L_lslow_9:
    s_mov_b32 s74, 4194304
L_sp_47:
    ds_read_b32 v9, v7
    s_waitcnt lgkmcnt(0)
    v_readlane_b32 s67, v9, 0
    v_readlane_b32 s76, v9, 1
    v_readlane_b32 s77, v9, 2
    s_min_u32 s67, s67, s76
    s_min_u32 s67, s67, s77
    s_cmp_ge_u32 s67, 2
    s_cbranch_scc1 L_lback_10
    s_sub_u32 s74, s74, 1
    s_cmp_eq_u32 s74, 0
    s_cbranch_scc0 L_sp_47
    s_branch L_lback_10
L_lslow_11:
    s_mov_b32 s74, 4194304
L_sp_48:
    ds_read_b32 v9, v7
    s_waitcnt lgkmcnt(0)
    v_readlane_b32 s67, v9, 0
    v_readlane_b32 s76, v9, 1
    v_readlane_b32 s77, v9, 2
    s_min_u32 s67, s67, s76
    s_min_u32 s67, s67, s77
    s_cmp_ge_u32 s67, 3
    s_cbranch_scc1 L_lback_12
    s_sub_u32 s74, s74, 1
    s_cmp_eq_u32 s74, 0
    s_cbranch_scc0 L_sp_48
    s_branch L_lback_12
L_lslow_13:
    s_mov_b32 s74, 4194304
L_sp_49:
    ds_read_b32 v9, v7
    s_waitcnt lgkmcnt(0)
    v_readlane_b32 s67, v9, 0
    v_readlane_b32 s76, v9, 1
    v_readlane_b32 s77, v9, 2
    s_min_u32 s67, s67, s76
    s_min_u32 s67, s67, s77
    s_cmp_ge_u32 s67, 5
    s_cbranch_scc1 L_lback_14
    s_sub_u32 s74, s74, 1
    s_cmp_eq_u32 s74, 0
    s_cbranch_scc0 L_sp_49
    s_branch L_lback_14
L_lslow_15:
    s_mov_b32 s74, 4194304
L_sp_50:
    ds_read_b32 v9, v7
    s_waitcnt lgkmcnt(0)
    v_readlane_b32 s67, v9, 0
    v_readlane_b32 s76, v9, 1
    v_readlane_b32 s77, v9, 2
    s_min_u32 s67, s67, s76
    s_min_u32 s67, s67, s77
    s_cmp_ge_u32 s67, 6
    s_cbranch_scc1 L_lback_16
    s_sub_u32 s74, s74, 1
    s_cmp_eq_u32 s74, 0
    s_cbranch_scc0 L_sp_50
    s_branch L_lback_16
L_lslow_17:
    s_mov_b32 s74, 4194304
L_sp_51:
    ds_read_b32 v9, v7
    s_waitcnt lgkmcnt(0)
    v_readlane_b32 s67, v9, 0
    v_readlane_b32 s76, v9, 1
    v_readlane_b32 s77, v9, 2
    s_min_u32 s67, s67, s76
    s_min_u32 s67, s67, s77
    s_cmp_ge_u32 s67, 7
    s_cbranch_scc1 L_lback_18
    s_sub_u32 s74, s74, 1
    s_cmp_eq_u32 s74, 0
    s_cbranch_scc0 L_sp_51
    s_branch L_lback_18
L_lslow_19:
    s_mov_b32 s74, 4194304
L_sp_52:
    ds_read_b32 v9, v7
    s_waitcnt lgkmcnt(0)
    v_readlane_b32 s67, v9, 0
    v_readlane_b32 s76, v9, 1
    v_readlane_b32 s77, v9, 2
    s_min_u32 s67, s67, s76
    s_min_u32 s67, s67, s77
    s_cmp_ge_u32 s67, 8
    s_cbranch_scc1 L_lback_20
    s_sub_u32 s74, s74, 1
    s_cmp_eq_u32 s74, 0
    s_cbranch_scc0 L_sp_52
    s_branch L_lback_20
L_lslow_21:
    s_mov_b32 s74, 4194304
L_sp_53:
    ds_read_b32 v9, v7
    s_waitcnt lgkmcnt(0)
    v_readlane_b32 s67, v9, 0
    v_readlane_b32 s76, v9, 1
    v_readlane_b32 s77, v9, 2
    s_min_u32 s67, s67, s76
    s_min_u32 s67, s67, s77
    s_cmp_ge_u32 s67, 9
    s_cbranch_scc1 L_lback_22
    s_sub_u32 s74, s74, 1
    s_cmp_eq_u32 s74, 0
    s_cbranch_scc0 L_sp_53
    s_branch L_lback_22
L_lslow_23:
    s_mov_b32 s74, 4194304
L_sp_54:
    ds_read_b32 v9, v7
    s_waitcnt lgkmcnt(0)
    v_readlane_b32 s67, v9, 0
    v_readlane_b32 s76, v9, 1
    v_readlane_b32 s77, v9, 2
    s_min_u32 s67, s67, s76
    s_min_u32 s67, s67, s77
    s_cmp_ge_u32 s67, 10
    s_cbranch_scc1 L_lback_24
    s_sub_u32 s74, s74, 1
    s_cmp_eq_u32 s74, 0
    s_cbranch_scc0 L_sp_54
    s_branch L_lback_24
L_lslow_25:
    s_mov_b32 s74, 4194304
L_sp_55:
    ds_read_b32 v9, v7
    s_waitcnt lgkmcnt(0)
    v_readlane_b32 s67, v9, 0
    v_readlane_b32 s76, v9, 1
    v_readlane_b32 s77, v9, 2
    s_min_u32 s67, s67, s76
    s_min_u32 s67, s67, s77
    s_cmp_ge_u32 s67, 11
    s_cbranch_scc1 L_lback_26
    s_sub_u32 s74, s74, 1
    s_cmp_eq_u32 s74, 0
    s_cbranch_scc0 L_sp_55
    s_branch L_lback_26
L_lslow_27:
    s_mov_b32 s74, 4194304
L_sp_56:
    ds_read_b32 v9, v7
    s_waitcnt lgkmcnt(0)
    v_readlane_b32 s67, v9, 0
    v_readlane_b32 s76, v9, 1
    v_readlane_b32 s77, v9, 2
    s_min_u32 s67, s67, s76
    s_min_u32 s67, s67, s77
    s_cmp_ge_u32 s67, 12
    s_cbranch_scc1 L_lback_28
    s_sub_u32 s74, s74, 1
    s_cmp_eq_u32 s74, 0
    s_cbranch_scc0 L_sp_56
    s_branch L_lback_28
L_lslow_29:
    s_mov_b32 s74, 4194304
L_sp_57:
    ds_read_b32 v9, v7
    s_waitcnt lgkmcnt(0)
    v_readlane_b32 s67, v9, 0
    v_readlane_b32 s76, v9, 1
    v_readlane_b32 s77, v9, 2
    s_min_u32 s67, s67, s76
    s_min_u32 s67, s67, s77
    s_cmp_ge_u32 s67, 13
    s_cbranch_scc1 L_lback_30
    s_sub_u32 s74, s74, 1
    s_cmp_eq_u32 s74, 0
    s_cbranch_scc0 L_sp_57
    s_branch L_lback_30
L_lslow_31:
    s_mov_b32 s74, 4194304
L_sp_58:
    ds_read_b32 v9, v7
    s_waitcnt lgkmcnt(0)
    v_readlane_b32 s67, v9, 0
    v_readlane_b32 s76, v9, 1
    v_readlane_b32 s77, v9, 2
    s_min_u32 s67, s67, s76
    s_min_u32 s67, s67, s77
    s_cmp_ge_u32 s67, 14
    s_cbranch_scc1 L_lback_32
    s_sub_u32 s74, s74, 1
    s_cmp_eq_u32 s74, 0
    s_cbranch_scc0 L_sp_58
    s_branch L_lback_32
L_lslow_33:
    s_mov_b32 s74, 4194304
L_sp_59:
    ds_read_b32 v9, v7
    s_waitcnt lgkmcnt(0)
    v_readlane_b32 s67, v9, 0
    v_readlane_b32 s76, v9, 1
    v_readlane_b32 s77, v9, 2
    s_min_u32 s67, s67, s76
    s_min_u32 s67, s67, s77
    s_cmp_ge_u32 s67, 15
    s_cbranch_scc1 L_lback_34
    s_sub_u32 s74, s74, 1
    s_cmp_eq_u32 s74, 0
    s_cbranch_scc0 L_sp_59
    s_branch L_lback_34
L_lslow_35:
    s_mov_b32 s74, 4194304
L_sp_60:
    ds_read_b32 v9, v7
    s_waitcnt lgkmcnt(0)
    v_readlane_b32 s67, v9, 0
    v_readlane_b32 s76, v9, 1
    v_readlane_b32 s77, v9, 2
    s_min_u32 s67, s67, s76
    s_min_u32 s67, s67, s77
    s_cmp_ge_u32 s67, 16
    s_cbranch_scc1 L_lback_36
    s_sub_u32 s74, s74, 1
    s_cmp_eq_u32 s74, 0
    s_cbranch_scc0 L_sp_60
    s_branch L_lback_36
L_lslow_37:
    s_mov_b32 s74, 4194304
L_sp_61:
    ds_read_b32 v9, v7
    s_waitcnt lgkmcnt(0)
    v_readlane_b32 s67, v9, 0
    v_readlane_b32 s76, v9, 1
    v_readlane_b32 s77, v9, 2
    s_min_u32 s67, s67, s76
    s_min_u32 s67, s67, s77
    s_cmp_ge_u32 s67, 17
    s_cbranch_scc1 L_lback_38
    s_sub_u32 s74, s74, 1
    s_cmp_eq_u32 s74, 0
    s_cbranch_scc0 L_sp_61
    s_branch L_lback_38
L_lslow_39:
    s_mov_b32 s74, 4194304
L_sp_62:
    ds_read_b32 v9, v7
    s_waitcnt lgkmcnt(0)
    v_readlane_b32 s67, v9, 0
    v_readlane_b32 s76, v9, 1
    v_readlane_b32 s77, v9, 2
    s_min_u32 s67, s67, s76
    s_min_u32 s67, s67, s77
    s_cmp_ge_u32 s67, 18
    s_cbranch_scc1 L_lback_40
    s_sub_u32 s74, s74, 1
    s_cmp_eq_u32 s74, 0
    s_cbranch_scc0 L_sp_62
    s_branch L_lback_40
L_lslow_41:
    s_mov_b32 s74, 4194304
L_sp_63:
    ds_read_b32 v9, v7
    s_waitcnt lgkmcnt(0)
    v_readlane_b32 s67, v9, 0
    v_readlane_b32 s76, v9, 1
    v_readlane_b32 s77, v9, 2
    s_min_u32 s67, s67, s76
    s_min_u32 s67, s67, s77
    s_cmp_ge_u32 s67, 19
    s_cbranch_scc1 L_lback_42
    s_sub_u32 s74, s74, 1
    s_cmp_eq_u32 s74, 0
    s_cbranch_scc0 L_sp_63
    s_branch L_lback_42
L_compute:
    s_lshl_b32 s65, s3, 8
    s_add_u32 s65, s65, 155904
    v_lshl_add_u32 v248, v0, 2, s65
    v_mov_b32 v249, 0
    ds_write_b32 v248, v249
    s_waitcnt lgkmcnt(0)
    s_barrier
    s_mov_b32 s40, s18
    s_mov_b32 s41, s19
    s_mov_b32 s42, 0x600000
    s_mov_b32 s43, 0x20000
    s_mov_b32 s65, 8388608
    s_add_u32 s44, s18, s65
    s_addc_u32 s45, s19, 0
    s_mov_b32 s46, 0x800000
    s_mov_b32 s47, 0x20000
    s_mov_b32 s65, 33554432
    s_add_u32 s48, s18, s65
    s_addc_u32 s49, s19, 0
    s_mov_b32 s50, 0x8000
    s_mov_b32 s51, 0x20000
    s_mov_b32 s52, s14
    s_mov_b32 s53, s15
    s_mov_b32 s54, 0xc0000
    s_mov_b32 s55, 0x20000
    v_lshlrev_b32 v250, 4, v0
    v_lshlrev_b32 v251, 2, v0
    v_bfe_u32 v4, v0, 2, 2
    v_bfe_u32 v30, v0, 4, 1
    v_lshrrev_b32 v1, 5, v0
    v_lshlrev_b32 v29, 5, v30
    v_and_b32 v31, 1, v0
    v_lshl_add_u32 v28, v31, 4, v29
    v_bfe_u32 v31, v0, 1, 1
    v_lshl_add_u32 v28, v31, 3, v28
    v_lshl_add_u32 v31, v1, 2, v4
    v_lshlrev_b32 v31, 8, v31
    v_xor_b32 v232, s3, v4
    v_lshlrev_b32 v232, 6, v232
    v_and_b32 v238, 3, v0
    v_lshl_add_u32 v232, v238, 4, v232
    v_lshl_add_u32 v238, v30, 2, v4
    v_lshl_add_u32 v238, v1, 4, v238
    v_lshl_add_u32 v232, v238, 8, v232
    v_add_u32 v232, 131072, v232
    v_add_u32 v254, 156928, v251
    v_lshrrev_b32 v238, 4, v0
    v_and_b32 v252, 0xf0, v250
    v_lshl_add_u32 v252, v238, 9, v252
    v_mov_b32 v237, 1
    v_mov_b32 v235, 0x7ffffff0
    v_mov_b32 v236, 0x7ffffff0
    v_mov_b32 v239, 0x7ffffff0
    v_mov_b32 v240, 0x7ffffff0
    v_mov_b32 v255, 0x7ffffff0
    s_lshl_b32 s69, s60, 5
    s_add_u32 s69, s69, s62
    s_lshl_b32 s9, s2, 7
    s_lshl_b32 s70, s3, 11
    s_add_u32 s65, s63, 1
    s_and_b32 s65, s65, 3
    s_lshl_b32 s65, s65, 3
    s_add_u32 s65, s65, s69
    s_mul_i32 s65, s65, 24576
    s_add_u32 s71, s65, s70
    s_add_u32 s65, s63, 2
    s_and_b32 s65, s65, 3
    s_lshl_b32 s65, s65, 3
    s_add_u32 s65, s65, s69
    s_mul_i32 s65, s65, 24576
    s_add_u32 s72, s65, s70
    s_add_u32 s65, s63, 3
    s_and_b32 s65, s65, 3
    s_lshl_b32 s65, s65, 3
    s_add_u32 s65, s65, s69
    s_mul_i32 s65, s65, 24576
    s_add_u32 s73, s65, s70
    v_add_u32 v234, s63, v4
    v_and_b32 v234, 3, v234
    v_and_b32 v238, 3, v0
    v_min_u32 v238, 2, v238
    v_lshl_add_u32 v234, v234, 2, v238
    v_lshlrev_b32 v234, 2, v234
    s_and_b32 s65, s2, 0xf8
    s_lshl_b32 s65, s65, 15
    s_lshl_b32 s66, s62, 12
    s_add_u32 s65, s65, s66
    s_lshl_b32 s66, s3, 8
    s_add_u32 s68, s65, s66
    s_lshl_b32 s66, s3, 5
    s_add_u32 s75, s65, s66
    s_mov_b32 s56, s16
    s_mov_b32 s57, s17
    s_mov_b32 s58, 256
    s_mov_b32 s59, 0x20000
    s_mov_b32 s8, 0x3e0293ee
    s_mov_b32 s4, 0
    s_mov_b32 s5, 0x41200000
    s_mov_b32 s6, 0
    s_mov_b32 s11, 32
    s_getreg_b32 s7, hwreg(HW_REG_XCC_ID)
    s_and_b32 s7, s7, 15
    s_add_u32 s7, s7, 16
    s_cmp_eq_u32 s3, 0
    s_cbranch_scc0 L_nomb_64
    s_mov_b64 exec, 0x3ffff
    buffer_load_dword v5, v251, s[48:51], s9 offen sc1
    v_cmp_eq_u32 vcc, 16, v0
    v_mov_b32 v2, s7
    s_nop 0
    v_cndmask_b32 v2, 0, v2, vcc
    v_cmp_eq_u32 vcc, 17, v0
    s_waitcnt vmcnt(0)
    v_add_u32 v5, 1, v5
    v_cndmask_b32 v2, v2, v5, vcc
    buffer_store_dword v2, v251, s[48:51], s9 offen sc1
    s_mov_b64 exec, -1
L_nomb_64:
    v_and_b32 v2, 1, v4
    v_cmp_eq_u32 vcc, v2, v30
    v_mov_b32 v2, 0x3f803f80
    s_nop 0
    v_cndmask_b32 v52, 0, v2, vcc
    v_mov_b32 v53, v52
    v_mov_b32 v54, v52
    v_mov_b32 v55, v52
    v_and_b32 v8, 3, v0
    v_lshl_add_u32 v9, v8, 3, v29
    v_add_u32 v9, v9, v31
    v_add_u32 v9, 65536, v9
    v_lshl_add_u32 v8, v1, 3, v4
    v_lshl_add_u32 v8, v8, 8, v28
    v_add_u32 v8, 65536, v8
    v_xor_b32 v2, 0, v4
    v_lshl_add_u32 v224, v2, 6, v9
    v_lshl_add_u32 v228, v2, 6, v8
    v_xor_b32 v2, 1, v4
    v_lshl_add_u32 v225, v2, 6, v9
    v_lshl_add_u32 v229, v2, 6, v8
    v_xor_b32 v2, 2, v4
    v_lshl_add_u32 v226, v2, 6, v9
    v_lshl_add_u32 v230, v2, 6, v8
    v_xor_b32 v2, 3, v4
    v_lshl_add_u32 v227, v2, 6, v9
    v_lshl_add_u32 v231, v2, 6, v8
    v_and_b32 v5, 31, v0
    v_and_b32 v3, 15, v0
    s_lshl_b32 s65, s3, 13
    s_add_u32 s66, s65, 131072
    s_add_u32 s65, s65, 32768
    v_add_u32 v7, 0, v1
    v_xor_b32 v7, v7, v3
    v_lshlrev_b32 v7, 4, v7
    v_lshl_add_u32 v208, v5, 8, v7
    v_add_u32 v216, s65, v208
    v_add_u32 v10, s66, v208
    v_add_u32 v7, 2, v1
    v_xor_b32 v7, v7, v3
    v_lshlrev_b32 v7, 4, v7
    v_lshl_add_u32 v209, v5, 8, v7
    v_add_u32 v217, s65, v209
    v_add_u32 v11, s66, v209
    v_add_u32 v7, 4, v1
    v_xor_b32 v7, v7, v3
    v_lshlrev_b32 v7, 4, v7
    v_lshl_add_u32 v210, v5, 8, v7
    v_add_u32 v218, s65, v210
    v_add_u32 v12, s66, v210
    v_add_u32 v7, 6, v1
    v_xor_b32 v7, v7, v3
    v_lshlrev_b32 v7, 4, v7
    v_lshl_add_u32 v211, v5, 8, v7
    v_add_u32 v219, s65, v211
    v_add_u32 v13, s66, v211
    v_add_u32 v7, 8, v1
    v_xor_b32 v7, v7, v3
    v_lshlrev_b32 v7, 4, v7
    v_lshl_add_u32 v212, v5, 8, v7
    v_add_u32 v220, s65, v212
    v_add_u32 v14, s66, v212
    v_add_u32 v7, 10, v1
    v_xor_b32 v7, v7, v3
    v_lshlrev_b32 v7, 4, v7
    v_lshl_add_u32 v213, v5, 8, v7
    v_add_u32 v221, s65, v213
    v_add_u32 v15, s66, v213
    v_add_u32 v7, 12, v1
    v_xor_b32 v7, v7, v3
    v_lshlrev_b32 v7, 4, v7
    v_lshl_add_u32 v214, v5, 8, v7
    v_add_u32 v222, s65, v214
    v_add_u32 v16, s66, v214
    v_add_u32 v7, 14, v1
    v_xor_b32 v7, v7, v3
    v_lshlrev_b32 v7, 4, v7
    v_lshl_add_u32 v215, v5, 8, v7
    v_add_u32 v223, s65, v215
    v_add_u32 v17, s66, v215
    v_mov_b32 v247, 155648
    s_lshl_b32 s28, s2, 15
    s_add_u32 s29, s28, 4096
    s_add_u32 s30, s28, 8192
    s_add_u32 s31, s28, 12288
    s_add_u32 s32, s28, 16384
    s_add_u32 s33, s28, 20480
    s_add_u32 s34, s28, 24576
    s_add_u32 s35, s28, 28672
    s_lshl_b32 s67, s3, 10
    v_add_u32 v239, s67, v250
    s_lshl_b32 s67, s3, 7
    v_lshrrev_b32 v7, 2, v0
    v_lshl_add_u32 v240, v7, 3, s67
    s_lshl_b32 s66, s62, 12
    s_lshl_b32 s67, s3, 15
    s_add_u32 s66, s66, s67
    s_lshl_b32 s67, s63, 8
    s_add_u32 s66, s66, s67
    s_mul_i32 s67, s60, 98304
    s_add_u32 s36, s66, s67
    v_and_b32 v7, 0xf0, v251
    v_and_b32 v255, 3, v0
    v_lshl_add_u32 v255, v255, 10, v7
    s_mul_i32 s24, s2, 24576
    s_lshl_b32 s66, s3, 13
    s_add_u32 s24, s24, s66
    s_add_u32 s25, s24, 4096
    v_lshlrev_b32 v7, 2, v1
    v_sub_u32 v7, v5, v7
    v_mov_b32 v8, 0x3f80
    v_mov_b32 v9, 0x3f800000
    v_cmp_eq_u32 vcc, 0, v7
    s_nop 1
    v_cndmask_b32 v2, 0, v8, vcc
    v_cmp_eq_u32 vcc, 1, v7
    s_nop 1
    v_cndmask_b32 v28, v2, v9, vcc
    v_cmp_eq_u32 vcc, 2, v7
    s_nop 1
    v_cndmask_b32 v2, 0, v8, vcc
    v_cmp_eq_u32 vcc, 3, v7
    s_nop 1
    v_cndmask_b32 v29, v2, v9, vcc
    v_cmp_eq_u32 vcc, 8, v7
    s_nop 1
    v_cndmask_b32 v2, 0, v8, vcc
    v_cmp_eq_u32 vcc, 9, v7
    s_nop 1
    v_cndmask_b32 v30, v2, v9, vcc
    v_cmp_eq_u32 vcc, 10, v7
    s_nop 1
    v_cndmask_b32 v2, 0, v8, vcc
    v_cmp_eq_u32 vcc, 11, v7
    s_nop 1
    v_cndmask_b32 v31, v2, v9, vcc
    v_lshl_add_u32 v2, v1, 2, v4
    v_lshlrev_b32 v2, 7, v2
    v_and_b32 v3, 3, v0
    v_lshl_add_u32 v2, v3, 3, v2
    v_bfe_u32 v3, v0, 4, 1
    v_lshl_add_u32 v2, v3, 5, v2
    v_add_u32 v2, 114688, v2
    v_lshrrev_b32 v3, 1, v4
    v_lshl_add_u32 v8, v3, 6, v2
    v_xor_b32 v9, 64, v8
    v_mov_b32 v32, 0
    v_mov_b32 v33, 0
    v_mov_b32 v34, 0
    v_mov_b32 v35, 0
    v_mov_b32 v36, 0
    v_mov_b32 v37, 0
    v_mov_b32 v38, 0
    v_mov_b32 v39, 0
    v_mov_b32 v40, 0
    v_mov_b32 v41, 0
    v_mov_b32 v42, 0
    v_mov_b32 v43, 0
    v_mov_b32 v44, 0
    v_mov_b32 v45, 0
    v_mov_b32 v46, 0
    v_mov_b32 v47, 0
    v_mov_b32 v48, 0
    v_mov_b32 v49, 0
    v_mov_b32 v50, 0
    v_mov_b32 v51, 0
    ds_read_b32 v246, v247
    s_waitcnt lgkmcnt(0)
    v_cmp_le_u32 vcc, 1, v246
    s_cbranch_vccz L_st_65
L_bk_66:
    v_mov_b32 v249, 1
    ds_read_b128 v[128:131], v216
    ds_read_b64_tr_b16 a[128:129], v228 offset:0
    ds_read_b64_tr_b16 a[130:131], v228 offset:1024
    ds_read_b64_tr_b16 a[132:133], v229 offset:0
    ds_read_b64_tr_b16 a[134:135], v229 offset:1024
    ds_read_b64_tr_b16 a[136:137], v230 offset:0
    ds_read_b64_tr_b16 a[138:139], v230 offset:1024
    ds_read_b64_tr_b16 a[140:141], v231 offset:0
    ds_read_b64_tr_b16 a[142:143], v231 offset:1024
    ds_read_b128 v[132:135], v217
    ds_read_b64_tr_b16 a[144:145], v228 offset:4096
    ds_read_b64_tr_b16 a[146:147], v228 offset:5120
    ds_read_b64_tr_b16 a[148:149], v229 offset:4096
    ds_read_b64_tr_b16 a[150:151], v229 offset:5120
    s_waitcnt lgkmcnt(11)
    v_mfma_f32_32x32x16_bf16 v[64:79], a[128:131], v[128:131], 0
    ds_read_b64_tr_b16 a[152:153], v230 offset:4096
    ds_read_b64_tr_b16 a[154:155], v230 offset:5120
    ds_read_b64_tr_b16 a[156:157], v231 offset:4096
    ds_read_b64_tr_b16 a[158:159], v231 offset:5120
    ds_read_b128 v[136:139], v218
    s_waitcnt lgkmcnt(14)
    v_mfma_f32_32x32x16_bf16 v[80:95], a[132:135], v[128:131], 0
    ds_read_b64_tr_b16 a[160:161], v228 offset:8192
    ds_read_b64_tr_b16 a[162:163], v228 offset:9216
    ds_read_b64_tr_b16 a[164:165], v229 offset:8192
    ds_read_b64_tr_b16 a[166:167], v229 offset:9216
    s_waitcnt lgkmcnt(15)
    v_mfma_f32_32x32x16_bf16 v[96:111], a[136:139], v[128:131], 0
    ds_read_b64_tr_b16 a[168:169], v230 offset:8192
    ds_read_b64_tr_b16 a[170:171], v230 offset:9216
    ds_read_b64_tr_b16 a[172:173], v231 offset:8192
    ds_read_b64_tr_b16 a[174:175], v231 offset:9216
    s_waitcnt lgkmcnt(15)
    v_mfma_f32_32x32x16_bf16 v[112:127], a[140:143], v[128:131], 0
    ds_read_b128 v[140:143], v219
    ds_read_b64_tr_b16 a[176:177], v228 offset:12288
    ds_read_b64_tr_b16 a[178:179], v228 offset:13312
    ds_read_b64_tr_b16 a[180:181], v229 offset:12288
    v_mfma_f32_32x32x16_bf16 v[64:79], a[144:147], v[132:135], v[64:79]
    ds_read_b64_tr_b16 a[182:183], v229 offset:13312
    ds_read_b64_tr_b16 a[184:185], v230 offset:12288
    ds_read_b64_tr_b16 a[186:187], v230 offset:13312
    ds_read_b64_tr_b16 a[188:189], v231 offset:12288
    s_waitcnt lgkmcnt(15)
    v_mfma_f32_32x32x16_bf16 v[80:95], a[148:151], v[132:135], v[80:95]
    ds_read_b64_tr_b16 a[190:191], v231 offset:13312
    ds_read_b128 v[144:147], v220
    ds_read_b64_tr_b16 a[192:193], v228 offset:16384
    ds_read_b64_tr_b16 a[194:195], v228 offset:17408
    v_mfma_f32_32x32x16_bf16 v[96:111], a[152:155], v[132:135], v[96:111]
    ds_read_b64_tr_b16 a[196:197], v229 offset:16384
    ds_read_b64_tr_b16 a[198:199], v229 offset:17408
    ds_read_b64_tr_b16 a[200:201], v230 offset:16384
    ds_read_b64_tr_b16 a[202:203], v230 offset:17408
    v_mfma_f32_32x32x16_bf16 v[112:127], a[156:159], v[132:135], v[112:127]
    ds_read_b64_tr_b16 a[204:205], v231 offset:16384
    ds_read_b64_tr_b16 a[206:207], v231 offset:17408
    ds_read_b128 v[148:151], v221
    ds_read_b64_tr_b16 a[208:209], v228 offset:20480
    ds_read_b64_tr_b16 a[210:211], v228 offset:21504
    s_waitcnt lgkmcnt(15)
    v_mfma_f32_32x32x16_bf16 v[64:79], a[160:163], v[136:139], v[64:79]
    ds_read_b64_tr_b16 a[212:213], v229 offset:20480
    ds_read_b64_tr_b16 a[214:215], v229 offset:21504
    ds_read_b64_tr_b16 a[216:217], v230 offset:20480
    ds_read_b64_tr_b16 a[218:219], v230 offset:21504
    v_mfma_f32_32x32x16_bf16 v[80:95], a[164:167], v[136:139], v[80:95]
    ds_read_b64_tr_b16 a[220:221], v231 offset:20480
    ds_read_b64_tr_b16 a[222:223], v231 offset:21504
    ds_read_b128 v[152:155], v222
    ds_read_b64_tr_b16 a[224:225], v228 offset:24576
    v_mfma_f32_32x32x16_bf16 v[96:111], a[168:171], v[136:139], v[96:111]
    ds_read_b64_tr_b16 a[226:227], v228 offset:25600
    ds_read_b64_tr_b16 a[228:229], v229 offset:24576
    ds_read_b64_tr_b16 a[230:231], v229 offset:25600
    ds_read_b64_tr_b16 a[232:233], v230 offset:24576
    v_mfma_f32_32x32x16_bf16 v[112:127], a[172:175], v[136:139], v[112:127]
    ds_read_b64_tr_b16 a[234:235], v230 offset:25600
    ds_read_b64_tr_b16 a[236:237], v231 offset:24576
    ds_read_b64_tr_b16 a[238:239], v231 offset:25600
    ds_read_b128 v[156:159], v223
    v_mfma_f32_32x32x16_bf16 v[64:79], a[176:179], v[140:143], v[64:79]
    ds_read_b64_tr_b16 a[240:241], v228 offset:28672
    ds_read_b64_tr_b16 a[242:243], v228 offset:29696
    ds_read_b64_tr_b16 a[244:245], v229 offset:28672
    ds_read_b64_tr_b16 a[246:247], v229 offset:29696
    v_mfma_f32_32x32x16_bf16 v[80:95], a[180:183], v[140:143], v[80:95]
    ds_read_b64_tr_b16 a[248:249], v230 offset:28672
    ds_read_b64_tr_b16 a[250:251], v230 offset:29696
    ds_read_b64_tr_b16 a[252:253], v231 offset:28672
    ds_read_b64_tr_b16 a[254:255], v231 offset:29696
    s_waitcnt lgkmcnt(0)
    ds_write_b32 v248, v249
    v_mfma_f32_32x32x16_bf16 v[96:111], a[184:187], v[140:143], v[96:111]
    v_mfma_f32_32x32x16_bf16 v[112:127], a[188:191], v[140:143], v[112:127]
    v_mfma_f32_32x32x16_bf16 v[64:79], a[192:195], v[144:147], v[64:79]
    v_mfma_f32_32x32x16_bf16 v[80:95], a[196:199], v[144:147], v[80:95]
    v_mfma_f32_32x32x16_bf16 v[96:111], a[200:203], v[144:147], v[96:111]
    v_mfma_f32_32x32x16_bf16 v[112:127], a[204:207], v[144:147], v[112:127]
    v_mfma_f32_32x32x16_bf16 v[64:79], a[208:211], v[148:151], v[64:79]
    v_mfma_f32_32x32x16_bf16 v[80:95], a[212:215], v[148:151], v[80:95]
    v_mfma_f32_32x32x16_bf16 v[96:111], a[216:219], v[148:151], v[96:111]
    v_mfma_f32_32x32x16_bf16 v[112:127], a[220:223], v[148:151], v[112:127]
    v_mfma_f32_32x32x16_bf16 v[64:79], a[224:227], v[152:155], v[64:79]
    v_mfma_f32_32x32x16_bf16 v[80:95], a[228:231], v[152:155], v[80:95]
    v_mfma_f32_32x32x16_bf16 v[96:111], a[232:235], v[152:155], v[96:111]
    v_mfma_f32_32x32x16_bf16 v[112:127], a[236:239], v[152:155], v[112:127]
    v_mfma_f32_32x32x16_bf16 v[64:79], a[240:243], v[156:159], v[64:79]
    ds_read_b32 v246, v247
    v_mfma_f32_32x32x16_bf16 v[80:95], a[244:247], v[156:159], v[80:95]
    v_mfma_f32_32x32x16_bf16 v[96:111], a[248:251], v[156:159], v[96:111]
    v_mfma_f32_32x32x16_bf16 v[112:127], a[252:255], v[156:159], v[112:127]
    s_waitcnt lgkmcnt(0)
    v_cmp_le_u32 vcc, 2, v246
    s_cbranch_vccz L_st_67
L_bk_68:
    v_mov_b32 v249, 2
    ds_read_b128 v[128:131], v10
    ds_read_b64_tr_b16 a[128:129], v228 offset:32768
    ds_read_b64_tr_b16 a[130:131], v228 offset:33792
    ds_read_b64_tr_b16 a[132:133], v229 offset:32768
    ds_read_b64_tr_b16 a[134:135], v229 offset:33792
    ds_read_b64_tr_b16 a[136:137], v230 offset:32768
    ds_read_b64_tr_b16 a[138:139], v230 offset:33792
    ds_read_b64_tr_b16 a[140:141], v231 offset:32768
    ds_read_b64_tr_b16 a[142:143], v231 offset:33792
    ds_read_b128 v[132:135], v11
    ds_read_b64_tr_b16 a[144:145], v228 offset:36864
    ds_read_b64_tr_b16 a[146:147], v228 offset:37888
    ds_read_b64_tr_b16 a[148:149], v229 offset:36864
    ds_read_b64_tr_b16 a[150:151], v229 offset:37888
    s_waitcnt lgkmcnt(11)
    v_mfma_f32_32x32x16_bf16 v[64:79], a[128:131], v[128:131], v[64:79]
    ds_read_b64_tr_b16 a[152:153], v230 offset:36864
    ds_read_b64_tr_b16 a[154:155], v230 offset:37888
    ds_read_b64_tr_b16 a[156:157], v231 offset:36864
    ds_read_b64_tr_b16 a[158:159], v231 offset:37888
    ds_read_b128 v[136:139], v12
    s_waitcnt lgkmcnt(14)
    v_mfma_f32_32x32x16_bf16 v[80:95], a[132:135], v[128:131], v[80:95]
    ds_read_b64_tr_b16 a[160:161], v228 offset:40960
    ds_read_b64_tr_b16 a[162:163], v228 offset:41984
    ds_read_b64_tr_b16 a[164:165], v229 offset:40960
    ds_read_b64_tr_b16 a[166:167], v229 offset:41984
    s_waitcnt lgkmcnt(15)
    v_mfma_f32_32x32x16_bf16 v[96:111], a[136:139], v[128:131], v[96:111]
    ds_read_b64_tr_b16 a[168:169], v230 offset:40960
    ds_read_b64_tr_b16 a[170:171], v230 offset:41984
    ds_read_b64_tr_b16 a[172:173], v231 offset:40960
    ds_read_b64_tr_b16 a[174:175], v231 offset:41984
    s_waitcnt lgkmcnt(15)
    v_mfma_f32_32x32x16_bf16 v[112:127], a[140:143], v[128:131], v[112:127]
    ds_read_b128 v[140:143], v13
    ds_read_b64_tr_b16 a[176:177], v228 offset:45056
    ds_read_b64_tr_b16 a[178:179], v228 offset:46080
    ds_read_b64_tr_b16 a[180:181], v229 offset:45056
    v_mfma_f32_32x32x16_bf16 v[64:79], a[144:147], v[132:135], v[64:79]
    ds_read_b64_tr_b16 a[182:183], v229 offset:46080
    ds_read_b64_tr_b16 a[184:185], v230 offset:45056
    ds_read_b64_tr_b16 a[186:187], v230 offset:46080
    ds_read_b64_tr_b16 a[188:189], v231 offset:45056
    s_waitcnt lgkmcnt(15)
    v_mfma_f32_32x32x16_bf16 v[80:95], a[148:151], v[132:135], v[80:95]
    ds_read_b64_tr_b16 a[190:191], v231 offset:46080
    ds_read_b128 v[144:147], v14
    ds_read_b64_tr_b16 a[192:193], v228 offset:49152
    ds_read_b64_tr_b16 a[194:195], v228 offset:50176
    v_mfma_f32_32x32x16_bf16 v[96:111], a[152:155], v[132:135], v[96:111]
    ds_read_b64_tr_b16 a[196:197], v229 offset:49152
    ds_read_b64_tr_b16 a[198:199], v229 offset:50176
    ds_read_b64_tr_b16 a[200:201], v230 offset:49152
    ds_read_b64_tr_b16 a[202:203], v230 offset:50176
    v_mfma_f32_32x32x16_bf16 v[112:127], a[156:159], v[132:135], v[112:127]
    ds_read_b64_tr_b16 a[204:205], v231 offset:49152
    ds_read_b64_tr_b16 a[206:207], v231 offset:50176
    ds_read_b128 v[148:151], v15
    ds_read_b64_tr_b16 a[208:209], v228 offset:53248
    ds_read_b64_tr_b16 a[210:211], v228 offset:54272
    s_waitcnt lgkmcnt(15)
    v_mfma_f32_32x32x16_bf16 v[64:79], a[160:163], v[136:139], v[64:79]
    ds_read_b64_tr_b16 a[212:213], v229 offset:53248
    ds_read_b64_tr_b16 a[214:215], v229 offset:54272
    ds_read_b64_tr_b16 a[216:217], v230 offset:53248
    ds_read_b64_tr_b16 a[218:219], v230 offset:54272
    v_mfma_f32_32x32x16_bf16 v[80:95], a[164:167], v[136:139], v[80:95]
    ds_read_b64_tr_b16 a[220:221], v231 offset:53248
    ds_read_b64_tr_b16 a[222:223], v231 offset:54272
    ds_read_b128 v[152:155], v16
    ds_read_b64_tr_b16 a[224:225], v228 offset:57344
    v_mfma_f32_32x32x16_bf16 v[96:111], a[168:171], v[136:139], v[96:111]
    ds_read_b64_tr_b16 a[226:227], v228 offset:58368
    ds_read_b64_tr_b16 a[228:229], v229 offset:57344
    ds_read_b64_tr_b16 a[230:231], v229 offset:58368
    ds_read_b64_tr_b16 a[232:233], v230 offset:57344
    v_mfma_f32_32x32x16_bf16 v[112:127], a[172:175], v[136:139], v[112:127]
    ds_read_b64_tr_b16 a[234:235], v230 offset:58368
    ds_read_b64_tr_b16 a[236:237], v231 offset:57344
    ds_read_b64_tr_b16 a[238:239], v231 offset:58368
    ds_read_b128 v[156:159], v17
    v_mfma_f32_32x32x16_bf16 v[64:79], a[176:179], v[140:143], v[64:79]
    ds_read_b64_tr_b16 a[240:241], v228 offset:61440
    ds_read_b64_tr_b16 a[242:243], v228 offset:62464
    ds_read_b64_tr_b16 a[244:245], v229 offset:61440
    ds_read_b64_tr_b16 a[246:247], v229 offset:62464
    v_mfma_f32_32x32x16_bf16 v[80:95], a[180:183], v[140:143], v[80:95]
    ds_read_b64_tr_b16 a[248:249], v230 offset:61440
    ds_read_b64_tr_b16 a[250:251], v230 offset:62464
    ds_read_b64_tr_b16 a[252:253], v231 offset:61440
    ds_read_b64_tr_b16 a[254:255], v231 offset:62464
    s_waitcnt lgkmcnt(0)
    ds_write_b32 v248, v249
    v_mfma_f32_32x32x16_bf16 v[96:111], a[184:187], v[140:143], v[96:111]
    v_mfma_f32_32x32x16_bf16 v[112:127], a[188:191], v[140:143], v[112:127]
    v_mfma_f32_32x32x16_bf16 v[64:79], a[192:195], v[144:147], v[64:79]
    v_mfma_f32_32x32x16_bf16 v[80:95], a[196:199], v[144:147], v[80:95]
    v_mfma_f32_32x32x16_bf16 v[96:111], a[200:203], v[144:147], v[96:111]
    v_mfma_f32_32x32x16_bf16 v[112:127], a[204:207], v[144:147], v[112:127]
    v_mfma_f32_32x32x16_bf16 v[64:79], a[208:211], v[148:151], v[64:79]
    v_mfma_f32_32x32x16_bf16 v[80:95], a[212:215], v[148:151], v[80:95]
    v_mfma_f32_32x32x16_bf16 v[96:111], a[216:219], v[148:151], v[96:111]
    v_mfma_f32_32x32x16_bf16 v[112:127], a[220:223], v[148:151], v[112:127]
    v_mfma_f32_32x32x16_bf16 v[64:79], a[224:227], v[152:155], v[64:79]
    v_mfma_f32_32x32x16_bf16 v[80:95], a[228:231], v[152:155], v[80:95]
    v_mfma_f32_32x32x16_bf16 v[96:111], a[232:235], v[152:155], v[96:111]
    v_mfma_f32_32x32x16_bf16 v[112:127], a[236:239], v[152:155], v[112:127]
    v_mfma_f32_32x32x16_bf16 v[64:79], a[240:243], v[156:159], v[64:79]
    ds_read_b32 v246, v247
    v_mfma_f32_32x32x16_bf16 v[80:95], a[244:247], v[156:159], v[80:95]
    v_mfma_f32_32x32x16_bf16 v[96:111], a[248:251], v[156:159], v[96:111]
    v_mfma_f32_32x32x16_bf16 v[112:127], a[252:255], v[156:159], v[112:127]
    s_waitcnt lgkmcnt(0)
    v_cmp_le_u32 vcc, 3, v246
    s_cbranch_vccz L_st_69
L_bk_70:
    v_mov_b32 v249, 3
    ds_read_b128 v[128:131], v10
    ds_read_b64_tr_b16 a[128:129], v228 offset:32768
    ds_read_b64_tr_b16 a[130:131], v228 offset:33792
    ds_read_b64_tr_b16 a[132:133], v229 offset:32768
    ds_read_b64_tr_b16 a[134:135], v229 offset:33792
    ds_read_b64_tr_b16 a[136:137], v230 offset:32768
    ds_read_b64_tr_b16 a[138:139], v230 offset:33792
    ds_read_b64_tr_b16 a[140:141], v231 offset:32768
    ds_read_b64_tr_b16 a[142:143], v231 offset:33792
    ds_read_b128 v[132:135], v11
    ds_read_b64_tr_b16 a[144:145], v228 offset:36864
    ds_read_b64_tr_b16 a[146:147], v228 offset:37888
    ds_read_b64_tr_b16 a[148:149], v229 offset:36864
    ds_read_b64_tr_b16 a[150:151], v229 offset:37888
    s_waitcnt lgkmcnt(11)
    v_mfma_f32_32x32x16_bf16 v[64:79], a[128:131], v[128:131], v[64:79]
    ds_read_b64_tr_b16 a[152:153], v230 offset:36864
    ds_read_b64_tr_b16 a[154:155], v230 offset:37888
    ds_read_b64_tr_b16 a[156:157], v231 offset:36864
    ds_read_b64_tr_b16 a[158:159], v231 offset:37888
    ds_read_b128 v[136:139], v12
    ds_read_b64_tr_b16 a[160:161], v228 offset:40960
    s_waitcnt lgkmcnt(15)
    v_mfma_f32_32x32x16_bf16 v[80:95], a[132:135], v[128:131], v[80:95]
    ds_read_b64_tr_b16 a[162:163], v228 offset:41984
    ds_read_b64_tr_b16 a[164:165], v229 offset:40960
    ds_read_b64_tr_b16 a[166:167], v229 offset:41984
    ds_read_b64_tr_b16 a[168:169], v230 offset:40960
    ds_read_b64_tr_b16 a[170:171], v230 offset:41984
    s_waitcnt lgkmcnt(15)
    v_mfma_f32_32x32x16_bf16 v[96:111], a[136:139], v[128:131], v[96:111]
    ds_read_b64_tr_b16 a[172:173], v231 offset:40960
    ds_read_b64_tr_b16 a[174:175], v231 offset:41984
    ds_read_b128 v[140:143], v13
    ds_read_b64_tr_b16 a[176:177], v228 offset:45056
    ds_read_b64_tr_b16 a[178:179], v228 offset:46080
    v_mfma_f32_32x32x16_bf16 v[112:127], a[140:143], v[128:131], v[112:127]
    ds_read_b64_tr_b16 a[180:181], v229 offset:45056
    ds_read_b64_tr_b16 a[182:183], v229 offset:46080
    ds_read_b64_tr_b16 a[184:185], v230 offset:45056
    ds_read_b64_tr_b16 a[186:187], v230 offset:46080
    ds_read_b64_tr_b16 a[188:189], v231 offset:45056
    ds_read_b64_tr_b16 a[190:191], v231 offset:46080
    s_waitcnt lgkmcnt(15)
    v_mfma_f32_32x32x16_bf16 v[64:79], a[144:147], v[132:135], v[64:79]
    ds_read_b128 v[144:147], v14
    ds_read_b64_tr_b16 a[192:193], v228 offset:49152
    ds_read_b64_tr_b16 a[194:195], v228 offset:50176
    ds_read_b64_tr_b16 a[196:197], v229 offset:49152
    ds_read_b64_tr_b16 a[198:199], v229 offset:50176
    v_mfma_f32_32x32x16_bf16 v[80:95], a[148:151], v[132:135], v[80:95]
    ds_read_b64_tr_b16 a[200:201], v230 offset:49152
    ds_read_b64_tr_b16 a[202:203], v230 offset:50176
    ds_read_b64_tr_b16 a[204:205], v231 offset:49152
    ds_read_b64_tr_b16 a[206:207], v231 offset:50176
    ds_read_b128 v[148:151], v15
    v_mfma_f32_32x32x16_bf16 v[96:111], a[152:155], v[132:135], v[96:111]
    ds_read_b64_tr_b16 a[208:209], v228 offset:53248
    ds_read_b64_tr_b16 a[210:211], v228 offset:54272
    ds_read_b64_tr_b16 a[212:213], v229 offset:53248
    ds_read_b64_tr_b16 a[214:215], v229 offset:54272
    ds_read_b64_tr_b16 a[216:217], v230 offset:53248
    v_mfma_f32_32x32x16_bf16 v[112:127], a[156:159], v[132:135], v[112:127]
    ds_read_b64_tr_b16 a[218:219], v230 offset:54272
    ds_read_b64_tr_b16 a[220:221], v231 offset:53248
    ds_read_b64_tr_b16 a[222:223], v231 offset:54272
    ds_read_b128 v[152:155], v16
    ds_read_b64_tr_b16 a[224:225], v228 offset:57344
    ds_read_b64_tr_b16 a[226:227], v228 offset:58368
    v_mfma_f32_32x32x16_bf16 v[64:79], a[160:163], v[136:139], v[64:79]
    ds_read_b64_tr_b16 a[228:229], v229 offset:57344
    ds_read_b64_tr_b16 a[230:231], v229 offset:58368
    ds_read_b64_tr_b16 a[232:233], v230 offset:57344
    ds_read_b64_tr_b16 a[234:235], v230 offset:58368
    ds_read_b64_tr_b16 a[236:237], v231 offset:57344
    s_waitcnt lgkmcnt(15)
    v_mfma_f32_32x32x16_bf16 v[80:95], a[164:167], v[136:139], v[80:95]
    ds_read_b64_tr_b16 a[238:239], v231 offset:58368
    ds_read_b128 v[156:159], v17
    ds_read_b64_tr_b16 a[240:241], v228 offset:61440
    ds_read_b64_tr_b16 a[242:243], v228 offset:62464
    ds_read_b64_tr_b16 a[244:245], v229 offset:61440
    v_mfma_f32_32x32x16_bf16 v[96:111], a[168:171], v[136:139], v[96:111]
    ds_read_b64_tr_b16 a[246:247], v229 offset:62464
    ds_read_b64_tr_b16 a[248:249], v230 offset:61440
    ds_read_b64_tr_b16 a[250:251], v230 offset:62464
    ds_read_b64_tr_b16 a[252:253], v231 offset:61440
    ds_read_b64_tr_b16 a[254:255], v231 offset:62464
    ds_read_b128 a[0:3], v208 offset:0
    v_mfma_f32_32x32x16_bf16 v[112:127], a[172:175], v[136:139], v[112:127]
    ds_read_b128 a[4:7], v209 offset:0
    ds_read_b128 a[8:11], v210 offset:0
    ds_read_b128 a[12:15], v211 offset:0
    ds_read_b128 a[16:19], v212 offset:0
    ds_read_b128 a[20:23], v213 offset:0
    v_mfma_f32_32x32x16_bf16 v[64:79], a[176:179], v[140:143], v[64:79]
    ds_read_b128 a[24:27], v214 offset:0
    ds_read_b128 a[28:31], v215 offset:0
    ds_read_b128 a[32:35], v208 offset:8192
    ds_read_b128 a[36:39], v209 offset:8192
    ds_read_b128 a[40:43], v210 offset:8192
    v_mfma_f32_32x32x16_bf16 v[80:95], a[180:183], v[140:143], v[80:95]
    ds_read_b128 a[44:47], v211 offset:8192
    ds_read_b128 a[48:51], v212 offset:8192
    ds_read_b128 a[52:55], v213 offset:8192
    ds_read_b128 a[56:59], v214 offset:8192
    ds_read_b128 a[60:63], v215 offset:8192
    s_waitcnt lgkmcnt(0)
    ds_write_b32 v248, v249
    v_mfma_f32_32x32x16_bf16 v[96:111], a[184:187], v[140:143], v[96:111]
    v_mfma_f32_32x32x16_bf16 v[112:127], a[188:191], v[140:143], v[112:127]
    v_mfma_f32_32x32x16_bf16 v[64:79], a[192:195], v[144:147], v[64:79]
    v_mfma_f32_32x32x16_bf16 v[80:95], a[196:199], v[144:147], v[80:95]
    v_mfma_f32_32x32x16_bf16 v[96:111], a[200:203], v[144:147], v[96:111]
    v_mfma_f32_32x32x16_bf16 v[112:127], a[204:207], v[144:147], v[112:127]
    v_mfma_f32_32x32x16_bf16 v[64:79], a[208:211], v[148:151], v[64:79]
    v_mfma_f32_32x32x16_bf16 v[80:95], a[212:215], v[148:151], v[80:95]
    v_mfma_f32_32x32x16_bf16 v[96:111], a[216:219], v[148:151], v[96:111]
    v_mfma_f32_32x32x16_bf16 v[112:127], a[220:223], v[148:151], v[112:127]
    v_mfma_f32_32x32x16_bf16 v[64:79], a[224:227], v[152:155], v[64:79]
    v_mfma_f32_32x32x16_bf16 v[80:95], a[228:231], v[152:155], v[80:95]
    v_mfma_f32_32x32x16_bf16 v[96:111], a[232:235], v[152:155], v[96:111]
    v_mfma_f32_32x32x16_bf16 v[112:127], a[236:239], v[152:155], v[112:127]
    v_mfma_f32_32x32x16_bf16 v[64:79], a[240:243], v[156:159], v[64:79]
    ds_read_b32 v246, v247
    v_mfma_f32_32x32x16_bf16 v[80:95], a[244:247], v[156:159], v[80:95]
    v_mfma_f32_32x32x16_bf16 v[96:111], a[248:251], v[156:159], v[96:111]
    v_mfma_f32_32x32x16_bf16 v[112:127], a[252:255], v[156:159], v[112:127]
    s_waitcnt lgkmcnt(0)
    v_cmp_le_u32 vcc, 4, v246
    s_cbranch_vccz L_st_71
L_bk_72:
    v_mov_b32 v249, 5
    ds_read_b128 v[128:131], v10
    ds_read_b64_tr_b16 a[128:129], v228 offset:32768
    ds_read_b64_tr_b16 a[130:131], v228 offset:33792
    ds_read_b64_tr_b16 a[132:133], v229 offset:32768
    ds_read_b64_tr_b16 a[134:135], v229 offset:33792
    ds_read_b64_tr_b16 a[136:137], v230 offset:32768
    ds_read_b64_tr_b16 a[138:139], v230 offset:33792
    ds_read_b64_tr_b16 a[140:141], v231 offset:32768
    ds_read_b64_tr_b16 a[142:143], v231 offset:33792
    ds_read_b128 v[132:135], v11
    ds_read_b64_tr_b16 a[144:145], v228 offset:36864
    ds_read_b64_tr_b16 a[146:147], v228 offset:37888
    ds_read_b64_tr_b16 a[148:149], v229 offset:36864
    ds_read_b64_tr_b16 a[150:151], v229 offset:37888
    s_waitcnt lgkmcnt(11)
    v_mfma_f32_32x32x16_bf16 v[64:79], a[128:131], v[128:131], v[64:79]
    ds_read_b64_tr_b16 a[152:153], v230 offset:36864
    ds_read_b64_tr_b16 a[154:155], v230 offset:37888
    ds_read_b64_tr_b16 a[156:157], v231 offset:36864
    ds_read_b64_tr_b16 a[158:159], v231 offset:37888
    ds_read_b128 v[136:139], v12
    ds_read_b64_tr_b16 a[160:161], v228 offset:40960
    s_waitcnt lgkmcnt(15)
    v_mfma_f32_32x32x16_bf16 v[80:95], a[132:135], v[128:131], v[80:95]
    ds_read_b64_tr_b16 a[162:163], v228 offset:41984
    ds_read_b64_tr_b16 a[164:165], v229 offset:40960
    ds_read_b64_tr_b16 a[166:167], v229 offset:41984
    ds_read_b64_tr_b16 a[168:169], v230 offset:40960
    ds_read_b64_tr_b16 a[170:171], v230 offset:41984
    s_waitcnt lgkmcnt(15)
    v_mfma_f32_32x32x16_bf16 v[96:111], a[136:139], v[128:131], v[96:111]
    ds_read_b64_tr_b16 a[172:173], v231 offset:40960
    ds_read_b64_tr_b16 a[174:175], v231 offset:41984
    ds_read_b128 v[140:143], v13
    ds_read_b64_tr_b16 a[176:177], v228 offset:45056
    ds_read_b64_tr_b16 a[178:179], v228 offset:46080
    v_mfma_f32_32x32x16_bf16 v[112:127], a[140:143], v[128:131], v[112:127]
    ds_read_b64_tr_b16 a[180:181], v229 offset:45056
    ds_read_b64_tr_b16 a[182:183], v229 offset:46080
    ds_read_b64_tr_b16 a[184:185], v230 offset:45056
    ds_read_b64_tr_b16 a[186:187], v230 offset:46080
    ds_read_b64_tr_b16 a[188:189], v231 offset:45056
    ds_read_b64_tr_b16 a[190:191], v231 offset:46080
    s_waitcnt lgkmcnt(15)
    v_mfma_f32_32x32x16_bf16 v[64:79], a[144:147], v[132:135], v[64:79]
    ds_read_b128 v[144:147], v14
    ds_read_b64_tr_b16 a[192:193], v228 offset:49152
    ds_read_b64_tr_b16 a[194:195], v228 offset:50176
    ds_read_b64_tr_b16 a[196:197], v229 offset:49152
    ds_read_b64_tr_b16 a[198:199], v229 offset:50176
    v_mfma_f32_32x32x16_bf16 v[80:95], a[148:151], v[132:135], v[80:95]
    ds_read_b64_tr_b16 a[200:201], v230 offset:49152
    ds_read_b64_tr_b16 a[202:203], v230 offset:50176
    ds_read_b64_tr_b16 a[204:205], v231 offset:49152
    ds_read_b64_tr_b16 a[206:207], v231 offset:50176
    ds_read_b128 v[148:151], v15
    v_mfma_f32_32x32x16_bf16 v[96:111], a[152:155], v[132:135], v[96:111]
    ds_read_b64_tr_b16 a[208:209], v228 offset:53248
    ds_read_b64_tr_b16 a[210:211], v228 offset:54272
    ds_read_b64_tr_b16 a[212:213], v229 offset:53248
    ds_read_b64_tr_b16 a[214:215], v229 offset:54272
    ds_read_b64_tr_b16 a[216:217], v230 offset:53248
    v_mfma_f32_32x32x16_bf16 v[112:127], a[156:159], v[132:135], v[112:127]
    ds_read_b64_tr_b16 a[218:219], v230 offset:54272
    ds_read_b64_tr_b16 a[220:221], v231 offset:53248
    ds_read_b64_tr_b16 a[222:223], v231 offset:54272
    ds_read_b128 v[152:155], v16
    ds_read_b64_tr_b16 a[224:225], v228 offset:57344
    ds_read_b64_tr_b16 a[226:227], v228 offset:58368
    v_mfma_f32_32x32x16_bf16 v[64:79], a[160:163], v[136:139], v[64:79]
    ds_read_b64_tr_b16 a[228:229], v229 offset:57344
    ds_read_b64_tr_b16 a[230:231], v229 offset:58368
    ds_read_b64_tr_b16 a[232:233], v230 offset:57344
    ds_read_b64_tr_b16 a[234:235], v230 offset:58368
    ds_read_b64_tr_b16 a[236:237], v231 offset:57344
    s_waitcnt lgkmcnt(15)
    v_mfma_f32_32x32x16_bf16 v[80:95], a[164:167], v[136:139], v[80:95]
    ds_read_b64_tr_b16 a[238:239], v231 offset:58368
    ds_read_b128 v[156:159], v17
    ds_read_b64_tr_b16 a[240:241], v228 offset:61440
    ds_read_b64_tr_b16 a[242:243], v228 offset:62464
    ds_read_b64_tr_b16 a[244:245], v229 offset:61440
    v_mfma_f32_32x32x16_bf16 v[96:111], a[168:171], v[136:139], v[96:111]
    ds_read_b64_tr_b16 a[246:247], v229 offset:62464
    ds_read_b64_tr_b16 a[248:249], v230 offset:61440
    ds_read_b64_tr_b16 a[250:251], v230 offset:62464
    ds_read_b64_tr_b16 a[252:253], v231 offset:61440
    ds_read_b64_tr_b16 a[254:255], v231 offset:62464
    ds_read_b128 a[64:67], v208 offset:16384
    v_mfma_f32_32x32x16_bf16 v[112:127], a[172:175], v[136:139], v[112:127]
    ds_read_b128 a[68:71], v209 offset:16384
    ds_read_b128 a[72:75], v210 offset:16384
    ds_read_b128 a[76:79], v211 offset:16384
    ds_read_b128 a[80:83], v212 offset:16384
    ds_read_b128 a[84:87], v213 offset:16384
    v_mfma_f32_32x32x16_bf16 v[64:79], a[176:179], v[140:143], v[64:79]
    ds_read_b128 a[88:91], v214 offset:16384
    ds_read_b128 a[92:95], v215 offset:16384
    ds_read_b128 a[96:99], v208 offset:24576
    ds_read_b128 a[100:103], v209 offset:24576
    ds_read_b128 a[104:107], v210 offset:24576
    v_mfma_f32_32x32x16_bf16 v[80:95], a[180:183], v[140:143], v[80:95]
    ds_read_b128 a[108:111], v211 offset:24576
    ds_read_b128 a[112:115], v212 offset:24576
    ds_read_b128 a[116:119], v213 offset:24576
    ds_read_b128 a[120:123], v214 offset:24576
    ds_read_b128 a[124:127], v215 offset:24576
    s_waitcnt lgkmcnt(0)
    ds_write_b32 v248, v249
    s_cmp_eq_u32 s3, 0
    s_cbranch_scc1 L_st_73
L_bk_74:
    v_mfma_f32_32x32x16_bf16 v[64:79], a[192:195], v[144:147], v[64:79]
    v_mfma_f32_32x32x16_bf16 v[64:79], a[208:211], v[148:151], v[64:79]
    v_mfma_f32_32x32x16_bf16 v[64:79], a[224:227], v[152:155], v[64:79]
    v_mfma_f32_32x32x16_bf16 v[64:79], a[240:243], v[156:159], v[64:79]
    v_mfma_f32_32x32x16_bf16 v[80:95], a[196:199], v[144:147], v[80:95]
    v_mfma_f32_32x32x16_bf16 v[80:95], a[212:215], v[148:151], v[80:95]
    v_mfma_f32_32x32x16_bf16 v[80:95], a[228:231], v[152:155], v[80:95]
    v_mfma_f32_32x32x16_bf16 v[80:95], a[244:247], v[156:159], v[80:95]
    v_mfma_f32_32x32x16_bf16 v[96:111], a[184:187], v[140:143], v[96:111]
    s_nop 6
    v_mul_f32 v64, s8, v64
    v_mul_f32 v65, s8, v65
    v_cvt_pk_bf16_f32 v176, v64, v65
    v_mul_f32 v66, s8, v66
    v_mul_f32 v67, s8, v67
    v_mfma_f32_32x32x16_bf16 v[96:111], a[200:203], v[144:147], v[96:111]
    v_cvt_pk_bf16_f32 v177, v66, v67
    v_mul_f32 v68, s8, v68
    v_mul_f32 v69, s8, v69
    v_cvt_pk_bf16_f32 v178, v68, v69
    v_mul_f32 v70, s8, v70
    v_mfma_f32_32x32x16_bf16 v[96:111], a[216:219], v[148:151], v[96:111]
    v_mul_f32 v71, s8, v71
    v_cvt_pk_bf16_f32 v179, v70, v71
    v_mul_f32 v72, s8, v72
    v_mul_f32 v73, s8, v73
    v_cvt_pk_bf16_f32 v180, v72, v73
    v_mfma_f32_32x32x16_bf16 v[96:111], a[232:235], v[152:155], v[96:111]
    v_mul_f32 v74, s8, v74
    v_mul_f32 v75, s8, v75
    v_cvt_pk_bf16_f32 v181, v74, v75
    v_mul_f32 v76, s8, v76
    v_mul_f32 v77, s8, v77
    v_mfma_f32_32x32x16_bf16 v[96:111], a[248:251], v[156:159], v[96:111]
    v_cvt_pk_bf16_f32 v182, v76, v77
    v_mul_f32 v78, s8, v78
    v_mul_f32 v79, s8, v79
    v_cvt_pk_bf16_f32 v183, v78, v79
    v_mfma_f32_32x32x16_bf16 v[112:127], a[188:191], v[140:143], v[112:127]
    v_mul_f32 v80, s8, v80
    v_mul_f32 v81, s8, v81
    v_cvt_pk_bf16_f32 v184, v80, v81
    v_mul_f32 v82, s8, v82
    v_mul_f32 v83, s8, v83
    v_mfma_f32_32x32x16_bf16 v[112:127], a[204:207], v[144:147], v[112:127]
    v_cvt_pk_bf16_f32 v185, v82, v83
    v_mul_f32 v84, s8, v84
    v_mul_f32 v85, s8, v85
    v_cvt_pk_bf16_f32 v186, v84, v85
    v_mul_f32 v86, s8, v86
    v_mfma_f32_32x32x16_bf16 v[112:127], a[220:223], v[148:151], v[112:127]
    v_mul_f32 v87, s8, v87
    v_cvt_pk_bf16_f32 v187, v86, v87
    v_mul_f32 v88, s8, v88
    v_mul_f32 v89, s8, v89
    v_cvt_pk_bf16_f32 v188, v88, v89
    v_mfma_f32_32x32x16_bf16 v[112:127], a[236:239], v[152:155], v[112:127]
    v_mul_f32 v90, s8, v90
    v_mul_f32 v91, s8, v91
    v_cvt_pk_bf16_f32 v189, v90, v91
    v_mul_f32 v92, s8, v92
    v_mul_f32 v93, s8, v93
    v_mfma_f32_32x32x16_bf16 v[112:127], a[252:255], v[156:159], v[112:127]
    v_cvt_pk_bf16_f32 v190, v92, v93
    v_mul_f32 v94, s8, v94
    v_mul_f32 v95, s8, v95
    v_cvt_pk_bf16_f32 v191, v94, v95
    v_mul_f32 v96, s8, v96
    v_mul_f32 v97, s8, v97
    v_cvt_pk_bf16_f32 v192, v96, v97
    v_mul_f32 v98, s8, v98
    v_mul_f32 v99, s8, v99
    v_cvt_pk_bf16_f32 v193, v98, v99
    v_mul_f32 v100, s8, v100
    v_mul_f32 v101, s8, v101
    v_cvt_pk_bf16_f32 v194, v100, v101
    v_mul_f32 v102, s8, v102
    v_mul_f32 v103, s8, v103
    v_cvt_pk_bf16_f32 v195, v102, v103
    v_mul_f32 v104, s8, v104
    v_mul_f32 v105, s8, v105
    v_cvt_pk_bf16_f32 v196, v104, v105
    v_mul_f32 v106, s8, v106
    v_mul_f32 v107, s8, v107
    v_cvt_pk_bf16_f32 v197, v106, v107
    v_mul_f32 v108, s8, v108
    v_mul_f32 v109, s8, v109
    v_cvt_pk_bf16_f32 v198, v108, v109
    v_mul_f32 v110, s8, v110
    v_mul_f32 v111, s8, v111
    v_cvt_pk_bf16_f32 v199, v110, v111
    v_mul_f32 v112, s8, v112
    v_mul_f32 v113, s8, v113
    v_cvt_pk_bf16_f32 v200, v112, v113
    v_mul_f32 v114, s8, v114
    v_mul_f32 v115, s8, v115
    v_cvt_pk_bf16_f32 v201, v114, v115
    v_mul_f32 v116, s8, v116
    v_mul_f32 v117, s8, v117
    v_cvt_pk_bf16_f32 v202, v116, v117
    v_mul_f32 v118, s8, v118
    v_mul_f32 v119, s8, v119
    v_cvt_pk_bf16_f32 v203, v118, v119
    v_mul_f32 v120, s8, v120
    v_mul_f32 v121, s8, v121
    v_cvt_pk_bf16_f32 v204, v120, v121
    v_mul_f32 v122, s8, v122
    v_mul_f32 v123, s8, v123
    v_cvt_pk_bf16_f32 v205, v122, v123
    v_mul_f32 v124, s8, v124
    v_mul_f32 v125, s8, v125
    v_cvt_pk_bf16_f32 v206, v124, v125
    v_mul_f32 v126, s8, v126
    v_mul_f32 v127, s8, v127
    v_cvt_pk_bf16_f32 v207, v126, v127
    v_mfma_f32_32x32x16_bf16 v[128:143], a[0:3], v[176:179], v[32:47]
    v_mov_b32 v64, 0
    v_mov_b32 v65, 0
    v_mov_b32 v66, 0
    v_mov_b32 v67, 0
    v_mov_b32 v68, 0
    v_mfma_f32_32x32x16_bf16 v[128:143], a[4:7], v[180:183], v[128:143]
    v_mov_b32 v69, 0
    v_mov_b32 v70, 0
    v_mov_b32 v71, 0
    v_mov_b32 v72, 0
    v_mov_b32 v73, 0
    v_mfma_f32_32x32x16_bf16 v[128:143], a[8:11], v[184:187], v[128:143]
    v_mov_b32 v74, 0
    v_mov_b32 v75, 0
    v_mov_b32 v76, 0
    v_mov_b32 v77, 0
    v_mov_b32 v78, 0
    v_mfma_f32_32x32x16_bf16 v[128:143], a[12:15], v[188:191], v[128:143]
    v_mov_b32 v79, 0
    v_mov_b32 v80, 0
    v_mov_b32 v81, 0
    v_mov_b32 v82, 0
    v_mov_b32 v83, 0
    v_mfma_f32_32x32x16_bf16 v[128:143], a[16:19], v[192:195], v[128:143]
    v_mov_b32 v84, 0
    v_mov_b32 v85, 0
    v_mov_b32 v86, 0
    v_mov_b32 v87, 0
    v_mov_b32 v88, 0
    v_mfma_f32_32x32x16_bf16 v[128:143], a[20:23], v[196:199], v[128:143]
    v_mov_b32 v89, 0
    v_mov_b32 v90, 0
    v_mov_b32 v91, 0
    v_mov_b32 v92, 0
    v_mov_b32 v93, 0
    v_mfma_f32_32x32x16_bf16 v[128:143], a[24:27], v[200:203], v[128:143]
    v_mov_b32 v94, 0
    v_mov_b32 v95, 0
    v_mov_b32 v96, 0
    v_mov_b32 v97, 0
    v_mov_b32 v98, 0
    v_mfma_f32_32x32x16_bf16 v[128:143], a[28:31], v[204:207], v[128:143]
    v_mov_b32 v99, 0
    v_mov_b32 v100, 0
    v_mov_b32 v101, 0
    v_mov_b32 v102, 0
    v_mov_b32 v103, 0
    v_mfma_f32_32x32x16_bf16 v[144:159], a[32:35], v[176:179], v[32:47]
    v_mov_b32 v104, 0
    v_mov_b32 v105, 0
    v_mov_b32 v106, 0
    v_mov_b32 v107, 0
    v_mfma_f32_32x32x16_bf16 v[144:159], a[36:39], v[180:183], v[144:159]
    v_mov_b32 v108, 0
    v_mov_b32 v109, 0
    v_mov_b32 v110, 0
    v_mov_b32 v111, 0
    v_mfma_f32_32x32x16_bf16 v[144:159], a[40:43], v[184:187], v[144:159]
    v_mov_b32 v112, 0
    v_mov_b32 v113, 0
    v_mov_b32 v114, 0
    v_mov_b32 v115, 0
    v_mfma_f32_32x32x16_bf16 v[144:159], a[44:47], v[188:191], v[144:159]
    v_mov_b32 v116, 0
    v_mov_b32 v117, 0
    v_mov_b32 v118, 0
    v_mov_b32 v119, 0
    v_mfma_f32_32x32x16_bf16 v[144:159], a[48:51], v[192:195], v[144:159]
    v_mov_b32 v120, 0
    v_mov_b32 v121, 0
    v_mov_b32 v122, 0
    v_mov_b32 v123, 0
    v_mfma_f32_32x32x16_bf16 v[144:159], a[52:55], v[196:199], v[144:159]
    v_mov_b32 v124, 0
    v_mov_b32 v125, 0
    v_mov_b32 v126, 0
    v_mov_b32 v127, 0
    v_mfma_f32_32x32x16_bf16 v[144:159], a[56:59], v[200:203], v[144:159]
    v_max3_f32 v244, v128, v129, v130
    v_max3_f32 v244, v131, v132, v244
    v_max3_f32 v244, v133, v134, v244
    v_max3_f32 v244, v135, v136, v244
    v_mfma_f32_32x32x16_bf16 v[144:159], a[60:63], v[204:207], v[144:159]
    v_max3_f32 v244, v137, v138, v244
    v_max3_f32 v244, v139, v140, v244
    v_max3_f32 v244, v141, v142, v244
    v_max_f32 v244, v143, v244
    s_nop 7
    v_max3_f32 v244, v144, v145, v244
    v_max3_f32 v244, v146, v147, v244
    v_max3_f32 v244, v148, v149, v244
    v_max3_f32 v244, v150, v151, v244
    v_max3_f32 v244, v152, v153, v244
    v_max3_f32 v244, v154, v155, v244
    v_max3_f32 v244, v156, v157, v244
    v_max3_f32 v244, v158, v159, v244
    v_mov_b32 v245, v244
    s_nop 1
    v_permlane32_swap_b32 v244, v245
    v_max_f32 v244, v244, v245
    v_sub_f32 v128, v128, v244
    v_sub_f32 v129, v129, v244
    v_sub_f32 v130, v130, v244
    v_sub_f32 v131, v131, v244
    v_sub_f32 v132, v132, v244
    v_sub_f32 v133, v133, v244
    v_sub_f32 v134, v134, v244
    v_sub_f32 v135, v135, v244
    v_sub_f32 v136, v136, v244
    v_sub_f32 v137, v137, v244
    v_sub_f32 v138, v138, v244
    v_sub_f32 v139, v139, v244
    v_sub_f32 v140, v140, v244
    v_sub_f32 v141, v141, v244
    v_sub_f32 v142, v142, v244
    v_sub_f32 v143, v143, v244
    v_sub_f32 v144, v144, v244
    v_sub_f32 v145, v145, v244
    v_sub_f32 v146, v146, v244
    v_sub_f32 v147, v147, v244
    v_sub_f32 v148, v148, v244
    v_sub_f32 v149, v149, v244
    v_sub_f32 v150, v150, v244
    v_sub_f32 v151, v151, v244
    v_sub_f32 v152, v152, v244
    v_sub_f32 v153, v153, v244
    v_sub_f32 v154, v154, v244
    v_sub_f32 v155, v155, v244
    v_sub_f32 v156, v156, v244
    v_sub_f32 v157, v157, v244
    v_sub_f32 v158, v158, v244
    v_sub_f32 v159, v159, v244
    v_sub_f32 v32, v32, v244
    v_sub_f32 v33, v33, v244
    v_sub_f32 v34, v34, v244
    v_sub_f32 v35, v35, v244
    v_sub_f32 v36, v36, v244
    v_sub_f32 v37, v37, v244
    v_sub_f32 v38, v38, v244
    v_sub_f32 v39, v39, v244
    v_sub_f32 v40, v40, v244
    v_sub_f32 v41, v41, v244
    v_sub_f32 v42, v42, v244
    v_sub_f32 v43, v43, v244
    v_sub_f32 v44, v44, v244
    v_sub_f32 v45, v45, v244
    v_sub_f32 v46, v46, v244
    v_sub_f32 v47, v47, v244
    ds_read_b32 v246, v247
    v_exp_f32 v128, v128
    v_exp_f32 v129, v129
    v_exp_f32 v130, v130
    v_exp_f32 v131, v131
    v_cvt_pk_bf16_f32 v160, v128, v129
    v_exp_f32 v132, v132
    v_exp_f32 v133, v133
    v_cvt_pk_bf16_f32 v161, v130, v131
    v_exp_f32 v134, v134
    v_exp_f32 v135, v135
    v_cvt_pk_bf16_f32 v162, v132, v133
    v_exp_f32 v136, v136
    v_exp_f32 v137, v137
    v_cvt_pk_bf16_f32 v163, v134, v135
    v_exp_f32 v138, v138
    v_exp_f32 v139, v139
    v_cvt_pk_bf16_f32 v164, v136, v137
    v_exp_f32 v140, v140
    v_exp_f32 v141, v141
    v_cvt_pk_bf16_f32 v165, v138, v139
    v_exp_f32 v142, v142
    v_exp_f32 v143, v143
    v_cvt_pk_bf16_f32 v166, v140, v141
    v_cvt_pk_bf16_f32 v167, v142, v143
    v_exp_f32 v144, v144
    v_exp_f32 v145, v145
    v_exp_f32 v146, v146
    v_exp_f32 v147, v147
    s_waitcnt lgkmcnt(0)
    v_cmp_le_u32 vcc, 11, v246
    s_cbranch_vccz L_st_75
L_bk_76:
    v_mfma_f32_32x32x16_bf16 v[128:143], a[64:67], v[176:179], v[32:47]
    ds_read_b128 a[0:3], v208 offset:32768
    v_cvt_pk_bf16_f32 v168, v144, v145
    v_cvt_pk_bf16_f32 v169, v146, v147
    v_exp_f32 v148, v148
    v_mfma_f32_32x32x16_bf16 v[128:143], a[68:71], v[180:183], v[128:143]
    ds_read_b128 a[4:7], v209 offset:32768
    v_exp_f32 v149, v149
    v_exp_f32 v150, v150
    v_mfma_f32_32x32x16_bf16 v[128:143], a[72:75], v[184:187], v[128:143]
    ds_read_b128 a[8:11], v210 offset:32768
    v_exp_f32 v151, v151
    v_cvt_pk_bf16_f32 v170, v148, v149
    v_exp_f32 v152, v152
    v_mfma_f32_32x32x16_bf16 v[128:143], a[76:79], v[188:191], v[128:143]
    ds_read_b128 a[12:15], v211 offset:32768
    v_exp_f32 v153, v153
    v_cvt_pk_bf16_f32 v171, v150, v151
    v_mfma_f32_32x32x16_bf16 v[128:143], a[80:83], v[192:195], v[128:143]
    ds_read_b128 a[16:19], v212 offset:32768
    v_exp_f32 v154, v154
    v_exp_f32 v155, v155
    v_mfma_f32_32x32x16_bf16 v[128:143], a[84:87], v[196:199], v[128:143]
    ds_read_b128 a[20:23], v213 offset:32768
    v_cvt_pk_bf16_f32 v172, v152, v153
    v_exp_f32 v156, v156
    v_exp_f32 v157, v157
    v_mfma_f32_32x32x16_bf16 v[128:143], a[88:91], v[200:203], v[128:143]
    ds_read_b128 a[24:27], v214 offset:32768
    v_cvt_pk_bf16_f32 v173, v154, v155
    v_exp_f32 v158, v158
    v_mfma_f32_32x32x16_bf16 v[128:143], a[92:95], v[204:207], v[128:143]
    ds_read_b128 a[28:31], v215 offset:32768
    v_exp_f32 v159, v159
    v_cvt_pk_bf16_f32 v174, v156, v157
    v_cvt_pk_bf16_f32 v175, v158, v159
    v_mfma_f32_32x32x16_bf16 v[144:159], a[96:99], v[176:179], v[32:47]
    s_nop 3
    v_mfma_f32_32x32x16_bf16 v[144:159], a[100:103], v[180:183], v[144:159]
    s_nop 3
    v_max3_f32 v244, v128, v129, v130
    v_mfma_f32_32x32x16_bf16 v[144:159], a[104:107], v[184:187], v[144:159]
    v_max3_f32 v244, v131, v132, v244
    v_mfma_f32_32x32x16_bf16 v[144:159], a[108:111], v[188:191], v[144:159]
    v_max3_f32 v244, v133, v134, v244
    v_mfma_f32_32x32x16_bf16 v[144:159], a[112:115], v[192:195], v[144:159]
    v_max3_f32 v244, v135, v136, v244
    v_mfma_f32_32x32x16_bf16 v[144:159], a[116:119], v[196:199], v[144:159]
    v_max3_f32 v244, v137, v138, v244
    v_max3_f32 v244, v139, v140, v244
    v_mfma_f32_32x32x16_bf16 v[144:159], a[120:123], v[200:203], v[144:159]
    v_max3_f32 v244, v141, v142, v244
    v_mfma_f32_32x32x16_bf16 v[144:159], a[124:127], v[204:207], v[144:159]
    v_max_f32 v244, v143, v244
    s_nop 10
    v_max3_f32 v244, v144, v145, v244
    v_max3_f32 v244, v146, v147, v244
    v_max3_f32 v244, v148, v149, v244
    v_max3_f32 v244, v150, v151, v244
    v_max3_f32 v244, v152, v153, v244
    v_max3_f32 v244, v154, v155, v244
    v_max3_f32 v244, v156, v157, v244
    v_max3_f32 v244, v158, v159, v244
    v_cmp_lt_f32 vcc, s5, v244
    s_cbranch_vccnz L_st_77
L_bk_78:
    v_exp_f32 v128, v128
    v_exp_f32 v129, v129
    v_exp_f32 v130, v130
    v_exp_f32 v131, v131
    v_cvt_pk_bf16_f32 v12, v128, v129
    v_exp_f32 v132, v132
    v_exp_f32 v133, v133
    v_cvt_pk_bf16_f32 v13, v130, v131
    v_exp_f32 v134, v134
    v_exp_f32 v135, v135
    v_cvt_pk_bf16_f32 v14, v132, v133
    v_exp_f32 v136, v136
    v_exp_f32 v137, v137
    v_cvt_pk_bf16_f32 v15, v134, v135
    v_exp_f32 v138, v138
    v_exp_f32 v139, v139
    v_cvt_pk_bf16_f32 v16, v136, v137
    v_exp_f32 v140, v140
    v_exp_f32 v141, v141
    v_cvt_pk_bf16_f32 v17, v138, v139
    v_exp_f32 v142, v142
    v_exp_f32 v143, v143
    v_cvt_pk_bf16_f32 v18, v140, v141
    v_cvt_pk_bf16_f32 v19, v142, v143
    v_exp_f32 v144, v144
    v_exp_f32 v145, v145
    v_exp_f32 v146, v146
    v_exp_f32 v147, v147
    s_waitcnt lgkmcnt(0)
    v_mfma_f32_32x32x16_bf16 v[128:143], a[0:3], v[176:179], v[32:47]
    ds_read_b128 a[32:35], v208 offset:40960
    v_cvt_pk_bf16_f32 v20, v144, v145
    v_cvt_pk_bf16_f32 v21, v146, v147
    v_exp_f32 v148, v148
    v_mfma_f32_32x32x16_bf16 v[128:143], a[4:7], v[180:183], v[128:143]
    ds_read_b128 a[36:39], v209 offset:40960
    ds_read_b128 a[40:43], v210 offset:40960
    v_exp_f32 v149, v149
    v_exp_f32 v150, v150
    v_mfma_f32_32x32x16_bf16 v[128:143], a[8:11], v[184:187], v[128:143]
    ds_read_b128 a[44:47], v211 offset:40960
    v_exp_f32 v151, v151
    v_cvt_pk_bf16_f32 v22, v148, v149
    v_mfma_f32_32x32x16_bf16 v[128:143], a[12:15], v[188:191], v[128:143]
    ds_read_b32 v246, v247
    v_exp_f32 v152, v152
    v_exp_f32 v153, v153
    v_cvt_pk_bf16_f32 v23, v150, v151
    v_mfma_f32_32x32x16_bf16 v[128:143], a[16:19], v[192:195], v[128:143]
    ds_read_b128 a[48:51], v212 offset:40960
    v_exp_f32 v154, v154
    v_exp_f32 v155, v155
    v_mfma_f32_32x32x16_bf16 v[128:143], a[20:23], v[196:199], v[128:143]
    ds_read_b128 a[52:55], v213 offset:40960
    v_cvt_pk_bf16_f32 v24, v152, v153
    v_exp_f32 v156, v156
    v_exp_f32 v157, v157
    v_mfma_f32_32x32x16_bf16 v[128:143], a[24:27], v[200:203], v[128:143]
    ds_read_b128 a[56:59], v214 offset:40960
    v_cvt_pk_bf16_f32 v25, v154, v155
    v_exp_f32 v158, v158
    v_mfma_f32_32x32x16_bf16 v[128:143], a[28:31], v[204:207], v[128:143]
    ds_read_b128 a[60:63], v215 offset:40960
    v_exp_f32 v159, v159
    s_waitcnt lgkmcnt(4)
    v_cmp_le_u32 vcc, 22, v246
    v_cvt_pk_bf16_f32 v26, v156, v157
    v_cvt_pk_bf16_f32 v27, v158, v159
    v_mfma_f32_32x32x16_bf16 v[144:159], a[32:35], v[176:179], v[32:47]
    s_cbranch_vccz L_st_79
L_bk_80:
    ds_read_b64_tr_b16 a[64:65], v224 offset:0
    ds_read_b64_tr_b16 a[66:67], v224 offset:2048
    v_mfma_f32_32x32x16_bf16 v[144:159], a[36:39], v[180:183], v[144:159]
    ds_read_b64_tr_b16 a[68:69], v225 offset:0
    ds_read_b64_tr_b16 a[70:71], v225 offset:2048
    ds_read_b64_tr_b16 a[72:73], v226 offset:0
    v_mfma_f32_32x32x16_bf16 v[144:159], a[40:43], v[184:187], v[144:159]
    ds_read_b64_tr_b16 a[74:75], v226 offset:2048
    v_max3_f32 v244, v128, v129, v130
    v_max3_f32 v244, v131, v132, v244
    v_mfma_f32_32x32x16_bf16 v[144:159], a[44:47], v[188:191], v[144:159]
    ds_read_b64_tr_b16 a[76:77], v227 offset:0
    ds_read_b64_tr_b16 a[78:79], v227 offset:2048
    ds_read_b64_tr_b16 a[80:81], v224 offset:4096
    v_max3_f32 v244, v133, v134, v244
    s_waitcnt lgkmcnt(12)
    v_mfma_f32_32x32x16_bf16 v[144:159], a[48:51], v[192:195], v[144:159]
    ds_read_b64_tr_b16 a[82:83], v224 offset:6144
    ds_read_b64_tr_b16 a[84:85], v225 offset:4096
    v_max3_f32 v244, v135, v136, v244
    s_waitcnt lgkmcnt(13)
    v_mfma_f32_32x32x16_bf16 v[144:159], a[52:55], v[196:199], v[144:159]
    ds_read_b64_tr_b16 a[86:87], v225 offset:6144
    v_max3_f32 v244, v137, v138, v244
    v_max3_f32 v244, v139, v140, v244
    s_waitcnt lgkmcnt(13)
    v_mfma_f32_32x32x16_bf16 v[144:159], a[56:59], v[200:203], v[144:159]
    ds_read_b64_tr_b16 a[88:89], v226 offset:4096
    ds_read_b64_tr_b16 a[90:91], v226 offset:6144
    v_max3_f32 v244, v141, v142, v244
    s_waitcnt lgkmcnt(14)
    v_mfma_f32_32x32x16_bf16 v[144:159], a[60:63], v[204:207], v[144:159]
    ds_read_b64_tr_b16 a[92:93], v227 offset:4096
    ds_read_b64_tr_b16 a[94:95], v227 offset:6144
    v_max_f32 v244, v143, v244
    s_waitcnt lgkmcnt(8)
    v_mfma_f32_32x32x16_bf16 v[64:79], a[64:67], v[160:163], v[64:79]
    ds_read_b64_tr_b16 a[96:97], v224 offset:8192
    ds_read_b64_tr_b16 a[98:99], v224 offset:10240
    ds_read_b64_tr_b16 a[100:101], v225 offset:8192
    ds_read_b64_tr_b16 a[102:103], v225 offset:10240
    v_mfma_f32_32x32x16_bf16 v[80:95], a[68:71], v[160:163], v[80:95]
    ds_read_b64_tr_b16 a[104:105], v226 offset:8192
    ds_read_b64_tr_b16 a[106:107], v226 offset:10240
    v_max3_f32 v244, v144, v145, v244
    v_max3_f32 v244, v146, v147, v244
    v_mfma_f32_32x32x16_bf16 v[96:111], a[72:75], v[160:163], v[96:111]
    ds_read_b64_tr_b16 a[108:109], v227 offset:8192
    ds_read_b64_tr_b16 a[110:111], v227 offset:10240
    v_max3_f32 v244, v148, v149, v244
    v_max3_f32 v244, v150, v151, v244
    v_mfma_f32_32x32x16_bf16 v[112:127], a[76:79], v[160:163], v[112:127]
    ds_read_b32 v246, v247
    v_max3_f32 v244, v152, v153, v244
    v_max3_f32 v244, v154, v155, v244
    v_max3_f32 v244, v156, v157, v244
    v_mfma_f32_16x16x32_bf16 v[48:51], v[52:55], v[160:163], v[48:51]
    ds_read_b64_tr_b16 a[112:113], v224 offset:12288
    s_waitcnt lgkmcnt(15)
    v_mfma_f32_32x32x16_bf16 v[64:79], a[80:83], v[164:167], v[64:79]
    ds_read_b64_tr_b16 a[114:115], v224 offset:14336
    ds_read_b64_tr_b16 a[116:117], v225 offset:12288
    v_max3_f32 v244, v158, v159, v244
    v_cmp_lt_f32 vcc, s5, v244
    s_waitcnt lgkmcnt(15)
    v_mfma_f32_32x32x16_bf16 v[80:95], a[84:87], v[164:167], v[80:95]
    s_cbranch_vccnz L_st_81
L_bk_82:
    ds_read_b64_tr_b16 a[118:119], v225 offset:14336
    ds_read_b64_tr_b16 a[120:121], v226 offset:12288
    v_exp_f32 v128, v128
    s_waitcnt lgkmcnt(15)
    v_mfma_f32_32x32x16_bf16 v[96:111], a[88:91], v[164:167], v[96:111]
    ds_read_b64_tr_b16 a[122:123], v226 offset:14336
    ds_read_b64_tr_b16 a[124:125], v227 offset:12288
    v_exp_f32 v129, v129
    s_waitcnt lgkmcnt(7)
    v_cmp_le_u32 vcc, 23, v246
    v_mfma_f32_32x32x16_bf16 v[112:127], a[92:95], v[164:167], v[112:127]
    ds_read_b64_tr_b16 a[126:127], v227 offset:14336
    v_exp_f32 v130, v130
    v_exp_f32 v131, v131
    v_mfma_f32_16x16x32_bf16 v[48:51], v[52:55], v[164:167], v[48:51]
    v_mov_b32 v249, 6
    v_mfma_f32_32x32x16_bf16 v[64:79], a[96:99], v[168:171], v[64:79]
    s_cbranch_vccz L_st_83
L_bk_84:
    v_cvt_pk_bf16_f32 v160, v128, v129
    v_exp_f32 v132, v132
    v_exp_f32 v133, v133
    v_mfma_f32_32x32x16_bf16 v[80:95], a[100:103], v[168:171], v[80:95]
    v_cvt_pk_bf16_f32 v161, v130, v131
    s_waitcnt lgkmcnt(0)
    ds_write_b32 v248, v249
    ds_read_b128 a[0:3], v208 offset:49152
    v_exp_f32 v134, v134
    v_mfma_f32_32x32x16_bf16 v[96:111], a[104:107], v[168:171], v[96:111]
    ds_read_b128 a[4:7], v209 offset:49152
    v_exp_f32 v135, v135
    v_cvt_pk_bf16_f32 v162, v132, v133
    v_exp_f32 v136, v136
    v_mfma_f32_32x32x16_bf16 v[112:127], a[108:111], v[168:171], v[112:127]
    ds_read_b128 a[8:11], v210 offset:49152
    v_exp_f32 v137, v137
    v_cvt_pk_bf16_f32 v163, v134, v135
    v_exp_f32 v138, v138
    v_mfma_f32_16x16x32_bf16 v[48:51], v[52:55], v[168:171], v[48:51]
    ds_read_b128 a[12:15], v211 offset:49152
    v_exp_f32 v139, v139
    v_mfma_f32_32x32x16_bf16 v[64:79], a[112:115], v[172:175], v[64:79]
    ds_read_b128 a[16:19], v212 offset:49152
    v_cvt_pk_bf16_f32 v164, v136, v137
    v_exp_f32 v140, v140
    v_exp_f32 v141, v141
    v_mfma_f32_32x32x16_bf16 v[80:95], a[116:119], v[172:175], v[80:95]
    ds_read_b128 a[20:23], v213 offset:49152
    ds_read_b128 a[24:27], v214 offset:49152
    v_cvt_pk_bf16_f32 v165, v138, v139
    v_exp_f32 v142, v142
    v_mfma_f32_32x32x16_bf16 v[96:111], a[120:123], v[172:175], v[96:111]
    ds_read_b128 a[28:31], v215 offset:49152
    v_exp_f32 v143, v143
    v_cvt_pk_bf16_f32 v166, v140, v141
    v_exp_f32 v144, v144
    v_mfma_f32_32x32x16_bf16 v[112:127], a[124:127], v[172:175], v[112:127]
    v_exp_f32 v145, v145
    v_cvt_pk_bf16_f32 v167, v142, v143
    v_exp_f32 v146, v146
    v_mfma_f32_16x16x32_bf16 v[48:51], v[52:55], v[172:175], v[48:51]
    v_exp_f32 v147, v147
    s_bitcmp1_b32 s4, 1
    s_cbranch_scc1 L_st_85
L_bk_86:
    s_waitcnt lgkmcnt(0)
    v_mfma_f32_32x32x16_bf16 v[128:143], a[0:3], v[176:179], v[32:47]
    ds_read_b128 a[32:35], v208 offset:57344
    v_cvt_pk_bf16_f32 v168, v144, v145
    v_cvt_pk_bf16_f32 v169, v146, v147
    v_exp_f32 v148, v148
    v_mfma_f32_32x32x16_bf16 v[128:143], a[4:7], v[180:183], v[128:143]
    ds_read_b128 a[36:39], v209 offset:57344
    ds_read_b128 a[40:43], v210 offset:57344
    v_exp_f32 v149, v149
    v_exp_f32 v150, v150
    v_mfma_f32_32x32x16_bf16 v[128:143], a[8:11], v[184:187], v[128:143]
    ds_read_b128 a[44:47], v211 offset:57344
    v_exp_f32 v151, v151
    v_cvt_pk_bf16_f32 v170, v148, v149
    v_mfma_f32_32x32x16_bf16 v[128:143], a[12:15], v[188:191], v[128:143]
    ds_read_b32 v246, v247
    v_exp_f32 v152, v152
    v_exp_f32 v153, v153
    v_cvt_pk_bf16_f32 v171, v150, v151
    v_mfma_f32_32x32x16_bf16 v[128:143], a[16:19], v[192:195], v[128:143]
    ds_read_b128 a[48:51], v212 offset:57344
    v_exp_f32 v154, v154
    v_exp_f32 v155, v155
    v_mfma_f32_32x32x16_bf16 v[128:143], a[20:23], v[196:199], v[128:143]
    ds_read_b128 a[52:55], v213 offset:57344
    v_cvt_pk_bf16_f32 v172, v152, v153
    v_exp_f32 v156, v156
    v_exp_f32 v157, v157
    v_mfma_f32_32x32x16_bf16 v[128:143], a[24:27], v[200:203], v[128:143]
    ds_read_b128 a[56:59], v214 offset:57344
    v_cvt_pk_bf16_f32 v173, v154, v155
    v_exp_f32 v158, v158
    v_mfma_f32_32x32x16_bf16 v[128:143], a[28:31], v[204:207], v[128:143]
    ds_read_b128 a[60:63], v215 offset:57344
    v_exp_f32 v159, v159
    s_waitcnt lgkmcnt(4)
    v_cmp_le_u32 vcc, 26, v246
    v_cvt_pk_bf16_f32 v174, v156, v157
    v_cvt_pk_bf16_f32 v175, v158, v159
    v_mfma_f32_32x32x16_bf16 v[144:159], a[32:35], v[176:179], v[32:47]
    s_cbranch_vccz L_st_87
L_bk_88:
    ds_read_b64_tr_b16 a[64:65], v224 offset:16384
    ds_read_b64_tr_b16 a[66:67], v224 offset:18432
    ds_read_b64_tr_b16 a[68:69], v225 offset:16384
    v_mfma_f32_32x32x16_bf16 v[144:159], a[36:39], v[180:183], v[144:159]
    ds_read_b64_tr_b16 a[70:71], v225 offset:18432
    ds_read_b64_tr_b16 a[72:73], v226 offset:16384
    v_max3_f32 v244, v128, v129, v130
    v_mfma_f32_32x32x16_bf16 v[144:159], a[40:43], v[184:187], v[144:159]
    ds_read_b64_tr_b16 a[74:75], v226 offset:18432
    ds_read_b64_tr_b16 a[76:77], v227 offset:16384
    ds_read_b64_tr_b16 a[78:79], v227 offset:18432
    v_max3_f32 v244, v131, v132, v244
    v_mfma_f32_32x32x16_bf16 v[144:159], a[44:47], v[188:191], v[144:159]
    ds_read_b64_tr_b16 a[80:81], v224 offset:20480
    ds_read_b64_tr_b16 a[82:83], v224 offset:22528
    ds_read_b64_tr_b16 a[84:85], v225 offset:20480
    v_max3_f32 v244, v133, v134, v244
    s_waitcnt lgkmcnt(14)
    v_mfma_f32_32x32x16_bf16 v[144:159], a[48:51], v[192:195], v[144:159]
    ds_read_b64_tr_b16 a[86:87], v225 offset:22528
    ds_read_b64_tr_b16 a[88:89], v226 offset:20480
    v_max3_f32 v244, v135, v136, v244
    s_waitcnt lgkmcnt(15)
    v_mfma_f32_32x32x16_bf16 v[144:159], a[52:55], v[196:199], v[144:159]
    ds_read_b64_tr_b16 a[90:91], v226 offset:22528
    ds_read_b64_tr_b16 a[92:93], v227 offset:20480
    v_max3_f32 v244, v137, v138, v244
    v_max3_f32 v244, v139, v140, v244
    s_waitcnt lgkmcnt(15)
    v_mfma_f32_32x32x16_bf16 v[144:159], a[56:59], v[200:203], v[144:159]
    ds_read_b64_tr_b16 a[94:95], v227 offset:22528
    ds_read_b64_tr_b16 a[128:129], v232 offset:0
    v_max3_f32 v244, v141, v142, v244
    v_mfma_f32_32x32x16_bf16 v[144:159], a[60:63], v[204:207], v[144:159]
    ds_read_b64_tr_b16 a[130:131], v232 offset:2048
    ds_read_b64_tr_b16 a[132:133], v232 offset:8
    ds_read_b64_tr_b16 a[134:135], v232 offset:2056
    v_max_f32 v244, v143, v244
    s_waitcnt lgkmcnt(12)
    v_mfma_f32_32x32x16_bf16 v[64:79], a[64:67], v[12:15], v[64:79]
    ds_read_b64_tr_b16 a[96:97], v224 offset:24576
    ds_read_b64_tr_b16 a[98:99], v224 offset:26624
    ds_read_b64_tr_b16 a[100:101], v225 offset:24576
    ds_read_b64_tr_b16 a[102:103], v225 offset:26624
    v_mfma_f32_32x32x16_bf16 v[80:95], a[68:71], v[12:15], v[80:95]
    ds_read_b64_tr_b16 a[104:105], v226 offset:24576
    ds_read_b64_tr_b16 a[106:107], v226 offset:26624
    v_max3_f32 v244, v144, v145, v244
    v_max3_f32 v244, v146, v147, v244
    v_mfma_f32_32x32x16_bf16 v[96:111], a[72:75], v[12:15], v[96:111]
    ds_read_b64_tr_b16 a[108:109], v227 offset:24576
    ds_read_b64_tr_b16 a[110:111], v227 offset:26624
    v_max3_f32 v244, v148, v149, v244
    v_max3_f32 v244, v150, v151, v244
    v_mfma_f32_32x32x16_bf16 v[112:127], a[76:79], v[12:15], v[112:127]
    ds_read_b32 v246, v247
    v_max3_f32 v244, v152, v153, v244
    v_max3_f32 v244, v154, v155, v244
    v_max3_f32 v244, v156, v157, v244
    v_mfma_f32_16x16x32_bf16 v[48:51], v[52:55], v[12:15], v[48:51]
    ds_read_b64_tr_b16 a[112:113], v224 offset:28672
    s_waitcnt lgkmcnt(15)
    v_mfma_f32_32x32x16_bf16 v[64:79], a[80:83], v[16:19], v[64:79]
    ds_read_b64_tr_b16 a[114:115], v224 offset:30720
    ds_read_b64_tr_b16 a[116:117], v225 offset:28672
    v_max3_f32 v244, v158, v159, v244
    v_cmp_lt_f32 vcc, s5, v244
    v_mfma_f32_32x32x16_bf16 v[80:95], a[84:87], v[16:19], v[80:95]
    s_cbranch_vccnz L_st_89
L_bk_90:
    ds_read_b64_tr_b16 a[118:119], v225 offset:30720
    ds_read_b64_tr_b16 a[120:121], v226 offset:28672
    v_exp_f32 v128, v128
    v_mfma_f32_32x32x16_bf16 v[96:111], a[88:91], v[16:19], v[96:111]
    ds_read_b64_tr_b16 a[122:123], v226 offset:30720
    ds_read_b64_tr_b16 a[124:125], v227 offset:28672
    v_exp_f32 v129, v129
    s_waitcnt lgkmcnt(7)
    v_cmp_le_u32 vcc, 28, v246
    v_mfma_f32_32x32x16_bf16 v[112:127], a[92:95], v[16:19], v[112:127]
    ds_read_b64_tr_b16 a[126:127], v227 offset:30720
    v_exp_f32 v130, v130
    v_exp_f32 v131, v131
    v_mfma_f32_16x16x32_bf16 v[48:51], v[52:55], v[16:19], v[48:51]
    v_mov_b32 v249, 7
    v_mfma_f32_32x32x16_bf16 v[64:79], a[96:99], v[20:23], v[64:79]
    s_cbranch_vccz L_st_91
L_bk_92:
    v_cvt_pk_bf16_f32 v12, v128, v129
    v_exp_f32 v132, v132
    v_exp_f32 v133, v133
    v_mfma_f32_32x32x16_bf16 v[80:95], a[100:103], v[20:23], v[80:95]
    v_cvt_pk_bf16_f32 v13, v130, v131
    s_waitcnt lgkmcnt(0)
    ds_write_b32 v248, v249
    ds_read_b128 a[0:3], v208 offset:0
    v_exp_f32 v134, v134
    v_mfma_f32_32x32x16_bf16 v[96:111], a[104:107], v[20:23], v[96:111]
    ds_read_b128 a[4:7], v209 offset:0
    v_exp_f32 v135, v135
    v_cvt_pk_bf16_f32 v14, v132, v133
    v_exp_f32 v136, v136
    v_mfma_f32_32x32x16_bf16 v[112:127], a[108:111], v[20:23], v[112:127]
    ds_read_b128 a[8:11], v210 offset:0
    v_exp_f32 v137, v137
    v_cvt_pk_bf16_f32 v15, v134, v135
    v_exp_f32 v138, v138
    v_mfma_f32_16x16x32_bf16 v[48:51], v[52:55], v[20:23], v[48:51]
    ds_read_b128 a[12:15], v211 offset:0
    v_exp_f32 v139, v139
    v_mfma_f32_32x32x16_bf16 v[64:79], a[112:115], v[24:27], v[64:79]
    ds_read_b128 a[16:19], v212 offset:0
    v_cvt_pk_bf16_f32 v16, v136, v137
    v_exp_f32 v140, v140
    v_exp_f32 v141, v141
    v_mfma_f32_32x32x16_bf16 v[80:95], a[116:119], v[24:27], v[80:95]
    ds_read_b128 a[20:23], v213 offset:0
    ds_read_b128 a[24:27], v214 offset:0
    v_cvt_pk_bf16_f32 v17, v138, v139
    v_exp_f32 v142, v142
    v_mfma_f32_32x32x16_bf16 v[96:111], a[120:123], v[24:27], v[96:111]
    ds_read_b128 a[28:31], v215 offset:0
    v_exp_f32 v143, v143
    v_cvt_pk_bf16_f32 v18, v140, v141
    v_exp_f32 v144, v144
    v_mfma_f32_32x32x16_bf16 v[112:127], a[124:127], v[24:27], v[112:127]
    v_exp_f32 v145, v145
    v_cvt_pk_bf16_f32 v19, v142, v143
    v_exp_f32 v146, v146
    v_mfma_f32_16x16x32_bf16 v[48:51], v[52:55], v[24:27], v[48:51]
    v_exp_f32 v147, v147
    s_bitcmp1_b32 s4, 0
    s_cbranch_scc1 L_st_93
L_bk_94:
    s_waitcnt lgkmcnt(0)
    v_mfma_f32_32x32x16_bf16 v[128:143], a[0:3], v[176:179], v[32:47]
    ds_read_b128 a[32:35], v208 offset:8192
    v_cvt_pk_bf16_f32 v20, v144, v145
    v_cvt_pk_bf16_f32 v21, v146, v147
    v_exp_f32 v148, v148
    v_mfma_f32_32x32x16_bf16 v[128:143], a[4:7], v[180:183], v[128:143]
    ds_read_b128 a[36:39], v209 offset:8192
    ds_read_b128 a[40:43], v210 offset:8192
    v_exp_f32 v149, v149
    v_exp_f32 v150, v150
    v_mfma_f32_32x32x16_bf16 v[128:143], a[8:11], v[184:187], v[128:143]
    ds_read_b128 a[44:47], v211 offset:8192
    v_exp_f32 v151, v151
    v_cvt_pk_bf16_f32 v22, v148, v149
    v_mfma_f32_32x32x16_bf16 v[128:143], a[12:15], v[188:191], v[128:143]
    ds_read_b32 v246, v247
    v_exp_f32 v152, v152
    v_exp_f32 v153, v153
    v_cvt_pk_bf16_f32 v23, v150, v151
    v_mfma_f32_32x32x16_bf16 v[128:143], a[16:19], v[192:195], v[128:143]
    ds_read_b128 a[48:51], v212 offset:8192
    v_exp_f32 v154, v154
    v_exp_f32 v155, v155
    v_mfma_f32_32x32x16_bf16 v[128:143], a[20:23], v[196:199], v[128:143]
    ds_read_b128 a[52:55], v213 offset:8192
    v_cvt_pk_bf16_f32 v24, v152, v153
    v_exp_f32 v156, v156
    v_exp_f32 v157, v157
    v_mfma_f32_32x32x16_bf16 v[128:143], a[24:27], v[200:203], v[128:143]
    ds_read_b128 a[56:59], v214 offset:8192
    v_cvt_pk_bf16_f32 v25, v154, v155
    v_exp_f32 v158, v158
    v_mfma_f32_32x32x16_bf16 v[128:143], a[28:31], v[204:207], v[128:143]
    ds_read_b128 a[60:63], v215 offset:8192
    v_exp_f32 v159, v159
    s_waitcnt lgkmcnt(4)
    v_cmp_le_u32 vcc, 31, v246
    v_cvt_pk_bf16_f32 v26, v156, v157
    v_cvt_pk_bf16_f32 v27, v158, v159
    v_mfma_f32_32x32x16_bf16 v[144:159], a[32:35], v[176:179], v[32:47]
    s_cbranch_vccz L_st_95
L_bk_96:
    ds_read_b64_tr_b16 a[64:65], v224 offset:32768
    ds_read_b64_tr_b16 a[66:67], v224 offset:34816
    ds_read_b64_tr_b16 a[68:69], v225 offset:32768
    v_mfma_f32_32x32x16_bf16 v[144:159], a[36:39], v[180:183], v[144:159]
    ds_read_b64_tr_b16 a[70:71], v225 offset:34816
    ds_read_b64_tr_b16 a[72:73], v226 offset:32768
    v_max3_f32 v244, v128, v129, v130
    v_mfma_f32_32x32x16_bf16 v[144:159], a[40:43], v[184:187], v[144:159]
    ds_read_b64_tr_b16 a[74:75], v226 offset:34816
    ds_read_b64_tr_b16 a[76:77], v227 offset:32768
    ds_read_b64_tr_b16 a[78:79], v227 offset:34816
    v_max3_f32 v244, v131, v132, v244
    v_mfma_f32_32x32x16_bf16 v[144:159], a[44:47], v[188:191], v[144:159]
    ds_read_b64_tr_b16 a[80:81], v224 offset:36864
    ds_read_b64_tr_b16 a[82:83], v224 offset:38912
    ds_read_b64_tr_b16 a[84:85], v225 offset:36864
    v_max3_f32 v244, v133, v134, v244
    s_waitcnt lgkmcnt(14)
    v_mfma_f32_32x32x16_bf16 v[144:159], a[48:51], v[192:195], v[144:159]
    ds_read_b64_tr_b16 a[86:87], v225 offset:38912
    ds_read_b64_tr_b16 a[88:89], v226 offset:36864
    v_max3_f32 v244, v135, v136, v244
    s_waitcnt lgkmcnt(15)
    v_mfma_f32_32x32x16_bf16 v[144:159], a[52:55], v[196:199], v[144:159]
    ds_read_b64_tr_b16 a[90:91], v226 offset:38912
    ds_read_b64_tr_b16 a[92:93], v227 offset:36864
    v_max3_f32 v244, v137, v138, v244
    v_max3_f32 v244, v139, v140, v244
    s_waitcnt lgkmcnt(15)
    v_mfma_f32_32x32x16_bf16 v[144:159], a[56:59], v[200:203], v[144:159]
    ds_read_b64_tr_b16 a[94:95], v227 offset:38912
    ds_read_b64_tr_b16 a[136:137], v232 offset:8192
    v_max3_f32 v244, v141, v142, v244
    v_mfma_f32_32x32x16_bf16 v[144:159], a[60:63], v[204:207], v[144:159]
    ds_read_b64_tr_b16 a[138:139], v232 offset:10240
    ds_read_b64_tr_b16 a[140:141], v232 offset:8200
    ds_read_b64_tr_b16 a[142:143], v232 offset:10248
    v_max_f32 v244, v143, v244
    s_waitcnt lgkmcnt(12)
    v_mfma_f32_32x32x16_bf16 v[64:79], a[64:67], v[160:163], v[64:79]
    ds_read_b64_tr_b16 a[96:97], v224 offset:40960
    ds_read_b64_tr_b16 a[98:99], v224 offset:43008
    ds_read_b64_tr_b16 a[100:101], v225 offset:40960
    ds_read_b64_tr_b16 a[102:103], v225 offset:43008
    v_mfma_f32_32x32x16_bf16 v[80:95], a[68:71], v[160:163], v[80:95]
    ds_read_b64_tr_b16 a[104:105], v226 offset:40960
    ds_read_b64_tr_b16 a[106:107], v226 offset:43008
    v_max3_f32 v244, v144, v145, v244
    v_max3_f32 v244, v146, v147, v244
    v_mfma_f32_32x32x16_bf16 v[96:111], a[72:75], v[160:163], v[96:111]
    ds_read_b64_tr_b16 a[108:109], v227 offset:40960
    ds_read_b64_tr_b16 a[110:111], v227 offset:43008
    v_max3_f32 v244, v148, v149, v244
    v_max3_f32 v244, v150, v151, v244
    v_mfma_f32_32x32x16_bf16 v[112:127], a[76:79], v[160:163], v[112:127]
    ds_read_b32 v246, v247
    v_max3_f32 v244, v152, v153, v244
    v_max3_f32 v244, v154, v155, v244
    v_max3_f32 v244, v156, v157, v244
    v_mfma_f32_16x16x32_bf16 v[48:51], v[52:55], v[160:163], v[48:51]
    ds_read_b64_tr_b16 a[112:113], v224 offset:45056
    s_waitcnt lgkmcnt(15)
    v_mfma_f32_32x32x16_bf16 v[64:79], a[80:83], v[164:167], v[64:79]
    ds_read_b64_tr_b16 a[114:115], v224 offset:47104
    ds_read_b64_tr_b16 a[116:117], v225 offset:45056
    v_max3_f32 v244, v158, v159, v244
    v_cmp_lt_f32 vcc, s5, v244
    v_mfma_f32_32x32x16_bf16 v[80:95], a[84:87], v[164:167], v[80:95]
    s_cbranch_vccnz L_st_97
L_bk_98:
    ds_read_b64_tr_b16 a[118:119], v225 offset:47104
    ds_read_b64_tr_b16 a[120:121], v226 offset:45056
    v_exp_f32 v128, v128
    v_mfma_f32_32x32x16_bf16 v[96:111], a[88:91], v[164:167], v[96:111]
    ds_read_b64_tr_b16 a[122:123], v226 offset:47104
    ds_read_b64_tr_b16 a[124:125], v227 offset:45056
    v_exp_f32 v129, v129
    s_waitcnt lgkmcnt(7)
    v_cmp_le_u32 vcc, 32, v246
    v_mfma_f32_32x32x16_bf16 v[112:127], a[92:95], v[164:167], v[112:127]
    ds_read_b64_tr_b16 a[126:127], v227 offset:47104
    v_exp_f32 v130, v130
    v_exp_f32 v131, v131
    v_mfma_f32_16x16x32_bf16 v[48:51], v[52:55], v[164:167], v[48:51]
    v_mov_b32 v249, 8
    v_mfma_f32_32x32x16_bf16 v[64:79], a[96:99], v[168:171], v[64:79]
    s_cbranch_vccz L_st_99
L_bk_100:
    v_cvt_pk_bf16_f32 v160, v128, v129
    v_exp_f32 v132, v132
    v_exp_f32 v133, v133
    v_mfma_f32_32x32x16_bf16 v[80:95], a[100:103], v[168:171], v[80:95]
    v_cvt_pk_bf16_f32 v161, v130, v131
    s_waitcnt lgkmcnt(0)
    ds_write_b32 v248, v249
    ds_read_b128 a[0:3], v208 offset:16384
    v_exp_f32 v134, v134
    v_mfma_f32_32x32x16_bf16 v[96:111], a[104:107], v[168:171], v[96:111]
    ds_read_b128 a[4:7], v209 offset:16384
    v_exp_f32 v135, v135
    v_cvt_pk_bf16_f32 v162, v132, v133
    v_exp_f32 v136, v136
    v_mfma_f32_32x32x16_bf16 v[112:127], a[108:111], v[168:171], v[112:127]
    ds_read_b128 a[8:11], v210 offset:16384
    v_exp_f32 v137, v137
    v_cvt_pk_bf16_f32 v163, v134, v135
    v_exp_f32 v138, v138
    v_mfma_f32_16x16x32_bf16 v[48:51], v[52:55], v[168:171], v[48:51]
    ds_read_b128 a[12:15], v211 offset:16384
    v_exp_f32 v139, v139
    v_mfma_f32_32x32x16_bf16 v[64:79], a[112:115], v[172:175], v[64:79]
    ds_read_b128 a[16:19], v212 offset:16384
    v_cvt_pk_bf16_f32 v164, v136, v137
    v_exp_f32 v140, v140
    v_exp_f32 v141, v141
    v_mfma_f32_32x32x16_bf16 v[80:95], a[116:119], v[172:175], v[80:95]
    ds_read_b128 a[20:23], v213 offset:16384
    ds_read_b128 a[24:27], v214 offset:16384
    v_cvt_pk_bf16_f32 v165, v138, v139
    v_exp_f32 v142, v142
    v_mfma_f32_32x32x16_bf16 v[96:111], a[120:123], v[172:175], v[96:111]
    ds_read_b128 a[28:31], v215 offset:16384
    v_exp_f32 v143, v143
    v_cvt_pk_bf16_f32 v166, v140, v141
    v_exp_f32 v144, v144
    v_mfma_f32_32x32x16_bf16 v[112:127], a[124:127], v[172:175], v[112:127]
    v_exp_f32 v145, v145
    v_cvt_pk_bf16_f32 v167, v142, v143
    v_exp_f32 v146, v146
    v_mfma_f32_16x16x32_bf16 v[48:51], v[52:55], v[172:175], v[48:51]
    v_exp_f32 v147, v147
    s_bitcmp1_b32 s4, 1
    s_cbranch_scc1 L_st_101
L_bk_102:
    s_waitcnt lgkmcnt(0)
    v_mfma_f32_32x32x16_bf16 v[128:143], a[0:3], v[176:179], v[32:47]
    ds_read_b128 a[32:35], v208 offset:24576
    v_cvt_pk_bf16_f32 v168, v144, v145
    v_cvt_pk_bf16_f32 v169, v146, v147
    v_exp_f32 v148, v148
    v_mfma_f32_32x32x16_bf16 v[128:143], a[4:7], v[180:183], v[128:143]
    ds_read_b128 a[36:39], v209 offset:24576
    ds_read_b128 a[40:43], v210 offset:24576
    v_exp_f32 v149, v149
    v_exp_f32 v150, v150
    v_mfma_f32_32x32x16_bf16 v[128:143], a[8:11], v[184:187], v[128:143]
    ds_read_b128 a[44:47], v211 offset:24576
    v_exp_f32 v151, v151
    v_cvt_pk_bf16_f32 v170, v148, v149
    v_mfma_f32_32x32x16_bf16 v[128:143], a[12:15], v[188:191], v[128:143]
    ds_read_b32 v246, v247
    v_exp_f32 v152, v152
    v_exp_f32 v153, v153
    v_cvt_pk_bf16_f32 v171, v150, v151
    v_mfma_f32_32x32x16_bf16 v[128:143], a[16:19], v[192:195], v[128:143]
    ds_read_b128 a[48:51], v212 offset:24576
    v_exp_f32 v154, v154
    v_exp_f32 v155, v155
    v_mfma_f32_32x32x16_bf16 v[128:143], a[20:23], v[196:199], v[128:143]
    ds_read_b128 a[52:55], v213 offset:24576
    v_cvt_pk_bf16_f32 v172, v152, v153
    v_exp_f32 v156, v156
    v_exp_f32 v157, v157
    v_mfma_f32_32x32x16_bf16 v[128:143], a[24:27], v[200:203], v[128:143]
    ds_read_b128 a[56:59], v214 offset:24576
    v_cvt_pk_bf16_f32 v173, v154, v155
    v_exp_f32 v158, v158
    v_mfma_f32_32x32x16_bf16 v[128:143], a[28:31], v[204:207], v[128:143]
    ds_read_b128 a[60:63], v215 offset:24576
    v_exp_f32 v159, v159
    s_waitcnt lgkmcnt(4)
    v_cmp_le_u32 vcc, 35, v246
    v_cvt_pk_bf16_f32 v174, v156, v157
    v_cvt_pk_bf16_f32 v175, v158, v159
    v_mfma_f32_32x32x16_bf16 v[144:159], a[32:35], v[176:179], v[32:47]
    s_cbranch_vccz L_st_103
L_bk_104:
    ds_read_b64_tr_b16 a[64:65], v224 offset:49152
    ds_read_b64_tr_b16 a[66:67], v224 offset:51200
    ds_read_b64_tr_b16 a[68:69], v225 offset:49152
    v_mfma_f32_32x32x16_bf16 v[144:159], a[36:39], v[180:183], v[144:159]
    ds_read_b64_tr_b16 a[70:71], v225 offset:51200
    ds_read_b64_tr_b16 a[72:73], v226 offset:49152
    v_max3_f32 v244, v128, v129, v130
    v_mfma_f32_32x32x16_bf16 v[144:159], a[40:43], v[184:187], v[144:159]
    ds_read_b64_tr_b16 a[74:75], v226 offset:51200
    ds_read_b64_tr_b16 a[76:77], v227 offset:49152
    ds_read_b64_tr_b16 a[78:79], v227 offset:51200
    v_max3_f32 v244, v131, v132, v244
    v_mfma_f32_32x32x16_bf16 v[144:159], a[44:47], v[188:191], v[144:159]
    ds_read_b64_tr_b16 a[80:81], v224 offset:53248
    ds_read_b64_tr_b16 a[82:83], v224 offset:55296
    ds_read_b64_tr_b16 a[84:85], v225 offset:53248
    v_max3_f32 v244, v133, v134, v244
    s_waitcnt lgkmcnt(14)
    v_mfma_f32_32x32x16_bf16 v[144:159], a[48:51], v[192:195], v[144:159]
    ds_read_b64_tr_b16 a[86:87], v225 offset:55296
    ds_read_b64_tr_b16 a[88:89], v226 offset:53248
    v_max3_f32 v244, v135, v136, v244
    s_waitcnt lgkmcnt(15)
    v_mfma_f32_32x32x16_bf16 v[144:159], a[52:55], v[196:199], v[144:159]
    ds_read_b64_tr_b16 a[90:91], v226 offset:55296
    ds_read_b64_tr_b16 a[92:93], v227 offset:53248
    v_max3_f32 v244, v137, v138, v244
    v_max3_f32 v244, v139, v140, v244
    s_waitcnt lgkmcnt(15)
    v_mfma_f32_32x32x16_bf16 v[144:159], a[56:59], v[200:203], v[144:159]
    ds_read_b64_tr_b16 a[94:95], v227 offset:55296
    ds_read_b64_tr_b16 a[144:145], v232 offset:16384
    v_max3_f32 v244, v141, v142, v244
    v_mfma_f32_32x32x16_bf16 v[144:159], a[60:63], v[204:207], v[144:159]
    ds_read_b64_tr_b16 a[146:147], v232 offset:18432
    ds_read_b64_tr_b16 a[148:149], v232 offset:16392
    ds_read_b64_tr_b16 a[150:151], v232 offset:18440
    v_max_f32 v244, v143, v244
    s_waitcnt lgkmcnt(12)
    v_mfma_f32_32x32x16_bf16 v[64:79], a[64:67], v[12:15], v[64:79]
    ds_read_b64_tr_b16 a[96:97], v224 offset:57344
    ds_read_b64_tr_b16 a[98:99], v224 offset:59392
    ds_read_b64_tr_b16 a[100:101], v225 offset:57344
    ds_read_b64_tr_b16 a[102:103], v225 offset:59392
    v_mfma_f32_32x32x16_bf16 v[80:95], a[68:71], v[12:15], v[80:95]
    ds_read_b64_tr_b16 a[104:105], v226 offset:57344
    ds_read_b64_tr_b16 a[106:107], v226 offset:59392
    v_max3_f32 v244, v144, v145, v244
    v_max3_f32 v244, v146, v147, v244
    v_mfma_f32_32x32x16_bf16 v[96:111], a[72:75], v[12:15], v[96:111]
    ds_read_b64_tr_b16 a[108:109], v227 offset:57344
    ds_read_b64_tr_b16 a[110:111], v227 offset:59392
    v_max3_f32 v244, v148, v149, v244
    v_max3_f32 v244, v150, v151, v244
    v_mfma_f32_32x32x16_bf16 v[112:127], a[76:79], v[12:15], v[112:127]
    ds_read_b32 v246, v247
    v_max3_f32 v244, v152, v153, v244
    v_max3_f32 v244, v154, v155, v244
    v_max3_f32 v244, v156, v157, v244
    v_mfma_f32_16x16x32_bf16 v[48:51], v[52:55], v[12:15], v[48:51]
    ds_read_b64_tr_b16 a[112:113], v224 offset:61440
    s_waitcnt lgkmcnt(15)
    v_mfma_f32_32x32x16_bf16 v[64:79], a[80:83], v[16:19], v[64:79]
    ds_read_b64_tr_b16 a[114:115], v224 offset:63488
    ds_read_b64_tr_b16 a[116:117], v225 offset:61440
    v_max3_f32 v244, v158, v159, v244
    v_cmp_lt_f32 vcc, s5, v244
    v_mfma_f32_32x32x16_bf16 v[80:95], a[84:87], v[16:19], v[80:95]
    s_cbranch_vccnz L_st_105
L_bk_106:
    ds_read_b64_tr_b16 a[118:119], v225 offset:63488
    ds_read_b64_tr_b16 a[120:121], v226 offset:61440
    v_exp_f32 v128, v128
    v_mfma_f32_32x32x16_bf16 v[96:111], a[88:91], v[16:19], v[96:111]
    ds_read_b64_tr_b16 a[122:123], v226 offset:63488
    ds_read_b64_tr_b16 a[124:125], v227 offset:61440
    v_exp_f32 v129, v129
    s_waitcnt lgkmcnt(7)
    v_cmp_le_u32 vcc, 37, v246
    v_mfma_f32_32x32x16_bf16 v[112:127], a[92:95], v[16:19], v[112:127]
    ds_read_b64_tr_b16 a[126:127], v227 offset:63488
    v_exp_f32 v130, v130
    v_exp_f32 v131, v131
    v_mfma_f32_16x16x32_bf16 v[48:51], v[52:55], v[16:19], v[48:51]
    v_mov_b32 v249, 9
    v_mfma_f32_32x32x16_bf16 v[64:79], a[96:99], v[20:23], v[64:79]
    s_cbranch_vccz L_st_107
L_bk_108:
    v_cvt_pk_bf16_f32 v12, v128, v129
    v_exp_f32 v132, v132
    v_exp_f32 v133, v133
    v_mfma_f32_32x32x16_bf16 v[80:95], a[100:103], v[20:23], v[80:95]
    v_cvt_pk_bf16_f32 v13, v130, v131
    s_waitcnt lgkmcnt(0)
    ds_write_b32 v248, v249
    ds_read_b128 a[0:3], v208 offset:32768
    v_exp_f32 v134, v134
    v_mfma_f32_32x32x16_bf16 v[96:111], a[104:107], v[20:23], v[96:111]
    ds_read_b128 a[4:7], v209 offset:32768
    v_exp_f32 v135, v135
    v_cvt_pk_bf16_f32 v14, v132, v133
    v_exp_f32 v136, v136
    v_mfma_f32_32x32x16_bf16 v[112:127], a[108:111], v[20:23], v[112:127]
    ds_read_b128 a[8:11], v210 offset:32768
    v_exp_f32 v137, v137
    v_cvt_pk_bf16_f32 v15, v134, v135
    v_exp_f32 v138, v138
    v_mfma_f32_16x16x32_bf16 v[48:51], v[52:55], v[20:23], v[48:51]
    ds_read_b128 a[12:15], v211 offset:32768
    v_exp_f32 v139, v139
    v_mfma_f32_32x32x16_bf16 v[64:79], a[112:115], v[24:27], v[64:79]
    ds_read_b128 a[16:19], v212 offset:32768
    v_cvt_pk_bf16_f32 v16, v136, v137
    v_exp_f32 v140, v140
    v_exp_f32 v141, v141
    v_mfma_f32_32x32x16_bf16 v[80:95], a[116:119], v[24:27], v[80:95]
    ds_read_b128 a[20:23], v213 offset:32768
    ds_read_b128 a[24:27], v214 offset:32768
    v_cvt_pk_bf16_f32 v17, v138, v139
    v_exp_f32 v142, v142
    v_mfma_f32_32x32x16_bf16 v[96:111], a[120:123], v[24:27], v[96:111]
    ds_read_b128 a[28:31], v215 offset:32768
    v_exp_f32 v143, v143
    v_cvt_pk_bf16_f32 v18, v140, v141
    v_exp_f32 v144, v144
    v_mfma_f32_32x32x16_bf16 v[112:127], a[124:127], v[24:27], v[112:127]
    v_exp_f32 v145, v145
    v_cvt_pk_bf16_f32 v19, v142, v143
    v_exp_f32 v146, v146
    v_mfma_f32_16x16x32_bf16 v[48:51], v[52:55], v[24:27], v[48:51]
    v_exp_f32 v147, v147
    s_bitcmp1_b32 s4, 0
    s_cbranch_scc1 L_st_109
L_bk_110:
    s_waitcnt lgkmcnt(0)
    v_mfma_f32_32x32x16_bf16 v[128:143], a[0:3], v[176:179], v[32:47]
    ds_read_b128 a[32:35], v208 offset:40960
    v_cvt_pk_bf16_f32 v20, v144, v145
    v_cvt_pk_bf16_f32 v21, v146, v147
    v_exp_f32 v148, v148
    v_mfma_f32_32x32x16_bf16 v[128:143], a[4:7], v[180:183], v[128:143]
    ds_read_b128 a[36:39], v209 offset:40960
    ds_read_b128 a[40:43], v210 offset:40960
    v_exp_f32 v149, v149
    v_exp_f32 v150, v150
    v_mfma_f32_32x32x16_bf16 v[128:143], a[8:11], v[184:187], v[128:143]
    ds_read_b128 a[44:47], v211 offset:40960
    v_exp_f32 v151, v151
    v_cvt_pk_bf16_f32 v22, v148, v149
    v_mfma_f32_32x32x16_bf16 v[128:143], a[12:15], v[188:191], v[128:143]
    ds_read_b32 v246, v247
    v_exp_f32 v152, v152
    v_exp_f32 v153, v153
    v_cvt_pk_bf16_f32 v23, v150, v151
    v_mfma_f32_32x32x16_bf16 v[128:143], a[16:19], v[192:195], v[128:143]
    ds_read_b128 a[48:51], v212 offset:40960
    v_exp_f32 v154, v154
    v_exp_f32 v155, v155
    v_mfma_f32_32x32x16_bf16 v[128:143], a[20:23], v[196:199], v[128:143]
    ds_read_b128 a[52:55], v213 offset:40960
    v_cvt_pk_bf16_f32 v24, v152, v153
    v_exp_f32 v156, v156
    v_exp_f32 v157, v157
    v_mfma_f32_32x32x16_bf16 v[128:143], a[24:27], v[200:203], v[128:143]
    ds_read_b128 a[56:59], v214 offset:40960
    v_cvt_pk_bf16_f32 v25, v154, v155
    v_exp_f32 v158, v158
    v_mfma_f32_32x32x16_bf16 v[128:143], a[28:31], v[204:207], v[128:143]
    ds_read_b128 a[60:63], v215 offset:40960
    v_exp_f32 v159, v159
    s_waitcnt lgkmcnt(4)
    v_cmp_le_u32 vcc, 39, v246
    v_cvt_pk_bf16_f32 v26, v156, v157
    v_cvt_pk_bf16_f32 v27, v158, v159
    v_mfma_f32_32x32x16_bf16 v[144:159], a[32:35], v[176:179], v[32:47]
    s_cbranch_vccz L_st_111
L_bk_112:
    ds_read_b64_tr_b16 a[64:65], v224 offset:0
    ds_read_b64_tr_b16 a[66:67], v224 offset:2048
    ds_read_b64_tr_b16 a[68:69], v225 offset:0
    v_mfma_f32_32x32x16_bf16 v[144:159], a[36:39], v[180:183], v[144:159]
    ds_read_b64_tr_b16 a[70:71], v225 offset:2048
    ds_read_b64_tr_b16 a[72:73], v226 offset:0
    v_max3_f32 v244, v128, v129, v130
    v_mfma_f32_32x32x16_bf16 v[144:159], a[40:43], v[184:187], v[144:159]
    ds_read_b64_tr_b16 a[74:75], v226 offset:2048
    ds_read_b64_tr_b16 a[76:77], v227 offset:0
    ds_read_b64_tr_b16 a[78:79], v227 offset:2048
    v_max3_f32 v244, v131, v132, v244
    v_mfma_f32_32x32x16_bf16 v[144:159], a[44:47], v[188:191], v[144:159]
    ds_read_b64_tr_b16 a[80:81], v224 offset:4096
    ds_read_b64_tr_b16 a[82:83], v224 offset:6144
    ds_read_b64_tr_b16 a[84:85], v225 offset:4096
    v_max3_f32 v244, v133, v134, v244
    s_waitcnt lgkmcnt(14)
    v_mfma_f32_32x32x16_bf16 v[144:159], a[48:51], v[192:195], v[144:159]
    ds_read_b64_tr_b16 a[86:87], v225 offset:6144
    ds_read_b64_tr_b16 a[88:89], v226 offset:4096
    v_max3_f32 v244, v135, v136, v244
    s_waitcnt lgkmcnt(15)
    v_mfma_f32_32x32x16_bf16 v[144:159], a[52:55], v[196:199], v[144:159]
    ds_read_b64_tr_b16 a[90:91], v226 offset:6144
    ds_read_b64_tr_b16 a[92:93], v227 offset:4096
    v_max3_f32 v244, v137, v138, v244
    v_max3_f32 v244, v139, v140, v244
    s_waitcnt lgkmcnt(15)
    v_mfma_f32_32x32x16_bf16 v[144:159], a[56:59], v[200:203], v[144:159]
    ds_read_b64_tr_b16 a[94:95], v227 offset:6144
    ds_read_b64_tr_b16 a[152:153], v232 offset:0
    v_max3_f32 v244, v141, v142, v244
    v_mfma_f32_32x32x16_bf16 v[144:159], a[60:63], v[204:207], v[144:159]
    ds_read_b64_tr_b16 a[154:155], v232 offset:2048
    ds_read_b64_tr_b16 a[156:157], v232 offset:8
    ds_read_b64_tr_b16 a[158:159], v232 offset:2056
    v_max_f32 v244, v143, v244
    s_waitcnt lgkmcnt(12)
    v_mfma_f32_32x32x16_bf16 v[64:79], a[64:67], v[160:163], v[64:79]
    ds_read_b64_tr_b16 a[96:97], v224 offset:8192
    ds_read_b64_tr_b16 a[98:99], v224 offset:10240
    ds_read_b64_tr_b16 a[100:101], v225 offset:8192
    ds_read_b64_tr_b16 a[102:103], v225 offset:10240
    v_mfma_f32_32x32x16_bf16 v[80:95], a[68:71], v[160:163], v[80:95]
    ds_read_b64_tr_b16 a[104:105], v226 offset:8192
    ds_read_b64_tr_b16 a[106:107], v226 offset:10240
    v_max3_f32 v244, v144, v145, v244
    v_max3_f32 v244, v146, v147, v244
    v_mfma_f32_32x32x16_bf16 v[96:111], a[72:75], v[160:163], v[96:111]
    ds_read_b64_tr_b16 a[108:109], v227 offset:8192
    ds_read_b64_tr_b16 a[110:111], v227 offset:10240
    v_max3_f32 v244, v148, v149, v244
    v_max3_f32 v244, v150, v151, v244
    v_mfma_f32_32x32x16_bf16 v[112:127], a[76:79], v[160:163], v[112:127]
    ds_read_b32 v246, v247
    v_max3_f32 v244, v152, v153, v244
    v_max3_f32 v244, v154, v155, v244
    v_max3_f32 v244, v156, v157, v244
    v_mfma_f32_16x16x32_bf16 v[48:51], v[52:55], v[160:163], v[48:51]
    ds_read_b64_tr_b16 a[112:113], v224 offset:12288
    s_waitcnt lgkmcnt(15)
    v_mfma_f32_32x32x16_bf16 v[64:79], a[80:83], v[164:167], v[64:79]
    ds_read_b64_tr_b16 a[114:115], v224 offset:14336
    ds_read_b64_tr_b16 a[116:117], v225 offset:12288
    v_max3_f32 v244, v158, v159, v244
    v_cmp_lt_f32 vcc, s5, v244
    v_mfma_f32_32x32x16_bf16 v[80:95], a[84:87], v[164:167], v[80:95]
    s_cbranch_vccnz L_st_113
L_bk_114:
    ds_read_b64_tr_b16 a[118:119], v225 offset:14336
    ds_read_b64_tr_b16 a[120:121], v226 offset:12288
    v_exp_f32 v128, v128
    v_mfma_f32_32x32x16_bf16 v[96:111], a[88:91], v[164:167], v[96:111]
    ds_read_b64_tr_b16 a[122:123], v226 offset:14336
    ds_read_b64_tr_b16 a[124:125], v227 offset:12288
    v_exp_f32 v129, v129
    s_waitcnt lgkmcnt(7)
    v_cmp_le_u32 vcc, 41, v246
    v_mfma_f32_32x32x16_bf16 v[112:127], a[92:95], v[164:167], v[112:127]
    ds_read_b64_tr_b16 a[126:127], v227 offset:14336
    v_exp_f32 v130, v130
    v_exp_f32 v131, v131
    v_mfma_f32_16x16x32_bf16 v[48:51], v[52:55], v[164:167], v[48:51]
    v_mov_b32 v249, 10
    v_mfma_f32_32x32x16_bf16 v[64:79], a[96:99], v[168:171], v[64:79]
    s_cbranch_vccz L_st_115
L_bk_116:
    v_cvt_pk_bf16_f32 v160, v128, v129
    v_exp_f32 v132, v132
    v_exp_f32 v133, v133
    v_mfma_f32_32x32x16_bf16 v[80:95], a[100:103], v[168:171], v[80:95]
    v_cvt_pk_bf16_f32 v161, v130, v131
    s_waitcnt lgkmcnt(0)
    ds_write_b32 v248, v249
    ds_read_b128 a[0:3], v208 offset:49152
    v_exp_f32 v134, v134
    v_mfma_f32_32x32x16_bf16 v[96:111], a[104:107], v[168:171], v[96:111]
    ds_read_b128 a[4:7], v209 offset:49152
    v_exp_f32 v135, v135
    v_cvt_pk_bf16_f32 v162, v132, v133
    v_exp_f32 v136, v136
    v_mfma_f32_32x32x16_bf16 v[112:127], a[108:111], v[168:171], v[112:127]
    ds_read_b128 a[8:11], v210 offset:49152
    v_exp_f32 v137, v137
    v_cvt_pk_bf16_f32 v163, v134, v135
    v_exp_f32 v138, v138
    v_mfma_f32_16x16x32_bf16 v[48:51], v[52:55], v[168:171], v[48:51]
    ds_read_b128 a[12:15], v211 offset:49152
    v_exp_f32 v139, v139
    v_mfma_f32_32x32x16_bf16 v[64:79], a[112:115], v[172:175], v[64:79]
    ds_read_b128 a[16:19], v212 offset:49152
    v_cvt_pk_bf16_f32 v164, v136, v137
    v_exp_f32 v140, v140
    v_exp_f32 v141, v141
    v_mfma_f32_32x32x16_bf16 v[80:95], a[116:119], v[172:175], v[80:95]
    ds_read_b128 a[20:23], v213 offset:49152
    ds_read_b128 a[24:27], v214 offset:49152
    v_cvt_pk_bf16_f32 v165, v138, v139
    v_exp_f32 v142, v142
    v_mfma_f32_32x32x16_bf16 v[96:111], a[120:123], v[172:175], v[96:111]
    ds_read_b128 a[28:31], v215 offset:49152
    v_exp_f32 v143, v143
    v_cvt_pk_bf16_f32 v166, v140, v141
    v_exp_f32 v144, v144
    v_mfma_f32_32x32x16_bf16 v[112:127], a[124:127], v[172:175], v[112:127]
    v_exp_f32 v145, v145
    v_cvt_pk_bf16_f32 v167, v142, v143
    v_exp_f32 v146, v146
    v_mfma_f32_16x16x32_bf16 v[48:51], v[52:55], v[172:175], v[48:51]
    v_exp_f32 v147, v147
    s_bitcmp1_b32 s4, 1
    s_cbranch_scc1 L_st_117
L_bk_118:
    s_waitcnt lgkmcnt(0)
    v_mfma_f32_32x32x16_bf16 v[128:143], a[0:3], v[176:179], v[32:47]
    ds_read_b128 a[32:35], v208 offset:57344
    v_cvt_pk_bf16_f32 v168, v144, v145
    v_cvt_pk_bf16_f32 v169, v146, v147
    v_exp_f32 v148, v148
    v_mfma_f32_32x32x16_bf16 v[128:143], a[4:7], v[180:183], v[128:143]
    ds_read_b128 a[36:39], v209 offset:57344
    ds_read_b128 a[40:43], v210 offset:57344
    v_exp_f32 v149, v149
    v_exp_f32 v150, v150
    v_mfma_f32_32x32x16_bf16 v[128:143], a[8:11], v[184:187], v[128:143]
    ds_read_b128 a[44:47], v211 offset:57344
    v_exp_f32 v151, v151
    v_cvt_pk_bf16_f32 v170, v148, v149
    v_mfma_f32_32x32x16_bf16 v[128:143], a[12:15], v[188:191], v[128:143]
    ds_read_b32 v246, v247
    v_exp_f32 v152, v152
    v_exp_f32 v153, v153
    v_cvt_pk_bf16_f32 v171, v150, v151
    v_mfma_f32_32x32x16_bf16 v[128:143], a[16:19], v[192:195], v[128:143]
    ds_read_b128 a[48:51], v212 offset:57344
    v_exp_f32 v154, v154
    v_exp_f32 v155, v155
    v_mfma_f32_32x32x16_bf16 v[128:143], a[20:23], v[196:199], v[128:143]
    ds_read_b128 a[52:55], v213 offset:57344
    v_cvt_pk_bf16_f32 v172, v152, v153
    v_exp_f32 v156, v156
    v_exp_f32 v157, v157
    v_mfma_f32_32x32x16_bf16 v[128:143], a[24:27], v[200:203], v[128:143]
    ds_read_b128 a[56:59], v214 offset:57344
    v_cvt_pk_bf16_f32 v173, v154, v155
    v_exp_f32 v158, v158
    v_mfma_f32_32x32x16_bf16 v[128:143], a[28:31], v[204:207], v[128:143]
    ds_read_b128 a[60:63], v215 offset:57344
    v_exp_f32 v159, v159
    s_waitcnt lgkmcnt(4)
    v_cmp_le_u32 vcc, 44, v246
    v_cvt_pk_bf16_f32 v174, v156, v157
    v_cvt_pk_bf16_f32 v175, v158, v159
    v_mfma_f32_32x32x16_bf16 v[144:159], a[32:35], v[176:179], v[32:47]
    s_cbranch_vccz L_st_119
L_bk_120:
    ds_read_b64_tr_b16 a[64:65], v224 offset:16384
    ds_read_b64_tr_b16 a[66:67], v224 offset:18432
    ds_read_b64_tr_b16 a[68:69], v225 offset:16384
    v_mfma_f32_32x32x16_bf16 v[144:159], a[36:39], v[180:183], v[144:159]
    ds_read_b64_tr_b16 a[70:71], v225 offset:18432
    ds_read_b64_tr_b16 a[72:73], v226 offset:16384
    v_max3_f32 v244, v128, v129, v130
    v_mfma_f32_32x32x16_bf16 v[144:159], a[40:43], v[184:187], v[144:159]
    ds_read_b64_tr_b16 a[74:75], v226 offset:18432
    ds_read_b64_tr_b16 a[76:77], v227 offset:16384
    ds_read_b64_tr_b16 a[78:79], v227 offset:18432
    v_max3_f32 v244, v131, v132, v244
    v_mfma_f32_32x32x16_bf16 v[144:159], a[44:47], v[188:191], v[144:159]
    ds_read_b64_tr_b16 a[80:81], v224 offset:20480
    ds_read_b64_tr_b16 a[82:83], v224 offset:22528
    ds_read_b64_tr_b16 a[84:85], v225 offset:20480
    v_max3_f32 v244, v133, v134, v244
    s_waitcnt lgkmcnt(14)
    v_mfma_f32_32x32x16_bf16 v[144:159], a[48:51], v[192:195], v[144:159]
    ds_read_b64_tr_b16 a[86:87], v225 offset:22528
    ds_read_b64_tr_b16 a[88:89], v226 offset:20480
    v_max3_f32 v244, v135, v136, v244
    s_waitcnt lgkmcnt(15)
    v_mfma_f32_32x32x16_bf16 v[144:159], a[52:55], v[196:199], v[144:159]
    ds_read_b64_tr_b16 a[90:91], v226 offset:22528
    ds_read_b64_tr_b16 a[92:93], v227 offset:20480
    v_max3_f32 v244, v137, v138, v244
    v_max3_f32 v244, v139, v140, v244
    s_waitcnt lgkmcnt(15)
    v_mfma_f32_32x32x16_bf16 v[144:159], a[56:59], v[200:203], v[144:159]
    ds_read_b64_tr_b16 a[94:95], v227 offset:22528
    ds_read_b64_tr_b16 a[160:161], v232 offset:8192
    v_max3_f32 v244, v141, v142, v244
    v_mfma_f32_32x32x16_bf16 v[144:159], a[60:63], v[204:207], v[144:159]
    ds_read_b64_tr_b16 a[162:163], v232 offset:10240
    ds_read_b64_tr_b16 a[164:165], v232 offset:8200
    ds_read_b64_tr_b16 a[166:167], v232 offset:10248
    v_max_f32 v244, v143, v244
    s_waitcnt lgkmcnt(12)
    v_mfma_f32_32x32x16_bf16 v[64:79], a[64:67], v[12:15], v[64:79]
    ds_read_b64_tr_b16 a[96:97], v224 offset:24576
    ds_read_b64_tr_b16 a[98:99], v224 offset:26624
    ds_read_b64_tr_b16 a[100:101], v225 offset:24576
    ds_read_b64_tr_b16 a[102:103], v225 offset:26624
    v_mfma_f32_32x32x16_bf16 v[80:95], a[68:71], v[12:15], v[80:95]
    ds_read_b64_tr_b16 a[104:105], v226 offset:24576
    ds_read_b64_tr_b16 a[106:107], v226 offset:26624
    v_max3_f32 v244, v144, v145, v244
    v_max3_f32 v244, v146, v147, v244
    v_mfma_f32_32x32x16_bf16 v[96:111], a[72:75], v[12:15], v[96:111]
    ds_read_b64_tr_b16 a[108:109], v227 offset:24576
    ds_read_b64_tr_b16 a[110:111], v227 offset:26624
    v_max3_f32 v244, v148, v149, v244
    v_max3_f32 v244, v150, v151, v244
    v_mfma_f32_32x32x16_bf16 v[112:127], a[76:79], v[12:15], v[112:127]
    ds_read_b32 v246, v247
    v_max3_f32 v244, v152, v153, v244
    v_max3_f32 v244, v154, v155, v244
    v_max3_f32 v244, v156, v157, v244
    v_mfma_f32_16x16x32_bf16 v[48:51], v[52:55], v[12:15], v[48:51]
    ds_read_b64_tr_b16 a[112:113], v224 offset:28672
    s_waitcnt lgkmcnt(15)
    v_mfma_f32_32x32x16_bf16 v[64:79], a[80:83], v[16:19], v[64:79]
    ds_read_b64_tr_b16 a[114:115], v224 offset:30720
    ds_read_b64_tr_b16 a[116:117], v225 offset:28672
    v_max3_f32 v244, v158, v159, v244
    v_cmp_lt_f32 vcc, s5, v244
    v_mfma_f32_32x32x16_bf16 v[80:95], a[84:87], v[16:19], v[80:95]
    s_cbranch_vccnz L_st_121
L_bk_122:
    ds_read_b64_tr_b16 a[118:119], v225 offset:30720
    ds_read_b64_tr_b16 a[120:121], v226 offset:28672
    v_exp_f32 v128, v128
    v_mfma_f32_32x32x16_bf16 v[96:111], a[88:91], v[16:19], v[96:111]
    ds_read_b64_tr_b16 a[122:123], v226 offset:30720
    ds_read_b64_tr_b16 a[124:125], v227 offset:28672
    v_exp_f32 v129, v129
    s_waitcnt lgkmcnt(7)
    v_cmp_le_u32 vcc, 45, v246
    v_mfma_f32_32x32x16_bf16 v[112:127], a[92:95], v[16:19], v[112:127]
    ds_read_b64_tr_b16 a[126:127], v227 offset:30720
    v_exp_f32 v130, v130
    v_exp_f32 v131, v131
    v_mfma_f32_16x16x32_bf16 v[48:51], v[52:55], v[16:19], v[48:51]
    v_mov_b32 v249, 11
    v_mfma_f32_32x32x16_bf16 v[64:79], a[96:99], v[20:23], v[64:79]
    s_cbranch_vccz L_st_123
L_bk_124:
    v_cvt_pk_bf16_f32 v12, v128, v129
    v_exp_f32 v132, v132
    v_exp_f32 v133, v133
    v_mfma_f32_32x32x16_bf16 v[80:95], a[100:103], v[20:23], v[80:95]
    v_cvt_pk_bf16_f32 v13, v130, v131
    s_waitcnt lgkmcnt(0)
    ds_write_b32 v248, v249
    ds_read_b128 a[0:3], v208 offset:0
    v_exp_f32 v134, v134
    v_mfma_f32_32x32x16_bf16 v[96:111], a[104:107], v[20:23], v[96:111]
    ds_read_b128 a[4:7], v209 offset:0
    v_exp_f32 v135, v135
    v_cvt_pk_bf16_f32 v14, v132, v133
    v_exp_f32 v136, v136
    v_mfma_f32_32x32x16_bf16 v[112:127], a[108:111], v[20:23], v[112:127]
    ds_read_b128 a[8:11], v210 offset:0
    v_exp_f32 v137, v137
    v_cvt_pk_bf16_f32 v15, v134, v135
    v_exp_f32 v138, v138
    v_mfma_f32_16x16x32_bf16 v[48:51], v[52:55], v[20:23], v[48:51]
    ds_read_b128 a[12:15], v211 offset:0
    v_exp_f32 v139, v139
    v_mfma_f32_32x32x16_bf16 v[64:79], a[112:115], v[24:27], v[64:79]
    ds_read_b128 a[16:19], v212 offset:0
    v_cvt_pk_bf16_f32 v16, v136, v137
    v_exp_f32 v140, v140
    v_exp_f32 v141, v141
    v_mfma_f32_32x32x16_bf16 v[80:95], a[116:119], v[24:27], v[80:95]
    ds_read_b128 a[20:23], v213 offset:0
    ds_read_b128 a[24:27], v214 offset:0
    v_cvt_pk_bf16_f32 v17, v138, v139
    v_exp_f32 v142, v142
    v_mfma_f32_32x32x16_bf16 v[96:111], a[120:123], v[24:27], v[96:111]
    ds_read_b128 a[28:31], v215 offset:0
    v_exp_f32 v143, v143
    v_cvt_pk_bf16_f32 v18, v140, v141
    v_exp_f32 v144, v144
    v_mfma_f32_32x32x16_bf16 v[112:127], a[124:127], v[24:27], v[112:127]
    v_exp_f32 v145, v145
    v_cvt_pk_bf16_f32 v19, v142, v143
    v_exp_f32 v146, v146
    v_mfma_f32_16x16x32_bf16 v[48:51], v[52:55], v[24:27], v[48:51]
    v_exp_f32 v147, v147
    s_bitcmp1_b32 s4, 0
    s_cbranch_scc1 L_st_125
L_bk_126:
    s_waitcnt lgkmcnt(0)
    v_mfma_f32_32x32x16_bf16 v[128:143], a[0:3], v[176:179], v[32:47]
    ds_read_b128 a[32:35], v208 offset:8192
    v_cvt_pk_bf16_f32 v20, v144, v145
    v_cvt_pk_bf16_f32 v21, v146, v147
    v_exp_f32 v148, v148
    v_mfma_f32_32x32x16_bf16 v[128:143], a[4:7], v[180:183], v[128:143]
    ds_read_b128 a[36:39], v209 offset:8192
    ds_read_b128 a[40:43], v210 offset:8192
    v_exp_f32 v149, v149
    v_exp_f32 v150, v150
    v_mfma_f32_32x32x16_bf16 v[128:143], a[8:11], v[184:187], v[128:143]
    ds_read_b128 a[44:47], v211 offset:8192
    v_exp_f32 v151, v151
    v_cvt_pk_bf16_f32 v22, v148, v149
    v_mfma_f32_32x32x16_bf16 v[128:143], a[12:15], v[188:191], v[128:143]
    ds_read_b32 v246, v247
    v_exp_f32 v152, v152
    v_exp_f32 v153, v153
    v_cvt_pk_bf16_f32 v23, v150, v151
    v_mfma_f32_32x32x16_bf16 v[128:143], a[16:19], v[192:195], v[128:143]
    ds_read_b128 a[48:51], v212 offset:8192
    v_exp_f32 v154, v154
    v_exp_f32 v155, v155
    v_mfma_f32_32x32x16_bf16 v[128:143], a[20:23], v[196:199], v[128:143]
    ds_read_b128 a[52:55], v213 offset:8192
    v_cvt_pk_bf16_f32 v24, v152, v153
    v_exp_f32 v156, v156
    v_exp_f32 v157, v157
    v_mfma_f32_32x32x16_bf16 v[128:143], a[24:27], v[200:203], v[128:143]
    ds_read_b128 a[56:59], v214 offset:8192
    v_cvt_pk_bf16_f32 v25, v154, v155
    v_exp_f32 v158, v158
    v_mfma_f32_32x32x16_bf16 v[128:143], a[28:31], v[204:207], v[128:143]
    ds_read_b128 a[60:63], v215 offset:8192
    v_exp_f32 v159, v159
    s_waitcnt lgkmcnt(4)
    v_cmp_le_u32 vcc, 48, v246
    v_cvt_pk_bf16_f32 v26, v156, v157
    v_cvt_pk_bf16_f32 v27, v158, v159
    v_mfma_f32_32x32x16_bf16 v[144:159], a[32:35], v[176:179], v[32:47]
    s_cbranch_vccz L_st_127
L_bk_128:
    ds_read_b64_tr_b16 a[64:65], v224 offset:32768
    ds_read_b64_tr_b16 a[66:67], v224 offset:34816
    ds_read_b64_tr_b16 a[68:69], v225 offset:32768
    v_mfma_f32_32x32x16_bf16 v[144:159], a[36:39], v[180:183], v[144:159]
    ds_read_b64_tr_b16 a[70:71], v225 offset:34816
    ds_read_b64_tr_b16 a[72:73], v226 offset:32768
    v_max3_f32 v244, v128, v129, v130
    v_mfma_f32_32x32x16_bf16 v[144:159], a[40:43], v[184:187], v[144:159]
    ds_read_b64_tr_b16 a[74:75], v226 offset:34816
    ds_read_b64_tr_b16 a[76:77], v227 offset:32768
    ds_read_b64_tr_b16 a[78:79], v227 offset:34816
    v_max3_f32 v244, v131, v132, v244
    v_mfma_f32_32x32x16_bf16 v[144:159], a[44:47], v[188:191], v[144:159]
    ds_read_b64_tr_b16 a[80:81], v224 offset:36864
    ds_read_b64_tr_b16 a[82:83], v224 offset:38912
    ds_read_b64_tr_b16 a[84:85], v225 offset:36864
    v_max3_f32 v244, v133, v134, v244
    s_waitcnt lgkmcnt(14)
    v_mfma_f32_32x32x16_bf16 v[144:159], a[48:51], v[192:195], v[144:159]
    ds_read_b64_tr_b16 a[86:87], v225 offset:38912
    ds_read_b64_tr_b16 a[88:89], v226 offset:36864
    v_max3_f32 v244, v135, v136, v244
    s_waitcnt lgkmcnt(15)
    v_mfma_f32_32x32x16_bf16 v[144:159], a[52:55], v[196:199], v[144:159]
    ds_read_b64_tr_b16 a[90:91], v226 offset:38912
    ds_read_b64_tr_b16 a[92:93], v227 offset:36864
    v_max3_f32 v244, v137, v138, v244
    v_max3_f32 v244, v139, v140, v244
    s_waitcnt lgkmcnt(15)
    v_mfma_f32_32x32x16_bf16 v[144:159], a[56:59], v[200:203], v[144:159]
    ds_read_b64_tr_b16 a[94:95], v227 offset:38912
    ds_read_b64_tr_b16 a[168:169], v232 offset:16384
    v_max3_f32 v244, v141, v142, v244
    v_mfma_f32_32x32x16_bf16 v[144:159], a[60:63], v[204:207], v[144:159]
    ds_read_b64_tr_b16 a[170:171], v232 offset:18432
    ds_read_b64_tr_b16 a[172:173], v232 offset:16392
    ds_read_b64_tr_b16 a[174:175], v232 offset:18440
    v_max_f32 v244, v143, v244
    s_waitcnt lgkmcnt(12)
    v_mfma_f32_32x32x16_bf16 v[64:79], a[64:67], v[160:163], v[64:79]
    ds_read_b64_tr_b16 a[96:97], v224 offset:40960
    ds_read_b64_tr_b16 a[98:99], v224 offset:43008
    ds_read_b64_tr_b16 a[100:101], v225 offset:40960
    ds_read_b64_tr_b16 a[102:103], v225 offset:43008
    v_mfma_f32_32x32x16_bf16 v[80:95], a[68:71], v[160:163], v[80:95]
    ds_read_b64_tr_b16 a[104:105], v226 offset:40960
    ds_read_b64_tr_b16 a[106:107], v226 offset:43008
    v_max3_f32 v244, v144, v145, v244
    v_max3_f32 v244, v146, v147, v244
    v_mfma_f32_32x32x16_bf16 v[96:111], a[72:75], v[160:163], v[96:111]
    ds_read_b64_tr_b16 a[108:109], v227 offset:40960
    ds_read_b64_tr_b16 a[110:111], v227 offset:43008
    v_max3_f32 v244, v148, v149, v244
    v_max3_f32 v244, v150, v151, v244
    v_mfma_f32_32x32x16_bf16 v[112:127], a[76:79], v[160:163], v[112:127]
    ds_read_b32 v246, v247
    v_max3_f32 v244, v152, v153, v244
    v_max3_f32 v244, v154, v155, v244
    v_max3_f32 v244, v156, v157, v244
    v_mfma_f32_16x16x32_bf16 v[48:51], v[52:55], v[160:163], v[48:51]
    ds_read_b64_tr_b16 a[112:113], v224 offset:45056
    s_waitcnt lgkmcnt(15)
    v_mfma_f32_32x32x16_bf16 v[64:79], a[80:83], v[164:167], v[64:79]
    ds_read_b64_tr_b16 a[114:115], v224 offset:47104
    ds_read_b64_tr_b16 a[116:117], v225 offset:45056
    v_max3_f32 v244, v158, v159, v244
    v_cmp_lt_f32 vcc, s5, v244
    v_mfma_f32_32x32x16_bf16 v[80:95], a[84:87], v[164:167], v[80:95]
    s_cbranch_vccnz L_st_129
L_bk_130:
    ds_read_b64_tr_b16 a[118:119], v225 offset:47104
    ds_read_b64_tr_b16 a[120:121], v226 offset:45056
    v_exp_f32 v128, v128
    v_mfma_f32_32x32x16_bf16 v[96:111], a[88:91], v[164:167], v[96:111]
    ds_read_b64_tr_b16 a[122:123], v226 offset:47104
    ds_read_b64_tr_b16 a[124:125], v227 offset:45056
    v_exp_f32 v129, v129
    s_waitcnt lgkmcnt(7)
    v_cmp_le_u32 vcc, 49, v246
    v_mfma_f32_32x32x16_bf16 v[112:127], a[92:95], v[164:167], v[112:127]
    ds_read_b64_tr_b16 a[126:127], v227 offset:47104
    v_exp_f32 v130, v130
    v_exp_f32 v131, v131
    v_mfma_f32_16x16x32_bf16 v[48:51], v[52:55], v[164:167], v[48:51]
    v_mov_b32 v249, 12
    v_mfma_f32_32x32x16_bf16 v[64:79], a[96:99], v[168:171], v[64:79]
    s_cbranch_vccz L_st_131
L_bk_132:
    v_cvt_pk_bf16_f32 v160, v128, v129
    v_exp_f32 v132, v132
    v_exp_f32 v133, v133
    v_mfma_f32_32x32x16_bf16 v[80:95], a[100:103], v[168:171], v[80:95]
    v_cvt_pk_bf16_f32 v161, v130, v131
    s_waitcnt lgkmcnt(0)
    ds_write_b32 v248, v249
    ds_read_b128 a[0:3], v208 offset:16384
    v_exp_f32 v134, v134
    v_mfma_f32_32x32x16_bf16 v[96:111], a[104:107], v[168:171], v[96:111]
    ds_read_b128 a[4:7], v209 offset:16384
    v_exp_f32 v135, v135
    v_cvt_pk_bf16_f32 v162, v132, v133
    v_exp_f32 v136, v136
    v_mfma_f32_32x32x16_bf16 v[112:127], a[108:111], v[168:171], v[112:127]
    ds_read_b128 a[8:11], v210 offset:16384
    v_exp_f32 v137, v137
    v_cvt_pk_bf16_f32 v163, v134, v135
    v_exp_f32 v138, v138
    v_mfma_f32_16x16x32_bf16 v[48:51], v[52:55], v[168:171], v[48:51]
    ds_read_b128 a[12:15], v211 offset:16384
    v_exp_f32 v139, v139
    v_mfma_f32_32x32x16_bf16 v[64:79], a[112:115], v[172:175], v[64:79]
    ds_read_b128 a[16:19], v212 offset:16384
    v_cvt_pk_bf16_f32 v164, v136, v137
    v_exp_f32 v140, v140
    v_exp_f32 v141, v141
    v_mfma_f32_32x32x16_bf16 v[80:95], a[116:119], v[172:175], v[80:95]
    ds_read_b128 a[20:23], v213 offset:16384
    ds_read_b128 a[24:27], v214 offset:16384
    v_cvt_pk_bf16_f32 v165, v138, v139
    v_exp_f32 v142, v142
    v_mfma_f32_32x32x16_bf16 v[96:111], a[120:123], v[172:175], v[96:111]
    ds_read_b128 a[28:31], v215 offset:16384
    v_exp_f32 v143, v143
    v_cvt_pk_bf16_f32 v166, v140, v141
    v_exp_f32 v144, v144
    v_mfma_f32_32x32x16_bf16 v[112:127], a[124:127], v[172:175], v[112:127]
    v_exp_f32 v145, v145
    v_cvt_pk_bf16_f32 v167, v142, v143
    v_exp_f32 v146, v146
    v_mfma_f32_16x16x32_bf16 v[48:51], v[52:55], v[172:175], v[48:51]
    v_exp_f32 v147, v147
    s_bitcmp1_b32 s4, 1
    s_cbranch_scc1 L_st_133
L_bk_134:
    s_waitcnt lgkmcnt(0)
    v_mfma_f32_32x32x16_bf16 v[128:143], a[0:3], v[176:179], v[32:47]
    ds_read_b128 a[32:35], v208 offset:24576
    v_cvt_pk_bf16_f32 v168, v144, v145
    v_cvt_pk_bf16_f32 v169, v146, v147
    v_exp_f32 v148, v148
    v_mfma_f32_32x32x16_bf16 v[128:143], a[4:7], v[180:183], v[128:143]
    ds_read_b128 a[36:39], v209 offset:24576
    ds_read_b128 a[40:43], v210 offset:24576
    v_exp_f32 v149, v149
    v_exp_f32 v150, v150
    v_mfma_f32_32x32x16_bf16 v[128:143], a[8:11], v[184:187], v[128:143]
    ds_read_b128 a[44:47], v211 offset:24576
    v_exp_f32 v151, v151
    v_cvt_pk_bf16_f32 v170, v148, v149
    v_mfma_f32_32x32x16_bf16 v[128:143], a[12:15], v[188:191], v[128:143]
    ds_read_b32 v246, v247
    v_exp_f32 v152, v152
    v_exp_f32 v153, v153
    v_cvt_pk_bf16_f32 v171, v150, v151
    v_mfma_f32_32x32x16_bf16 v[128:143], a[16:19], v[192:195], v[128:143]
    ds_read_b128 a[48:51], v212 offset:24576
    v_exp_f32 v154, v154
    v_exp_f32 v155, v155
    v_mfma_f32_32x32x16_bf16 v[128:143], a[20:23], v[196:199], v[128:143]
    ds_read_b128 a[52:55], v213 offset:24576
    v_cvt_pk_bf16_f32 v172, v152, v153
    v_exp_f32 v156, v156
    v_exp_f32 v157, v157
    v_mfma_f32_32x32x16_bf16 v[128:143], a[24:27], v[200:203], v[128:143]
    ds_read_b128 a[56:59], v214 offset:24576
    v_cvt_pk_bf16_f32 v173, v154, v155
    v_exp_f32 v158, v158
    v_mfma_f32_32x32x16_bf16 v[128:143], a[28:31], v[204:207], v[128:143]
    ds_read_b128 a[60:63], v215 offset:24576
    v_exp_f32 v159, v159
    s_waitcnt lgkmcnt(4)
    v_cmp_le_u32 vcc, 52, v246
    v_cvt_pk_bf16_f32 v174, v156, v157
    v_cvt_pk_bf16_f32 v175, v158, v159
    v_mfma_f32_32x32x16_bf16 v[144:159], a[32:35], v[176:179], v[32:47]
    s_cbranch_vccz L_st_135
L_bk_136:
    ds_read_b64_tr_b16 a[64:65], v224 offset:49152
    ds_read_b64_tr_b16 a[66:67], v224 offset:51200
    ds_read_b64_tr_b16 a[68:69], v225 offset:49152
    v_mfma_f32_32x32x16_bf16 v[144:159], a[36:39], v[180:183], v[144:159]
    ds_read_b64_tr_b16 a[70:71], v225 offset:51200
    ds_read_b64_tr_b16 a[72:73], v226 offset:49152
    ds_read_b64_tr_b16 a[74:75], v226 offset:51200
    v_max3_f32 v244, v128, v129, v130
    v_mfma_f32_32x32x16_bf16 v[144:159], a[40:43], v[184:187], v[144:159]
    ds_read_b64_tr_b16 a[76:77], v227 offset:49152
    ds_read_b64_tr_b16 a[78:79], v227 offset:51200
    ds_read_b64_tr_b16 a[80:81], v224 offset:53248
    v_max3_f32 v244, v131, v132, v244
    v_mfma_f32_32x32x16_bf16 v[144:159], a[44:47], v[188:191], v[144:159]
    ds_read_b64_tr_b16 a[82:83], v224 offset:55296
    ds_read_b64_tr_b16 a[84:85], v225 offset:53248
    v_max3_f32 v244, v133, v134, v244
    v_max3_f32 v244, v135, v136, v244
    s_waitcnt lgkmcnt(14)
    v_mfma_f32_32x32x16_bf16 v[144:159], a[48:51], v[192:195], v[144:159]
    ds_read_b64_tr_b16 a[86:87], v225 offset:55296
    ds_read_b64_tr_b16 a[88:89], v226 offset:53248
    ds_read_b64_tr_b16 a[90:91], v226 offset:55296
    v_max3_f32 v244, v137, v138, v244
    s_waitcnt lgkmcnt(15)
    v_mfma_f32_32x32x16_bf16 v[144:159], a[52:55], v[196:199], v[144:159]
    ds_read_b64_tr_b16 a[92:93], v227 offset:53248
    ds_read_b64_tr_b16 a[94:95], v227 offset:55296
    ds_read_b64_tr_b16 a[176:177], v232 offset:0
    v_max3_f32 v244, v139, v140, v244
    v_mfma_f32_32x32x16_bf16 v[144:159], a[56:59], v[200:203], v[144:159]
    ds_read_b64_tr_b16 a[178:179], v232 offset:2048
    ds_read_b64_tr_b16 a[180:181], v232 offset:8
    v_max3_f32 v244, v141, v142, v244
    v_max_f32 v244, v143, v244
    s_waitcnt lgkmcnt(15)
    v_mfma_f32_32x32x16_bf16 v[144:159], a[60:63], v[204:207], v[144:159]
    ds_read_b64_tr_b16 a[182:183], v232 offset:2056
    s_lshl_b32 s65, s60, 5
    v_mov_b32 v3, 0
    buffer_load_dword v2, v3, s[56:59], s65 offen sc1
    s_waitcnt lgkmcnt(12)
    v_mfma_f32_32x32x16_bf16 v[64:79], a[64:67], v[12:15], v[64:79]
    ds_read_b64_tr_b16 a[96:97], v224 offset:57344
    ds_read_b64_tr_b16 a[98:99], v224 offset:59392
    ds_read_b64_tr_b16 a[100:101], v225 offset:57344
    ds_read_b64_tr_b16 a[102:103], v225 offset:59392
    v_mfma_f32_32x32x16_bf16 v[80:95], a[68:71], v[12:15], v[80:95]
    ds_read_b64_tr_b16 a[104:105], v226 offset:57344
    ds_read_b64_tr_b16 a[106:107], v226 offset:59392
    v_max3_f32 v244, v144, v145, v244
    v_max3_f32 v244, v146, v147, v244
    v_mfma_f32_32x32x16_bf16 v[96:111], a[72:75], v[12:15], v[96:111]
    ds_read_b64_tr_b16 a[108:109], v227 offset:57344
    ds_read_b64_tr_b16 a[110:111], v227 offset:59392
    v_max3_f32 v244, v148, v149, v244
    v_max3_f32 v244, v150, v151, v244
    v_mfma_f32_32x32x16_bf16 v[112:127], a[76:79], v[12:15], v[112:127]
    ds_read_b32 v246, v247
    v_max3_f32 v244, v152, v153, v244
    v_max3_f32 v244, v154, v155, v244
    v_max3_f32 v244, v156, v157, v244
    v_mfma_f32_16x16x32_bf16 v[48:51], v[52:55], v[12:15], v[48:51]
    ds_read_b64_tr_b16 a[112:113], v224 offset:61440
    s_waitcnt lgkmcnt(15)
    v_mfma_f32_32x32x16_bf16 v[64:79], a[80:83], v[16:19], v[64:79]
    ds_read_b64_tr_b16 a[114:115], v224 offset:63488
    ds_read_b64_tr_b16 a[116:117], v225 offset:61440
    v_max3_f32 v244, v158, v159, v244
    v_cmp_lt_f32 vcc, s5, v244
    v_mfma_f32_32x32x16_bf16 v[80:95], a[84:87], v[16:19], v[80:95]
    s_cbranch_vccnz L_st_137
L_bk_138:
    ds_read_b64_tr_b16 a[118:119], v225 offset:63488
    ds_read_b64_tr_b16 a[120:121], v226 offset:61440
    v_exp_f32 v128, v128
    v_mfma_f32_32x32x16_bf16 v[96:111], a[88:91], v[16:19], v[96:111]
    ds_read_b64_tr_b16 a[122:123], v226 offset:63488
    ds_read_b64_tr_b16 a[124:125], v227 offset:61440
    v_exp_f32 v129, v129
    s_waitcnt lgkmcnt(7)
    v_cmp_le_u32 vcc, 53, v246
    v_mfma_f32_32x32x16_bf16 v[112:127], a[92:95], v[16:19], v[112:127]
    ds_read_b64_tr_b16 a[126:127], v227 offset:63488
    v_exp_f32 v130, v130
    v_exp_f32 v131, v131
    v_mfma_f32_16x16x32_bf16 v[48:51], v[52:55], v[16:19], v[48:51]
    v_mov_b32 v249, 13
    v_mfma_f32_32x32x16_bf16 v[64:79], a[96:99], v[20:23], v[64:79]
    s_cbranch_vccz L_st_139
L_bk_140:
    v_cvt_pk_bf16_f32 v12, v128, v129
    v_exp_f32 v132, v132
    v_exp_f32 v133, v133
    v_mfma_f32_32x32x16_bf16 v[80:95], a[100:103], v[20:23], v[80:95]
    v_cvt_pk_bf16_f32 v13, v130, v131
    s_waitcnt lgkmcnt(0)
    ds_write_b32 v248, v249
    ds_read_b128 a[0:3], v208 offset:32768
    v_exp_f32 v134, v134
    v_mfma_f32_32x32x16_bf16 v[96:111], a[104:107], v[20:23], v[96:111]
    ds_read_b128 a[4:7], v209 offset:32768
    v_exp_f32 v135, v135
    v_cvt_pk_bf16_f32 v14, v132, v133
    v_exp_f32 v136, v136
    v_mfma_f32_32x32x16_bf16 v[112:127], a[108:111], v[20:23], v[112:127]
    ds_read_b128 a[8:11], v210 offset:32768
    v_exp_f32 v137, v137
    v_cvt_pk_bf16_f32 v15, v134, v135
    v_exp_f32 v138, v138
    v_mfma_f32_16x16x32_bf16 v[48:51], v[52:55], v[20:23], v[48:51]
    ds_read_b128 a[12:15], v211 offset:32768
    v_exp_f32 v139, v139
    v_mfma_f32_32x32x16_bf16 v[64:79], a[112:115], v[24:27], v[64:79]
    ds_read_b128 a[16:19], v212 offset:32768
    v_cvt_pk_bf16_f32 v16, v136, v137
    v_exp_f32 v140, v140
    v_exp_f32 v141, v141
    v_mfma_f32_32x32x16_bf16 v[80:95], a[116:119], v[24:27], v[80:95]
    ds_read_b128 a[20:23], v213 offset:32768
    ds_read_b128 a[24:27], v214 offset:32768
    v_cvt_pk_bf16_f32 v17, v138, v139
    v_exp_f32 v142, v142
    v_mfma_f32_32x32x16_bf16 v[96:111], a[120:123], v[24:27], v[96:111]
    ds_read_b128 a[28:31], v215 offset:32768
    v_exp_f32 v143, v143
    v_cvt_pk_bf16_f32 v18, v140, v141
    v_exp_f32 v144, v144
    v_mfma_f32_32x32x16_bf16 v[112:127], a[124:127], v[24:27], v[112:127]
    v_exp_f32 v145, v145
    v_cvt_pk_bf16_f32 v19, v142, v143
    v_exp_f32 v146, v146
    v_mfma_f32_16x16x32_bf16 v[48:51], v[52:55], v[24:27], v[48:51]
    v_exp_f32 v147, v147
    s_bitcmp1_b32 s4, 0
    s_cbranch_scc1 L_st_141
L_bk_142:
    s_waitcnt lgkmcnt(0)
    v_mfma_f32_32x32x16_bf16 v[128:143], a[0:3], v[176:179], v[32:47]
    ds_read_b128 a[32:35], v208 offset:40960
    v_cvt_pk_bf16_f32 v20, v144, v145
    v_cvt_pk_bf16_f32 v21, v146, v147
    v_exp_f32 v148, v148
    v_mfma_f32_32x32x16_bf16 v[128:143], a[4:7], v[180:183], v[128:143]
    ds_read_b128 a[36:39], v209 offset:40960
    ds_read_b128 a[40:43], v210 offset:40960
    v_exp_f32 v149, v149
    v_exp_f32 v150, v150
    v_mfma_f32_32x32x16_bf16 v[128:143], a[8:11], v[184:187], v[128:143]
    ds_read_b128 a[44:47], v211 offset:40960
    v_exp_f32 v151, v151
    v_cvt_pk_bf16_f32 v22, v148, v149
    v_mfma_f32_32x32x16_bf16 v[128:143], a[12:15], v[188:191], v[128:143]
    ds_read_b32 v246, v247
    v_exp_f32 v152, v152
    v_exp_f32 v153, v153
    v_cvt_pk_bf16_f32 v23, v150, v151
    v_mfma_f32_32x32x16_bf16 v[128:143], a[16:19], v[192:195], v[128:143]
    ds_read_b128 a[48:51], v212 offset:40960
    v_exp_f32 v154, v154
    v_exp_f32 v155, v155
    v_mfma_f32_32x32x16_bf16 v[128:143], a[20:23], v[196:199], v[128:143]
    ds_read_b128 a[52:55], v213 offset:40960
    v_cvt_pk_bf16_f32 v24, v152, v153
    v_exp_f32 v156, v156
    v_exp_f32 v157, v157
    v_mfma_f32_32x32x16_bf16 v[128:143], a[24:27], v[200:203], v[128:143]
    ds_read_b128 a[56:59], v214 offset:40960
    v_cvt_pk_bf16_f32 v25, v154, v155
    v_exp_f32 v158, v158
    v_mfma_f32_32x32x16_bf16 v[128:143], a[28:31], v[204:207], v[128:143]
    ds_read_b128 a[60:63], v215 offset:40960
    v_exp_f32 v159, v159
    s_waitcnt lgkmcnt(4)
    v_cmp_le_u32 vcc, 56, v246
    v_cvt_pk_bf16_f32 v26, v156, v157
    v_cvt_pk_bf16_f32 v27, v158, v159
    v_mfma_f32_32x32x16_bf16 v[144:159], a[32:35], v[176:179], v[32:47]
    s_cbranch_vccz L_st_143
L_bk_144:
    ds_read_b64_tr_b16 a[64:65], v224 offset:0
    ds_read_b64_tr_b16 a[66:67], v224 offset:2048
    ds_read_b64_tr_b16 a[68:69], v225 offset:0
    v_mfma_f32_32x32x16_bf16 v[144:159], a[36:39], v[180:183], v[144:159]
    ds_read_b64_tr_b16 a[70:71], v225 offset:2048
    ds_read_b64_tr_b16 a[72:73], v226 offset:0
    v_max3_f32 v244, v128, v129, v130
    v_mfma_f32_32x32x16_bf16 v[144:159], a[40:43], v[184:187], v[144:159]
    ds_read_b64_tr_b16 a[74:75], v226 offset:2048
    ds_read_b64_tr_b16 a[76:77], v227 offset:0
    ds_read_b64_tr_b16 a[78:79], v227 offset:2048
    v_max3_f32 v244, v131, v132, v244
    v_mfma_f32_32x32x16_bf16 v[144:159], a[44:47], v[188:191], v[144:159]
    ds_read_b64_tr_b16 a[80:81], v224 offset:4096
    ds_read_b64_tr_b16 a[82:83], v224 offset:6144
    ds_read_b64_tr_b16 a[84:85], v225 offset:4096
    v_max3_f32 v244, v133, v134, v244
    s_waitcnt lgkmcnt(14)
    v_mfma_f32_32x32x16_bf16 v[144:159], a[48:51], v[192:195], v[144:159]
    ds_read_b64_tr_b16 a[86:87], v225 offset:6144
    ds_read_b64_tr_b16 a[88:89], v226 offset:4096
    v_max3_f32 v244, v135, v136, v244
    s_waitcnt lgkmcnt(15)
    v_mfma_f32_32x32x16_bf16 v[144:159], a[52:55], v[196:199], v[144:159]
    ds_read_b64_tr_b16 a[90:91], v226 offset:6144
    ds_read_b64_tr_b16 a[92:93], v227 offset:4096
    v_max3_f32 v244, v137, v138, v244
    v_max3_f32 v244, v139, v140, v244
    s_waitcnt lgkmcnt(15)
    v_mfma_f32_32x32x16_bf16 v[144:159], a[56:59], v[200:203], v[144:159]
    ds_read_b64_tr_b16 a[94:95], v227 offset:6144
    ds_read_b64_tr_b16 a[184:185], v232 offset:8192
    v_max3_f32 v244, v141, v142, v244
    v_mfma_f32_32x32x16_bf16 v[144:159], a[60:63], v[204:207], v[144:159]
    ds_read_b64_tr_b16 a[186:187], v232 offset:10240
    ds_read_b64_tr_b16 a[188:189], v232 offset:8200
    ds_read_b64_tr_b16 a[190:191], v232 offset:10248
    v_max_f32 v244, v143, v244
    s_waitcnt lgkmcnt(12)
    v_mfma_f32_32x32x16_bf16 v[64:79], a[64:67], v[160:163], v[64:79]
    ds_read_b64_tr_b16 a[96:97], v224 offset:8192
    ds_read_b64_tr_b16 a[98:99], v224 offset:10240
    ds_read_b64_tr_b16 a[100:101], v225 offset:8192
    ds_read_b64_tr_b16 a[102:103], v225 offset:10240
    v_mfma_f32_32x32x16_bf16 v[80:95], a[68:71], v[160:163], v[80:95]
    ds_read_b64_tr_b16 a[104:105], v226 offset:8192
    ds_read_b64_tr_b16 a[106:107], v226 offset:10240
    v_max3_f32 v244, v144, v145, v244
    v_max3_f32 v244, v146, v147, v244
    v_mfma_f32_32x32x16_bf16 v[96:111], a[72:75], v[160:163], v[96:111]
    ds_read_b64_tr_b16 a[108:109], v227 offset:8192
    ds_read_b64_tr_b16 a[110:111], v227 offset:10240
    v_max3_f32 v244, v148, v149, v244
    v_max3_f32 v244, v150, v151, v244
    v_mfma_f32_32x32x16_bf16 v[112:127], a[76:79], v[160:163], v[112:127]
    ds_read_b32 v246, v247
    v_max3_f32 v244, v152, v153, v244
    v_max3_f32 v244, v154, v155, v244
    v_max3_f32 v244, v156, v157, v244
    v_mfma_f32_16x16x32_bf16 v[48:51], v[52:55], v[160:163], v[48:51]
    ds_read_b64_tr_b16 a[112:113], v224 offset:12288
    s_waitcnt lgkmcnt(15)
    v_mfma_f32_32x32x16_bf16 v[64:79], a[80:83], v[164:167], v[64:79]
    ds_read_b64_tr_b16 a[114:115], v224 offset:14336
    ds_read_b64_tr_b16 a[116:117], v225 offset:12288
    v_max3_f32 v244, v158, v159, v244
    v_cmp_lt_f32 vcc, s5, v244
    v_mfma_f32_32x32x16_bf16 v[80:95], a[84:87], v[164:167], v[80:95]
    s_cbranch_vccnz L_st_145
L_bk_146:
    ds_read_b64_tr_b16 a[118:119], v225 offset:14336
    ds_read_b64_tr_b16 a[120:121], v226 offset:12288
    v_exp_f32 v128, v128
    v_mfma_f32_32x32x16_bf16 v[96:111], a[88:91], v[164:167], v[96:111]
    ds_read_b64_tr_b16 a[122:123], v226 offset:14336
    ds_read_b64_tr_b16 a[124:125], v227 offset:12288
    v_exp_f32 v129, v129
    s_waitcnt lgkmcnt(7)
    v_cmp_le_u32 vcc, 57, v246
    v_mfma_f32_32x32x16_bf16 v[112:127], a[92:95], v[164:167], v[112:127]
    ds_read_b64_tr_b16 a[126:127], v227 offset:14336
    v_exp_f32 v130, v130
    v_exp_f32 v131, v131
    v_mfma_f32_16x16x32_bf16 v[48:51], v[52:55], v[164:167], v[48:51]
    v_mov_b32 v249, 14
    v_mfma_f32_32x32x16_bf16 v[64:79], a[96:99], v[168:171], v[64:79]
    s_cbranch_vccz L_st_147
L_bk_148:
    v_cvt_pk_bf16_f32 v160, v128, v129
    v_exp_f32 v132, v132
    v_exp_f32 v133, v133
    v_mfma_f32_32x32x16_bf16 v[80:95], a[100:103], v[168:171], v[80:95]
    v_cvt_pk_bf16_f32 v161, v130, v131
    s_waitcnt lgkmcnt(0)
    ds_write_b32 v248, v249
    ds_read_b128 a[0:3], v208 offset:49152
    v_exp_f32 v134, v134
    v_mfma_f32_32x32x16_bf16 v[96:111], a[104:107], v[168:171], v[96:111]
    ds_read_b128 a[4:7], v209 offset:49152
    v_exp_f32 v135, v135
    v_cvt_pk_bf16_f32 v162, v132, v133
    v_exp_f32 v136, v136
    v_mfma_f32_32x32x16_bf16 v[112:127], a[108:111], v[168:171], v[112:127]
    ds_read_b128 a[8:11], v210 offset:49152
    v_exp_f32 v137, v137
    v_cvt_pk_bf16_f32 v163, v134, v135
    v_exp_f32 v138, v138
    v_mfma_f32_16x16x32_bf16 v[48:51], v[52:55], v[168:171], v[48:51]
    ds_read_b128 a[12:15], v211 offset:49152
    v_exp_f32 v139, v139
    v_mfma_f32_32x32x16_bf16 v[64:79], a[112:115], v[172:175], v[64:79]
    ds_read_b128 a[16:19], v212 offset:49152
    v_cvt_pk_bf16_f32 v164, v136, v137
    v_exp_f32 v140, v140
    v_exp_f32 v141, v141
    v_mfma_f32_32x32x16_bf16 v[80:95], a[116:119], v[172:175], v[80:95]
    ds_read_b128 a[20:23], v213 offset:49152
    ds_read_b128 a[24:27], v214 offset:49152
    v_cvt_pk_bf16_f32 v165, v138, v139
    v_exp_f32 v142, v142
    v_mfma_f32_32x32x16_bf16 v[96:111], a[120:123], v[172:175], v[96:111]
    ds_read_b128 a[28:31], v215 offset:49152
    v_exp_f32 v143, v143
    v_cvt_pk_bf16_f32 v166, v140, v141
    v_exp_f32 v144, v144
    v_mfma_f32_32x32x16_bf16 v[112:127], a[124:127], v[172:175], v[112:127]
    v_exp_f32 v145, v145
    v_cvt_pk_bf16_f32 v167, v142, v143
    v_exp_f32 v146, v146
    v_mfma_f32_16x16x32_bf16 v[48:51], v[52:55], v[172:175], v[48:51]
    v_exp_f32 v147, v147
    s_bitcmp1_b32 s4, 1
    s_cbranch_scc1 L_st_149
L_bk_150:
    s_waitcnt lgkmcnt(0)
    v_mfma_f32_32x32x16_bf16 v[128:143], a[0:3], v[176:179], v[32:47]
    ds_read_b128 a[32:35], v208 offset:57344
    v_cvt_pk_bf16_f32 v168, v144, v145
    v_cvt_pk_bf16_f32 v169, v146, v147
    v_exp_f32 v148, v148
    v_mfma_f32_32x32x16_bf16 v[128:143], a[4:7], v[180:183], v[128:143]
    ds_read_b128 a[36:39], v209 offset:57344
    ds_read_b128 a[40:43], v210 offset:57344
    v_exp_f32 v149, v149
    v_exp_f32 v150, v150
    v_mfma_f32_32x32x16_bf16 v[128:143], a[8:11], v[184:187], v[128:143]
    ds_read_b128 a[44:47], v211 offset:57344
    v_exp_f32 v151, v151
    v_cvt_pk_bf16_f32 v170, v148, v149
    v_mfma_f32_32x32x16_bf16 v[128:143], a[12:15], v[188:191], v[128:143]
    ds_read_b32 v246, v247
    v_exp_f32 v152, v152
    v_exp_f32 v153, v153
    v_cvt_pk_bf16_f32 v171, v150, v151
    v_mfma_f32_32x32x16_bf16 v[128:143], a[16:19], v[192:195], v[128:143]
    ds_read_b128 a[48:51], v212 offset:57344
    v_exp_f32 v154, v154
    v_exp_f32 v155, v155
    v_mfma_f32_32x32x16_bf16 v[128:143], a[20:23], v[196:199], v[128:143]
    ds_read_b128 a[52:55], v213 offset:57344
    v_cvt_pk_bf16_f32 v172, v152, v153
    v_exp_f32 v156, v156
    v_exp_f32 v157, v157
    v_mfma_f32_32x32x16_bf16 v[128:143], a[24:27], v[200:203], v[128:143]
    ds_read_b128 a[56:59], v214 offset:57344
    v_cvt_pk_bf16_f32 v173, v154, v155
    v_exp_f32 v158, v158
    v_mfma_f32_32x32x16_bf16 v[128:143], a[28:31], v[204:207], v[128:143]
    ds_read_b128 a[60:63], v215 offset:57344
    v_exp_f32 v159, v159
    s_waitcnt lgkmcnt(4)
    v_cmp_le_u32 vcc, 60, v246
    v_cvt_pk_bf16_f32 v174, v156, v157
    v_cvt_pk_bf16_f32 v175, v158, v159
    v_mfma_f32_32x32x16_bf16 v[144:159], a[32:35], v[176:179], v[32:47]
    s_cbranch_vccz L_st_151
L_bk_152:
    ds_read_b64_tr_b16 a[64:65], v224 offset:16384
    ds_read_b64_tr_b16 a[66:67], v224 offset:18432
    ds_read_b64_tr_b16 a[68:69], v225 offset:16384
    ds_read_b64_tr_b16 a[70:71], v225 offset:18432
    v_mfma_f32_32x32x16_bf16 v[144:159], a[36:39], v[180:183], v[144:159]
    ds_read_b64_tr_b16 a[72:73], v226 offset:16384
    ds_read_b64_tr_b16 a[74:75], v226 offset:18432
    ds_read_b64_tr_b16 a[76:77], v227 offset:16384
    ds_read_b64_tr_b16 a[78:79], v227 offset:18432
    v_max3_f32 v244, v128, v129, v130
    v_max3_f32 v244, v131, v132, v244
    v_mfma_f32_32x32x16_bf16 v[144:159], a[40:43], v[184:187], v[144:159]
    ds_read_b64_tr_b16 a[80:81], v224 offset:20480
    ds_read_b64_tr_b16 a[82:83], v224 offset:22528
    ds_read_b64_tr_b16 a[84:85], v225 offset:20480
    v_max3_f32 v244, v133, v134, v244
    v_max3_f32 v244, v135, v136, v244
    v_mfma_f32_32x32x16_bf16 v[144:159], a[44:47], v[188:191], v[144:159]
    ds_read_b64_tr_b16 a[86:87], v225 offset:22528
    ds_read_b64_tr_b16 a[88:89], v226 offset:20480
    ds_read_b64_tr_b16 a[90:91], v226 offset:22528
    ds_read_b64_tr_b16 a[92:93], v227 offset:20480
    v_max3_f32 v244, v137, v138, v244
    v_max3_f32 v244, v139, v140, v244
    s_waitcnt lgkmcnt(15)
    v_mfma_f32_32x32x16_bf16 v[144:159], a[48:51], v[192:195], v[144:159]
    ds_read_b64_tr_b16 a[94:95], v227 offset:22528
    ds_read_b64_tr_b16 a[192:193], v232 offset:16384
    ds_read_b64_tr_b16 a[194:195], v232 offset:18432
    ds_read_b64_tr_b16 a[196:197], v232 offset:16392
    v_max3_f32 v244, v141, v142, v244
    v_mfma_f32_32x32x16_bf16 v[144:159], a[52:55], v[196:199], v[144:159]
    ds_read_b64_tr_b16 a[198:199], v232 offset:18440
    v_max_f32 v244, v143, v244
    s_waitcnt vmcnt(0)
    v_cmp_le_u32 vcc, 32, v2
    s_cbranch_vccz L_st_157
L_bk_158:
    v_mfma_f32_32x32x16_bf16 v[144:159], a[56:59], v[200:203], v[144:159]
    s_lshl_b32 s66, s63, 3
    s_lshl_b32 s67, s60, 12
    v_add_u32 v2, s66, v0
    v_lshlrev_b32 v2, 7, v2
    v_add_u32 v2, 4, v2
    v_and_b32 v3, 3, v0
    v_lshl_add_u32 v3, v3, 3, s62
    v_lshlrev_b32 v3, 7, v3
    v_cmp_gt_u32 vcc, 8, v0
    s_nop 1
    v_cndmask_b32 v3, v3, v2, vcc
    buffer_load_dword v233, v3, s[48:51], s67 offen offset:64 sc1
    v_mfma_f32_32x32x16_bf16 v[144:159], a[60:63], v[204:207], v[144:159]
    s_waitcnt lgkmcnt(12)
    v_mfma_f32_32x32x16_bf16 v[64:79], a[64:67], v[12:15], v[64:79]
    ds_read_b64_tr_b16 a[96:97], v224 offset:24576
    ds_read_b64_tr_b16 a[98:99], v224 offset:26624
    ds_read_b64_tr_b16 a[100:101], v225 offset:24576
    ds_read_b64_tr_b16 a[102:103], v225 offset:26624
    v_mfma_f32_32x32x16_bf16 v[80:95], a[68:71], v[12:15], v[80:95]
    ds_read_b64_tr_b16 a[104:105], v226 offset:24576
    ds_read_b64_tr_b16 a[106:107], v226 offset:26624
    s_nop 2
    v_max3_f32 v244, v144, v145, v244
    v_max3_f32 v244, v146, v147, v244
    v_mfma_f32_32x32x16_bf16 v[96:111], a[72:75], v[12:15], v[96:111]
    ds_read_b64_tr_b16 a[108:109], v227 offset:24576
    ds_read_b64_tr_b16 a[110:111], v227 offset:26624
    v_max3_f32 v244, v148, v149, v244
    v_max3_f32 v244, v150, v151, v244
    v_mfma_f32_32x32x16_bf16 v[112:127], a[76:79], v[12:15], v[112:127]
    ds_read_b32 v246, v247
    v_max3_f32 v244, v152, v153, v244
    v_max3_f32 v244, v154, v155, v244
    v_max3_f32 v244, v156, v157, v244
    v_mfma_f32_16x16x32_bf16 v[48:51], v[52:55], v[12:15], v[48:51]
    ds_read_b64_tr_b16 a[112:113], v224 offset:28672
    s_waitcnt lgkmcnt(15)
    v_mfma_f32_32x32x16_bf16 v[64:79], a[80:83], v[16:19], v[64:79]
    ds_read_b64_tr_b16 a[114:115], v224 offset:30720
    ds_read_b64_tr_b16 a[116:117], v225 offset:28672
    v_max3_f32 v244, v158, v159, v244
    v_cmp_lt_f32 vcc, s5, v244
    v_mfma_f32_32x32x16_bf16 v[80:95], a[84:87], v[16:19], v[80:95]
    s_cbranch_vccnz L_st_153
L_bk_154:
    ds_read_b64_tr_b16 a[118:119], v225 offset:30720
    ds_read_b64_tr_b16 a[120:121], v226 offset:28672
    v_exp_f32 v128, v128
    v_mfma_f32_32x32x16_bf16 v[96:111], a[88:91], v[16:19], v[96:111]
    ds_read_b64_tr_b16 a[122:123], v226 offset:30720
    ds_read_b64_tr_b16 a[124:125], v227 offset:28672
    v_exp_f32 v129, v129
    s_waitcnt lgkmcnt(7)
    v_cmp_le_u32 vcc, 61, v246
    v_mfma_f32_32x32x16_bf16 v[112:127], a[92:95], v[16:19], v[112:127]
    ds_read_b64_tr_b16 a[126:127], v227 offset:30720
    v_exp_f32 v130, v130
    v_exp_f32 v131, v131
    v_mfma_f32_16x16x32_bf16 v[48:51], v[52:55], v[16:19], v[48:51]
    v_mov_b32 v249, 15
    v_mfma_f32_32x32x16_bf16 v[64:79], a[96:99], v[20:23], v[64:79]
    s_cbranch_vccz L_st_155
L_bk_156:
    v_cvt_pk_bf16_f32 v12, v128, v129
    v_exp_f32 v132, v132
    v_exp_f32 v133, v133
    v_mfma_f32_32x32x16_bf16 v[80:95], a[100:103], v[20:23], v[80:95]
    v_cvt_pk_bf16_f32 v13, v130, v131
    s_waitcnt lgkmcnt(0)
    ds_write_b32 v248, v249
    ds_read_b128 a[0:3], v208 offset:0
    v_exp_f32 v134, v134
    v_mfma_f32_32x32x16_bf16 v[96:111], a[104:107], v[20:23], v[96:111]
    ds_read_b128 a[4:7], v209 offset:0
    v_exp_f32 v135, v135
    v_cvt_pk_bf16_f32 v14, v132, v133
    v_exp_f32 v136, v136
    v_mfma_f32_32x32x16_bf16 v[112:127], a[108:111], v[20:23], v[112:127]
    ds_read_b128 a[8:11], v210 offset:0
    v_exp_f32 v137, v137
    v_cvt_pk_bf16_f32 v15, v134, v135
    v_exp_f32 v138, v138
    v_mfma_f32_16x16x32_bf16 v[48:51], v[52:55], v[20:23], v[48:51]
    ds_read_b128 a[12:15], v211 offset:0
    v_exp_f32 v139, v139
    v_mfma_f32_32x32x16_bf16 v[64:79], a[112:115], v[24:27], v[64:79]
    ds_read_b128 a[16:19], v212 offset:0
    v_cvt_pk_bf16_f32 v16, v136, v137
    v_exp_f32 v140, v140
    v_exp_f32 v141, v141
    v_mfma_f32_32x32x16_bf16 v[80:95], a[116:119], v[24:27], v[80:95]
    ds_read_b128 a[20:23], v213 offset:0
    ds_read_b128 a[24:27], v214 offset:0
    v_cvt_pk_bf16_f32 v17, v138, v139
    v_exp_f32 v142, v142
    v_mfma_f32_32x32x16_bf16 v[96:111], a[120:123], v[24:27], v[96:111]
    ds_read_b128 a[28:31], v215 offset:0
    v_exp_f32 v143, v143
    v_cvt_pk_bf16_f32 v18, v140, v141
    v_exp_f32 v144, v144
    v_mfma_f32_32x32x16_bf16 v[112:127], a[124:127], v[24:27], v[112:127]
    v_exp_f32 v145, v145
    v_cvt_pk_bf16_f32 v19, v142, v143
    v_exp_f32 v146, v146
    v_mfma_f32_16x16x32_bf16 v[48:51], v[52:55], v[24:27], v[48:51]
    v_exp_f32 v147, v147
    s_bitcmp1_b32 s4, 0
    s_cbranch_scc1 L_st_159
L_bk_160:
    s_waitcnt lgkmcnt(0)
    v_mfma_f32_32x32x16_bf16 v[128:143], a[0:3], v[176:179], v[32:47]
    ds_read_b128 a[32:35], v208 offset:8192
    v_cvt_pk_bf16_f32 v20, v144, v145
    v_cvt_pk_bf16_f32 v21, v146, v147
    v_exp_f32 v148, v148
    v_mfma_f32_32x32x16_bf16 v[128:143], a[4:7], v[180:183], v[128:143]
    ds_read_b128 a[36:39], v209 offset:8192
    ds_read_b128 a[40:43], v210 offset:8192
    v_exp_f32 v149, v149
    v_exp_f32 v150, v150
    v_mfma_f32_32x32x16_bf16 v[128:143], a[8:11], v[184:187], v[128:143]
    ds_read_b128 a[44:47], v211 offset:8192
    v_exp_f32 v151, v151
    v_cvt_pk_bf16_f32 v22, v148, v149
    v_mfma_f32_32x32x16_bf16 v[128:143], a[12:15], v[188:191], v[128:143]
    ds_read_b32 v246, v247
    v_exp_f32 v152, v152
    v_exp_f32 v153, v153
    v_cvt_pk_bf16_f32 v23, v150, v151
    v_mfma_f32_32x32x16_bf16 v[128:143], a[16:19], v[192:195], v[128:143]
    ds_read_b128 a[48:51], v212 offset:8192
    v_exp_f32 v154, v154
    v_exp_f32 v155, v155
    v_mfma_f32_32x32x16_bf16 v[128:143], a[20:23], v[196:199], v[128:143]
    ds_read_b128 a[52:55], v213 offset:8192
    v_cvt_pk_bf16_f32 v24, v152, v153
    v_exp_f32 v156, v156
    v_exp_f32 v157, v157
    v_mfma_f32_32x32x16_bf16 v[128:143], a[24:27], v[200:203], v[128:143]
    ds_read_b128 a[56:59], v214 offset:8192
    v_cvt_pk_bf16_f32 v25, v154, v155
    v_exp_f32 v158, v158
    v_mfma_f32_32x32x16_bf16 v[128:143], a[28:31], v[204:207], v[128:143]
    ds_read_b128 a[60:63], v215 offset:8192
    v_exp_f32 v159, v159
    s_waitcnt lgkmcnt(4)
    v_cmp_le_u32 vcc, 64, v246
    v_cvt_pk_bf16_f32 v26, v156, v157
    v_cvt_pk_bf16_f32 v27, v158, v159
    v_mfma_f32_32x32x16_bf16 v[144:159], a[32:35], v[176:179], v[32:47]
    s_cbranch_vccz L_st_161
L_bk_162:
    ds_read_b64_tr_b16 a[64:65], v224 offset:32768
    ds_read_b64_tr_b16 a[66:67], v224 offset:34816
    ds_read_b64_tr_b16 a[68:69], v225 offset:32768
    v_mfma_f32_32x32x16_bf16 v[144:159], a[36:39], v[180:183], v[144:159]
    ds_read_b64_tr_b16 a[70:71], v225 offset:34816
    ds_read_b64_tr_b16 a[72:73], v226 offset:32768
    v_max3_f32 v244, v128, v129, v130
    v_mfma_f32_32x32x16_bf16 v[144:159], a[40:43], v[184:187], v[144:159]
    ds_read_b64_tr_b16 a[74:75], v226 offset:34816
    ds_read_b64_tr_b16 a[76:77], v227 offset:32768
    ds_read_b64_tr_b16 a[78:79], v227 offset:34816
    v_max3_f32 v244, v131, v132, v244
    v_mfma_f32_32x32x16_bf16 v[144:159], a[44:47], v[188:191], v[144:159]
    ds_read_b64_tr_b16 a[80:81], v224 offset:36864
    ds_read_b64_tr_b16 a[82:83], v224 offset:38912
    ds_read_b64_tr_b16 a[84:85], v225 offset:36864
    v_max3_f32 v244, v133, v134, v244
    s_waitcnt lgkmcnt(14)
    v_mfma_f32_32x32x16_bf16 v[144:159], a[48:51], v[192:195], v[144:159]
    ds_read_b64_tr_b16 a[86:87], v225 offset:38912
    ds_read_b64_tr_b16 a[88:89], v226 offset:36864
    v_max3_f32 v244, v135, v136, v244
    s_waitcnt lgkmcnt(15)
    v_mfma_f32_32x32x16_bf16 v[144:159], a[52:55], v[196:199], v[144:159]
    ds_read_b64_tr_b16 a[90:91], v226 offset:38912
    ds_read_b64_tr_b16 a[92:93], v227 offset:36864
    v_max3_f32 v244, v137, v138, v244
    v_max3_f32 v244, v139, v140, v244
    s_waitcnt lgkmcnt(15)
    v_mfma_f32_32x32x16_bf16 v[144:159], a[56:59], v[200:203], v[144:159]
    ds_read_b64_tr_b16 a[94:95], v227 offset:38912
    ds_read_b64_tr_b16 a[200:201], v232 offset:0
    v_max3_f32 v244, v141, v142, v244
    v_mfma_f32_32x32x16_bf16 v[144:159], a[60:63], v[204:207], v[144:159]
    ds_read_b64_tr_b16 a[202:203], v232 offset:2048
    ds_read_b64_tr_b16 a[204:205], v232 offset:8
    ds_read_b64_tr_b16 a[206:207], v232 offset:2056
    v_max_f32 v244, v143, v244
    s_waitcnt lgkmcnt(12)
    v_mfma_f32_32x32x16_bf16 v[64:79], a[64:67], v[160:163], v[64:79]
    ds_read_b64_tr_b16 a[96:97], v224 offset:40960
    ds_read_b64_tr_b16 a[98:99], v224 offset:43008
    ds_read_b64_tr_b16 a[100:101], v225 offset:40960
    ds_read_b64_tr_b16 a[102:103], v225 offset:43008
    v_mfma_f32_32x32x16_bf16 v[80:95], a[68:71], v[160:163], v[80:95]
    ds_read_b64_tr_b16 a[104:105], v226 offset:40960
    ds_read_b64_tr_b16 a[106:107], v226 offset:43008
    v_max3_f32 v244, v144, v145, v244
    v_max3_f32 v244, v146, v147, v244
    v_mfma_f32_32x32x16_bf16 v[96:111], a[72:75], v[160:163], v[96:111]
    ds_read_b64_tr_b16 a[108:109], v227 offset:40960
    ds_read_b64_tr_b16 a[110:111], v227 offset:43008
    v_max3_f32 v244, v148, v149, v244
    v_max3_f32 v244, v150, v151, v244
    v_mfma_f32_32x32x16_bf16 v[112:127], a[76:79], v[160:163], v[112:127]
    ds_read_b32 v246, v247
    v_max3_f32 v244, v152, v153, v244
    v_max3_f32 v244, v154, v155, v244
    v_max3_f32 v244, v156, v157, v244
    v_mfma_f32_16x16x32_bf16 v[48:51], v[52:55], v[160:163], v[48:51]
    ds_read_b64_tr_b16 a[112:113], v224 offset:45056
    s_waitcnt lgkmcnt(15)
    v_mfma_f32_32x32x16_bf16 v[64:79], a[80:83], v[164:167], v[64:79]
    ds_read_b64_tr_b16 a[114:115], v224 offset:47104
    ds_read_b64_tr_b16 a[116:117], v225 offset:45056
    v_max3_f32 v244, v158, v159, v244
    v_cmp_lt_f32 vcc, s5, v244
    v_mfma_f32_32x32x16_bf16 v[80:95], a[84:87], v[164:167], v[80:95]
    s_cbranch_vccnz L_st_163
L_bk_164:
    ds_read_b64_tr_b16 a[118:119], v225 offset:47104
    ds_read_b64_tr_b16 a[120:121], v226 offset:45056
    v_exp_f32 v128, v128
    v_mfma_f32_32x32x16_bf16 v[96:111], a[88:91], v[164:167], v[96:111]
    ds_read_b64_tr_b16 a[122:123], v226 offset:47104
    ds_read_b64_tr_b16 a[124:125], v227 offset:45056
    v_exp_f32 v129, v129
    s_waitcnt lgkmcnt(7)
    v_cmp_le_u32 vcc, 66, v246
    v_mfma_f32_32x32x16_bf16 v[112:127], a[92:95], v[164:167], v[112:127]
    ds_read_b64_tr_b16 a[126:127], v227 offset:47104
    v_exp_f32 v130, v130
    v_exp_f32 v131, v131
    v_mfma_f32_16x16x32_bf16 v[48:51], v[52:55], v[164:167], v[48:51]
    v_mov_b32 v249, 16
    v_mfma_f32_32x32x16_bf16 v[64:79], a[96:99], v[168:171], v[64:79]
    s_cbranch_vccz L_st_165
L_bk_166:
    v_cvt_pk_bf16_f32 v160, v128, v129
    v_exp_f32 v132, v132
    v_exp_f32 v133, v133
    v_mfma_f32_32x32x16_bf16 v[80:95], a[100:103], v[168:171], v[80:95]
    v_cvt_pk_bf16_f32 v161, v130, v131
    s_waitcnt lgkmcnt(0)
    ds_write_b32 v248, v249
    ds_read_b128 a[0:3], v208 offset:16384
    v_exp_f32 v134, v134
    v_mfma_f32_32x32x16_bf16 v[96:111], a[104:107], v[168:171], v[96:111]
    ds_read_b128 a[4:7], v209 offset:16384
    v_exp_f32 v135, v135
    v_cvt_pk_bf16_f32 v162, v132, v133
    v_exp_f32 v136, v136
    v_mfma_f32_32x32x16_bf16 v[112:127], a[108:111], v[168:171], v[112:127]
    ds_read_b128 a[8:11], v210 offset:16384
    v_exp_f32 v137, v137
    v_cvt_pk_bf16_f32 v163, v134, v135
    v_exp_f32 v138, v138
    v_mfma_f32_16x16x32_bf16 v[48:51], v[52:55], v[168:171], v[48:51]
    ds_read_b128 a[12:15], v211 offset:16384
    v_exp_f32 v139, v139
    v_mfma_f32_32x32x16_bf16 v[64:79], a[112:115], v[172:175], v[64:79]
    ds_read_b128 a[16:19], v212 offset:16384
    v_cvt_pk_bf16_f32 v164, v136, v137
    v_exp_f32 v140, v140
    v_exp_f32 v141, v141
    v_mfma_f32_32x32x16_bf16 v[80:95], a[116:119], v[172:175], v[80:95]
    ds_read_b128 a[20:23], v213 offset:16384
    ds_read_b128 a[24:27], v214 offset:16384
    v_cvt_pk_bf16_f32 v165, v138, v139
    v_exp_f32 v142, v142
    v_mfma_f32_32x32x16_bf16 v[96:111], a[120:123], v[172:175], v[96:111]
    ds_read_b128 a[28:31], v215 offset:16384
    v_exp_f32 v143, v143
    v_cvt_pk_bf16_f32 v166, v140, v141
    v_exp_f32 v144, v144
    v_mfma_f32_32x32x16_bf16 v[112:127], a[124:127], v[172:175], v[112:127]
    v_exp_f32 v145, v145
    v_cvt_pk_bf16_f32 v167, v142, v143
    v_exp_f32 v146, v146
    v_mfma_f32_16x16x32_bf16 v[48:51], v[52:55], v[172:175], v[48:51]
    v_exp_f32 v147, v147
    s_bitcmp1_b32 s4, 1
    s_cbranch_scc1 L_st_167
L_bk_168:
    s_waitcnt lgkmcnt(0)
    v_mfma_f32_32x32x16_bf16 v[128:143], a[0:3], v[176:179], v[32:47]
    ds_read_b128 a[32:35], v208 offset:24576
    v_cvt_pk_bf16_f32 v168, v144, v145
    v_cvt_pk_bf16_f32 v169, v146, v147
    v_exp_f32 v148, v148
    v_mfma_f32_32x32x16_bf16 v[128:143], a[4:7], v[180:183], v[128:143]
    ds_read_b128 a[36:39], v209 offset:24576
    ds_read_b128 a[40:43], v210 offset:24576
    v_exp_f32 v149, v149
    v_exp_f32 v150, v150
    v_mfma_f32_32x32x16_bf16 v[128:143], a[8:11], v[184:187], v[128:143]
    ds_read_b128 a[44:47], v211 offset:24576
    v_exp_f32 v151, v151
    v_cvt_pk_bf16_f32 v170, v148, v149
    v_mfma_f32_32x32x16_bf16 v[128:143], a[12:15], v[188:191], v[128:143]
    ds_read_b32 v246, v247
    v_exp_f32 v152, v152
    v_exp_f32 v153, v153
    v_cvt_pk_bf16_f32 v171, v150, v151
    v_mfma_f32_32x32x16_bf16 v[128:143], a[16:19], v[192:195], v[128:143]
    ds_read_b128 a[48:51], v212 offset:24576
    v_exp_f32 v154, v154
    v_exp_f32 v155, v155
    v_mfma_f32_32x32x16_bf16 v[128:143], a[20:23], v[196:199], v[128:143]
    ds_read_b128 a[52:55], v213 offset:24576
    v_cvt_pk_bf16_f32 v172, v152, v153
    v_exp_f32 v156, v156
    v_exp_f32 v157, v157
    v_mfma_f32_32x32x16_bf16 v[128:143], a[24:27], v[200:203], v[128:143]
    ds_read_b128 a[56:59], v214 offset:24576
    v_cvt_pk_bf16_f32 v173, v154, v155
    v_exp_f32 v158, v158
    v_mfma_f32_32x32x16_bf16 v[128:143], a[28:31], v[204:207], v[128:143]
    ds_read_b128 a[60:63], v215 offset:24576
    v_exp_f32 v159, v159
    s_waitcnt lgkmcnt(4)
    v_cmp_le_u32 vcc, 68, v246
    v_cvt_pk_bf16_f32 v174, v156, v157
    v_cvt_pk_bf16_f32 v175, v158, v159
    v_mfma_f32_32x32x16_bf16 v[144:159], a[32:35], v[176:179], v[32:47]
    s_cbranch_vccz L_st_169
L_bk_170:
    ds_read_b64_tr_b16 a[64:65], v224 offset:49152
    ds_read_b64_tr_b16 a[66:67], v224 offset:51200
    ds_read_b64_tr_b16 a[68:69], v225 offset:49152
    v_mfma_f32_32x32x16_bf16 v[144:159], a[36:39], v[180:183], v[144:159]
    ds_read_b64_tr_b16 a[70:71], v225 offset:51200
    ds_read_b64_tr_b16 a[72:73], v226 offset:49152
    ds_read_b64_tr_b16 a[74:75], v226 offset:51200
    ds_read_b64_tr_b16 a[76:77], v227 offset:49152
    v_max3_f32 v244, v128, v129, v130
    v_mfma_f32_32x32x16_bf16 v[144:159], a[40:43], v[184:187], v[144:159]
    ds_read_b64_tr_b16 a[78:79], v227 offset:51200
    ds_read_b64_tr_b16 a[80:81], v224 offset:53248
    v_max3_f32 v244, v131, v132, v244
    v_max3_f32 v244, v133, v134, v244
    v_mfma_f32_32x32x16_bf16 v[144:159], a[44:47], v[188:191], v[144:159]
    ds_read_b64_tr_b16 a[82:83], v224 offset:55296
    ds_read_b64_tr_b16 a[84:85], v225 offset:53248
    ds_read_b64_tr_b16 a[86:87], v225 offset:55296
    ds_read_b64_tr_b16 a[88:89], v226 offset:53248
    v_max3_f32 v244, v135, v136, v244
    s_waitcnt lgkmcnt(15)
    v_mfma_f32_32x32x16_bf16 v[144:159], a[48:51], v[192:195], v[144:159]
    ds_read_b64_tr_b16 a[90:91], v226 offset:55296
    ds_read_b64_tr_b16 a[92:93], v227 offset:53248
    v_max3_f32 v244, v137, v138, v244
    v_max3_f32 v244, v139, v140, v244
    v_mfma_f32_32x32x16_bf16 v[144:159], a[52:55], v[196:199], v[144:159]
    ds_read_b64_tr_b16 a[94:95], v227 offset:55296
    ds_read_b64_tr_b16 a[208:209], v232 offset:8192
    ds_read_b64_tr_b16 a[210:211], v232 offset:10240
    v_max3_f32 v244, v141, v142, v244
    s_waitcnt lgkmcnt(15)
    v_mfma_f32_32x32x16_bf16 v[144:159], a[56:59], v[200:203], v[144:159]
    ds_read_b64_tr_b16 a[212:213], v232 offset:8200
    ds_read_b64_tr_b16 a[214:215], v232 offset:10248
    v_max_f32 v244, v143, v244
    s_waitcnt vmcnt(0)
    v_readlane_b32 s22, v233, s62
    s_nop 0
    s_mul_i32 s23, s22, -8
    v_mfma_f32_32x32x16_bf16 v[144:159], a[60:63], v[204:207], v[144:159]
    v_cmp_ne_u32 vcc, s7, v233
    s_nop 0
    s_cmp_eq_u32 vcc_hi, 0
    s_cselect_b32 s6, 15, 0
    s_waitcnt lgkmcnt(12)
    v_mfma_f32_32x32x16_bf16 v[64:79], a[64:67], v[12:15], v[64:79]
    ds_read_b64_tr_b16 a[96:97], v224 offset:57344
    ds_read_b64_tr_b16 a[98:99], v224 offset:59392
    ds_read_b64_tr_b16 a[100:101], v225 offset:57344
    ds_read_b64_tr_b16 a[102:103], v225 offset:59392
    v_mfma_f32_32x32x16_bf16 v[80:95], a[68:71], v[12:15], v[80:95]
    ds_read_b64_tr_b16 a[104:105], v226 offset:57344
    ds_read_b64_tr_b16 a[106:107], v226 offset:59392
    v_max3_f32 v244, v144, v145, v244
    v_max3_f32 v244, v146, v147, v244
    v_mfma_f32_32x32x16_bf16 v[96:111], a[72:75], v[12:15], v[96:111]
    ds_read_b64_tr_b16 a[108:109], v227 offset:57344
    ds_read_b64_tr_b16 a[110:111], v227 offset:59392
    v_max3_f32 v244, v148, v149, v244
    v_max3_f32 v244, v150, v151, v244
    v_mfma_f32_32x32x16_bf16 v[112:127], a[76:79], v[12:15], v[112:127]
    ds_read_b32 v246, v247
    v_max3_f32 v244, v152, v153, v244
    v_max3_f32 v244, v154, v155, v244
    v_max3_f32 v244, v156, v157, v244
    v_mfma_f32_16x16x32_bf16 v[48:51], v[52:55], v[12:15], v[48:51]
    ds_read_b64_tr_b16 a[112:113], v224 offset:61440
    s_waitcnt lgkmcnt(15)
    v_mfma_f32_32x32x16_bf16 v[64:79], a[80:83], v[16:19], v[64:79]
    ds_read_b64_tr_b16 a[114:115], v224 offset:63488
    ds_read_b64_tr_b16 a[116:117], v225 offset:61440
    v_max3_f32 v244, v158, v159, v244
    v_cmp_lt_f32 vcc, s5, v244
    v_mfma_f32_32x32x16_bf16 v[80:95], a[84:87], v[16:19], v[80:95]
    s_cbranch_vccnz L_st_171
L_bk_172:
    ds_read_b64_tr_b16 a[118:119], v225 offset:63488
    ds_read_b64_tr_b16 a[120:121], v226 offset:61440
    v_exp_f32 v128, v128
    v_mfma_f32_32x32x16_bf16 v[96:111], a[88:91], v[16:19], v[96:111]
    ds_read_b64_tr_b16 a[122:123], v226 offset:63488
    ds_read_b64_tr_b16 a[124:125], v227 offset:61440
    v_exp_f32 v129, v129
    s_waitcnt lgkmcnt(7)
    v_cmp_le_u32 vcc, 70, v246
    v_mfma_f32_32x32x16_bf16 v[112:127], a[92:95], v[16:19], v[112:127]
    ds_read_b64_tr_b16 a[126:127], v227 offset:63488
    v_exp_f32 v130, v130
    v_exp_f32 v131, v131
    v_mfma_f32_16x16x32_bf16 v[48:51], v[52:55], v[16:19], v[48:51]
    v_mov_b32 v249, 17
    v_mfma_f32_32x32x16_bf16 v[64:79], a[96:99], v[20:23], v[64:79]
    s_cbranch_vccz L_st_173
L_bk_174:
    v_cvt_pk_bf16_f32 v12, v128, v129
    v_exp_f32 v132, v132
    v_exp_f32 v133, v133
    v_mfma_f32_32x32x16_bf16 v[80:95], a[100:103], v[20:23], v[80:95]
    v_cvt_pk_bf16_f32 v13, v130, v131
    s_waitcnt lgkmcnt(0)
    ds_write_b32 v248, v249
    ds_read_b128 a[0:3], v208 offset:32768
    v_exp_f32 v134, v134
    v_mfma_f32_32x32x16_bf16 v[96:111], a[104:107], v[20:23], v[96:111]
    ds_read_b128 a[4:7], v209 offset:32768
    v_exp_f32 v135, v135
    v_cvt_pk_bf16_f32 v14, v132, v133
    v_exp_f32 v136, v136
    v_mfma_f32_32x32x16_bf16 v[112:127], a[108:111], v[20:23], v[112:127]
    ds_read_b128 a[8:11], v210 offset:32768
    v_exp_f32 v137, v137
    v_cvt_pk_bf16_f32 v15, v134, v135
    v_exp_f32 v138, v138
    v_mfma_f32_16x16x32_bf16 v[48:51], v[52:55], v[20:23], v[48:51]
    ds_read_b128 a[12:15], v211 offset:32768
    v_exp_f32 v139, v139
    v_mfma_f32_32x32x16_bf16 v[64:79], a[112:115], v[24:27], v[64:79]
    ds_read_b128 a[16:19], v212 offset:32768
    v_cvt_pk_bf16_f32 v16, v136, v137
    v_exp_f32 v140, v140
    v_exp_f32 v141, v141
    v_mfma_f32_32x32x16_bf16 v[80:95], a[116:119], v[24:27], v[80:95]
    ds_read_b128 a[20:23], v213 offset:32768
    ds_read_b128 a[24:27], v214 offset:32768
    v_cvt_pk_bf16_f32 v17, v138, v139
    v_exp_f32 v142, v142
    v_mfma_f32_32x32x16_bf16 v[96:111], a[120:123], v[24:27], v[96:111]
    ds_read_b128 a[28:31], v215 offset:32768
    v_exp_f32 v143, v143
    v_cvt_pk_bf16_f32 v18, v140, v141
    v_exp_f32 v144, v144
    v_mfma_f32_32x32x16_bf16 v[112:127], a[124:127], v[24:27], v[112:127]
    v_exp_f32 v145, v145
    v_cvt_pk_bf16_f32 v19, v142, v143
    v_exp_f32 v146, v146
    v_mfma_f32_16x16x32_bf16 v[48:51], v[52:55], v[24:27], v[48:51]
    v_exp_f32 v147, v147
    s_bitcmp1_b32 s4, 0
    s_cbranch_scc1 L_st_175
L_bk_176:
    s_waitcnt lgkmcnt(0)
    v_mfma_f32_32x32x16_bf16 v[128:143], a[0:3], v[176:179], v[32:47]
    ds_read_b128 a[32:35], v208 offset:40960
    v_cvt_pk_bf16_f32 v20, v144, v145
    v_cvt_pk_bf16_f32 v21, v146, v147
    v_exp_f32 v148, v148
    v_mfma_f32_32x32x16_bf16 v[128:143], a[4:7], v[180:183], v[128:143]
    ds_read_b128 a[36:39], v209 offset:40960
    ds_read_b128 a[40:43], v210 offset:40960
    v_exp_f32 v149, v149
    v_exp_f32 v150, v150
    v_mfma_f32_32x32x16_bf16 v[128:143], a[8:11], v[184:187], v[128:143]
    ds_read_b128 a[44:47], v211 offset:40960
    v_exp_f32 v151, v151
    v_cvt_pk_bf16_f32 v22, v148, v149
    v_mfma_f32_32x32x16_bf16 v[128:143], a[12:15], v[188:191], v[128:143]
    ds_read_b32 v246, v247
    v_exp_f32 v152, v152
    v_exp_f32 v153, v153
    v_cvt_pk_bf16_f32 v23, v150, v151
    v_mfma_f32_32x32x16_bf16 v[128:143], a[16:19], v[192:195], v[128:143]
    ds_read_b128 a[48:51], v212 offset:40960
    v_exp_f32 v154, v154
    v_exp_f32 v155, v155
    v_mfma_f32_32x32x16_bf16 v[128:143], a[20:23], v[196:199], v[128:143]
    ds_read_b128 a[52:55], v213 offset:40960
    v_cvt_pk_bf16_f32 v24, v152, v153
    v_exp_f32 v156, v156
    v_exp_f32 v157, v157
    v_mfma_f32_32x32x16_bf16 v[128:143], a[24:27], v[200:203], v[128:143]
    ds_read_b128 a[56:59], v214 offset:40960
    v_cvt_pk_bf16_f32 v25, v154, v155
    v_exp_f32 v158, v158
    v_mfma_f32_32x32x16_bf16 v[128:143], a[28:31], v[204:207], v[128:143]
    ds_read_b128 a[60:63], v215 offset:40960
    v_exp_f32 v159, v159
    s_waitcnt lgkmcnt(4)
    v_cmp_le_u32 vcc, 73, v246
    v_cvt_pk_bf16_f32 v26, v156, v157
    v_cvt_pk_bf16_f32 v27, v158, v159
    v_mfma_f32_32x32x16_bf16 v[144:159], a[32:35], v[176:179], v[32:47]
    s_cbranch_vccz L_st_177
L_bk_178:
    ds_read_b64_tr_b16 a[64:65], v224 offset:0
    ds_read_b64_tr_b16 a[66:67], v224 offset:2048
    ds_read_b64_tr_b16 a[68:69], v225 offset:0
    ds_read_b64_tr_b16 a[70:71], v225 offset:2048
    v_mfma_f32_32x32x16_bf16 v[144:159], a[36:39], v[180:183], v[144:159]
    ds_read_b64_tr_b16 a[72:73], v226 offset:0
    ds_read_b64_tr_b16 a[74:75], v226 offset:2048
    ds_read_b64_tr_b16 a[76:77], v227 offset:0
    v_max3_f32 v244, v128, v129, v130
    v_max3_f32 v244, v131, v132, v244
    v_mfma_f32_32x32x16_bf16 v[144:159], a[40:43], v[184:187], v[144:159]
    ds_read_b64_tr_b16 a[78:79], v227 offset:2048
    ds_read_b64_tr_b16 a[80:81], v224 offset:4096
    ds_read_b64_tr_b16 a[82:83], v224 offset:6144
    ds_read_b64_tr_b16 a[84:85], v225 offset:4096
    v_max3_f32 v244, v133, v134, v244
    v_mfma_f32_32x32x16_bf16 v[144:159], a[44:47], v[188:191], v[144:159]
    ds_read_b64_tr_b16 a[86:87], v225 offset:6144
    ds_read_b64_tr_b16 a[88:89], v226 offset:4096
    ds_read_b64_tr_b16 a[90:91], v226 offset:6144
    v_max3_f32 v244, v135, v136, v244
    v_max3_f32 v244, v137, v138, v244
    s_waitcnt lgkmcnt(15)
    v_mfma_f32_32x32x16_bf16 v[144:159], a[48:51], v[192:195], v[144:159]
    ds_read_b64_tr_b16 a[92:93], v227 offset:4096
    ds_read_b64_tr_b16 a[94:95], v227 offset:6144
    ds_read_b64_tr_b16 a[216:217], v232 offset:16384
    v_max3_f32 v244, v139, v140, v244
    v_max3_f32 v244, v141, v142, v244
    v_mfma_f32_32x32x16_bf16 v[144:159], a[52:55], v[196:199], v[144:159]
    ds_read_b64_tr_b16 a[218:219], v232 offset:18432
    ds_read_b64_tr_b16 a[220:221], v232 offset:16392
    ds_read_b64_tr_b16 a[222:223], v232 offset:18440
    v_max_f32 v244, v143, v244
    v_mfma_f32_32x32x16_bf16 v[144:159], a[56:59], v[200:203], v[144:159]
    s_lshl_b32 s66, s69, 7
    s_lshl_b32 s67, s63, 2
    s_add_u32 s67, s67, s3
    s_lshl_b32 s67, s67, 2
    s_add_u32 s66, s66, s67
    v_lshl_add_u32 v2, v0, 10, s66
    s_waitcnt lgkmcnt(15)
    v_mfma_f32_32x32x16_bf16 v[144:159], a[60:63], v[204:207], v[144:159]
    s_mov_b32 vcc_hi, 0
    s_mov_b32 vcc_lo, s6
    v_cndmask_b32 v235, v235, v2, vcc
    s_xor_b32 vcc_lo, vcc_lo, 15
    v_cndmask_b32 v236, v236, v2, vcc
    s_waitcnt lgkmcnt(12)
    v_mfma_f32_32x32x16_bf16 v[64:79], a[64:67], v[160:163], v[64:79]
    ds_read_b64_tr_b16 a[96:97], v224 offset:8192
    ds_read_b64_tr_b16 a[98:99], v224 offset:10240
    ds_read_b64_tr_b16 a[100:101], v225 offset:8192
    ds_read_b64_tr_b16 a[102:103], v225 offset:10240
    v_mfma_f32_32x32x16_bf16 v[80:95], a[68:71], v[160:163], v[80:95]
    ds_read_b64_tr_b16 a[104:105], v226 offset:8192
    ds_read_b64_tr_b16 a[106:107], v226 offset:10240
    v_max3_f32 v244, v144, v145, v244
    v_max3_f32 v244, v146, v147, v244
    v_mfma_f32_32x32x16_bf16 v[96:111], a[72:75], v[160:163], v[96:111]
    ds_read_b64_tr_b16 a[108:109], v227 offset:8192
    ds_read_b64_tr_b16 a[110:111], v227 offset:10240
    v_max3_f32 v244, v148, v149, v244
    v_max3_f32 v244, v150, v151, v244
    v_mfma_f32_32x32x16_bf16 v[112:127], a[76:79], v[160:163], v[112:127]
    ds_read_b32 v246, v247
    v_max3_f32 v244, v152, v153, v244
    v_max3_f32 v244, v154, v155, v244
    v_max3_f32 v244, v156, v157, v244
    v_mfma_f32_16x16x32_bf16 v[48:51], v[52:55], v[160:163], v[48:51]
    ds_read_b64_tr_b16 a[112:113], v224 offset:12288
    s_waitcnt lgkmcnt(15)
    v_mfma_f32_32x32x16_bf16 v[64:79], a[80:83], v[164:167], v[64:79]
    ds_read_b64_tr_b16 a[114:115], v224 offset:14336
    ds_read_b64_tr_b16 a[116:117], v225 offset:12288
    v_max3_f32 v244, v158, v159, v244
    v_cmp_lt_f32 vcc, s5, v244
    v_mfma_f32_32x32x16_bf16 v[80:95], a[84:87], v[164:167], v[80:95]
    s_cbranch_vccnz L_st_179
L_bk_180:
    ds_read_b64_tr_b16 a[118:119], v225 offset:14336
    ds_read_b64_tr_b16 a[120:121], v226 offset:12288
    v_exp_f32 v128, v128
    v_mfma_f32_32x32x16_bf16 v[96:111], a[88:91], v[164:167], v[96:111]
    ds_read_b64_tr_b16 a[122:123], v226 offset:14336
    ds_read_b64_tr_b16 a[124:125], v227 offset:12288
    v_exp_f32 v129, v129
    s_waitcnt lgkmcnt(7)
    v_cmp_le_u32 vcc, 75, v246
    v_mfma_f32_32x32x16_bf16 v[112:127], a[92:95], v[164:167], v[112:127]
    ds_read_b64_tr_b16 a[126:127], v227 offset:14336
    v_exp_f32 v130, v130
    v_exp_f32 v131, v131
    v_mfma_f32_16x16x32_bf16 v[48:51], v[52:55], v[164:167], v[48:51]
    v_mov_b32 v249, 18
    v_mfma_f32_32x32x16_bf16 v[64:79], a[96:99], v[168:171], v[64:79]
    s_cbranch_vccz L_st_181
L_bk_182:
    v_cvt_pk_bf16_f32 v160, v128, v129
    v_exp_f32 v132, v132
    v_exp_f32 v133, v133
    v_mfma_f32_32x32x16_bf16 v[80:95], a[100:103], v[168:171], v[80:95]
    v_cvt_pk_bf16_f32 v161, v130, v131
    s_waitcnt lgkmcnt(0)
    ds_write_b32 v248, v249
    ds_read_b128 a[0:3], v208 offset:49152
    v_exp_f32 v134, v134
    v_mfma_f32_32x32x16_bf16 v[96:111], a[104:107], v[168:171], v[96:111]
    ds_read_b128 a[4:7], v209 offset:49152
    v_exp_f32 v135, v135
    v_cvt_pk_bf16_f32 v162, v132, v133
    v_exp_f32 v136, v136
    v_mfma_f32_32x32x16_bf16 v[112:127], a[108:111], v[168:171], v[112:127]
    ds_read_b128 a[8:11], v210 offset:49152
    v_exp_f32 v137, v137
    v_cvt_pk_bf16_f32 v163, v134, v135
    v_exp_f32 v138, v138
    v_mfma_f32_16x16x32_bf16 v[48:51], v[52:55], v[168:171], v[48:51]
    ds_read_b128 a[12:15], v211 offset:49152
    v_exp_f32 v139, v139
    v_mfma_f32_32x32x16_bf16 v[64:79], a[112:115], v[172:175], v[64:79]
    ds_read_b128 a[16:19], v212 offset:49152
    v_cvt_pk_bf16_f32 v164, v136, v137
    v_exp_f32 v140, v140
    v_exp_f32 v141, v141
    v_mfma_f32_32x32x16_bf16 v[80:95], a[116:119], v[172:175], v[80:95]
    ds_read_b128 a[20:23], v213 offset:49152
    ds_read_b128 a[24:27], v214 offset:49152
    v_cvt_pk_bf16_f32 v165, v138, v139
    v_exp_f32 v142, v142
    v_mfma_f32_32x32x16_bf16 v[96:111], a[120:123], v[172:175], v[96:111]
    ds_read_b128 a[28:31], v215 offset:49152
    v_exp_f32 v143, v143
    v_cvt_pk_bf16_f32 v166, v140, v141
    v_exp_f32 v144, v144
    v_mfma_f32_32x32x16_bf16 v[112:127], a[124:127], v[172:175], v[112:127]
    v_exp_f32 v145, v145
    v_cvt_pk_bf16_f32 v167, v142, v143
    v_exp_f32 v146, v146
    v_mfma_f32_16x16x32_bf16 v[48:51], v[52:55], v[172:175], v[48:51]
    v_exp_f32 v147, v147
    s_bitcmp1_b32 s4, 1
    s_cbranch_scc1 L_st_183
L_bk_184:
    s_waitcnt lgkmcnt(0)
    v_mfma_f32_32x32x16_bf16 v[128:143], a[0:3], v[176:179], v[32:47]
    ds_read_b128 a[32:35], v208 offset:57344
    v_cvt_pk_bf16_f32 v168, v144, v145
    v_cvt_pk_bf16_f32 v169, v146, v147
    v_exp_f32 v148, v148
    v_mfma_f32_32x32x16_bf16 v[128:143], a[4:7], v[180:183], v[128:143]
    ds_read_b128 a[36:39], v209 offset:57344
    v_exp_f32 v149, v149
    v_exp_f32 v150, v150
    v_mfma_f32_32x32x16_bf16 v[128:143], a[8:11], v[184:187], v[128:143]
    ds_read_b128 a[40:43], v210 offset:57344
    v_exp_f32 v151, v151
    v_cvt_pk_bf16_f32 v170, v148, v149
    v_exp_f32 v152, v152
    v_mfma_f32_32x32x16_bf16 v[128:143], a[12:15], v[188:191], v[128:143]
    ds_read_b128 a[44:47], v211 offset:57344
    v_exp_f32 v153, v153
    v_cvt_pk_bf16_f32 v171, v150, v151
    v_mfma_f32_32x32x16_bf16 v[128:143], a[16:19], v[192:195], v[128:143]
    ds_read_b128 a[48:51], v212 offset:57344
    v_exp_f32 v154, v154
    v_exp_f32 v155, v155
    v_mfma_f32_32x32x16_bf16 v[128:143], a[20:23], v[196:199], v[128:143]
    ds_read_b128 a[52:55], v213 offset:57344
    v_cvt_pk_bf16_f32 v172, v152, v153
    v_exp_f32 v156, v156
    v_exp_f32 v157, v157
    v_mfma_f32_32x32x16_bf16 v[128:143], a[24:27], v[200:203], v[128:143]
    ds_read_b128 a[56:59], v214 offset:57344
    v_cvt_pk_bf16_f32 v173, v154, v155
    v_exp_f32 v158, v158
    v_mfma_f32_32x32x16_bf16 v[128:143], a[28:31], v[204:207], v[128:143]
    ds_read_b128 a[60:63], v215 offset:57344
    v_exp_f32 v159, v159
    v_cvt_pk_bf16_f32 v174, v156, v157
    v_cvt_pk_bf16_f32 v175, v158, v159
    s_waitcnt lgkmcnt(7)
    v_mfma_f32_32x32x16_bf16 v[144:159], a[32:35], v[176:179], v[32:47]
    s_waitcnt lgkmcnt(6)
    v_mfma_f32_32x32x16_bf16 v[144:159], a[36:39], v[180:183], v[144:159]
    s_waitcnt lgkmcnt(5)
    v_mfma_f32_32x32x16_bf16 v[144:159], a[40:43], v[184:187], v[144:159]
    ds_read_b32 v246, v247
    ds_read_b64_tr_b16 a[64:65], v224 offset:16384
    ds_read_b64_tr_b16 a[66:67], v224 offset:18432
    v_max3_f32 v244, v128, v129, v130
    s_waitcnt lgkmcnt(7)
    v_mfma_f32_32x32x16_bf16 v[144:159], a[44:47], v[188:191], v[144:159]
    ds_read_b64_tr_b16 a[68:69], v225 offset:16384
    ds_read_b64_tr_b16 a[70:71], v225 offset:18432
    ds_read_b64_tr_b16 a[72:73], v226 offset:16384
    v_max3_f32 v244, v131, v132, v244
    v_max3_f32 v244, v133, v134, v244
    s_waitcnt lgkmcnt(9)
    v_mfma_f32_32x32x16_bf16 v[144:159], a[48:51], v[192:195], v[144:159]
    ds_read_b64_tr_b16 a[74:75], v226 offset:18432
    ds_read_b64_tr_b16 a[76:77], v227 offset:16384
    ds_read_b64_tr_b16 a[78:79], v227 offset:18432
    v_max3_f32 v244, v135, v136, v244
    s_waitcnt lgkmcnt(11)
    v_mfma_f32_32x32x16_bf16 v[144:159], a[52:55], v[196:199], v[144:159]
    ds_read_b64_tr_b16 a[80:81], v224 offset:20480
    ds_read_b64_tr_b16 a[82:83], v224 offset:22528
    v_max3_f32 v244, v137, v138, v244
    v_max3_f32 v244, v139, v140, v244
    s_waitcnt lgkmcnt(12)
    v_mfma_f32_32x32x16_bf16 v[144:159], a[56:59], v[200:203], v[144:159]
    ds_read_b64_tr_b16 a[84:85], v225 offset:20480
    ds_read_b64_tr_b16 a[86:87], v225 offset:22528
    ds_read_b64_tr_b16 a[88:89], v226 offset:20480
    ds_read_b64_tr_b16 a[90:91], v226 offset:22528
    v_max3_f32 v244, v141, v142, v244
    s_waitcnt lgkmcnt(15)
    v_mfma_f32_32x32x16_bf16 v[144:159], a[60:63], v[204:207], v[144:159]
    ds_read_b64_tr_b16 a[92:93], v227 offset:20480
    ds_read_b64_tr_b16 a[94:95], v227 offset:22528
    v_max_f32 v244, v143, v244
    s_waitcnt lgkmcnt(15)
    v_cmp_le_u32 vcc, 77, v246
    s_cbranch_vccz L_rt_185
L_rb_186:
    s_waitcnt lgkmcnt(14)
    v_mfma_f32_32x32x16_bf16 v[64:79], a[64:67], v[12:15], v[64:79]
    ds_read_b64_tr_b16 a[224:225], v232 offset:0
    ds_read_b64_tr_b16 a[226:227], v232 offset:2048
    ds_read_b64_tr_b16 a[228:229], v232 offset:8
    ds_read_b64_tr_b16 a[230:231], v232 offset:2056
    v_max3_f32 v244, v144, v145, v244
    s_waitcnt lgkmcnt(15)
    v_mfma_f32_32x32x16_bf16 v[80:95], a[68:71], v[12:15], v[80:95]
    v_max3_f32 v244, v146, v147, v244
    v_max3_f32 v244, v148, v149, v244
    v_max3_f32 v244, v150, v151, v244
    v_max3_f32 v244, v152, v153, v244
    s_waitcnt lgkmcnt(14)
    v_mfma_f32_32x32x16_bf16 v[96:111], a[72:75], v[12:15], v[96:111]
    v_max3_f32 v244, v154, v155, v244
    v_max3_f32 v244, v156, v157, v244
    v_max3_f32 v244, v158, v159, v244
    v_cmp_lt_f32 vcc, s5, v244
    s_cbranch_vccnz L_st_187
L_bk_188:
    s_waitcnt lgkmcnt(12)
    v_mfma_f32_32x32x16_bf16 v[112:127], a[76:79], v[12:15], v[112:127]
    ds_read_b32 v246, v247
    ds_read_b64_tr_b16 a[96:97], v224 offset:24576
    v_exp_f32 v128, v128
    v_exp_f32 v129, v129
    v_mfma_f32_16x16x32_bf16 v[48:51], v[52:55], v[12:15], v[48:51]
    ds_read_b64_tr_b16 a[98:99], v224 offset:26624
    ds_read_b64_tr_b16 a[100:101], v225 offset:24576
    s_waitcnt lgkmcnt(14)
    v_mfma_f32_32x32x16_bf16 v[64:79], a[80:83], v[16:19], v[64:79]
    ds_read_b64_tr_b16 a[102:103], v225 offset:26624
    ds_read_b64_tr_b16 a[104:105], v226 offset:24576
    ds_read_b64_tr_b16 a[106:107], v226 offset:26624
    v_exp_f32 v130, v130
    v_exp_f32 v131, v131
    s_waitcnt lgkmcnt(15)
    v_mfma_f32_32x32x16_bf16 v[80:95], a[84:87], v[16:19], v[80:95]
    ds_read_b64_tr_b16 a[108:109], v227 offset:24576
    ds_read_b64_tr_b16 a[110:111], v227 offset:26624
    ds_read_b64_tr_b16 a[112:113], v224 offset:28672
    v_cvt_pk_bf16_f32 v216, v128, v129
    v_exp_f32 v132, v132
    s_waitcnt lgkmcnt(15)
    v_mfma_f32_32x32x16_bf16 v[96:111], a[88:91], v[16:19], v[96:111]
    ds_read_b64_tr_b16 a[114:115], v224 offset:30720
    ds_read_b64_tr_b16 a[116:117], v225 offset:28672
    ds_read_b64_tr_b16 a[118:119], v225 offset:30720
    ds_read_b64_tr_b16 a[120:121], v226 offset:28672
    v_exp_f32 v133, v133
    v_cvt_pk_bf16_f32 v217, v130, v131
    s_waitcnt lgkmcnt(15)
    v_mfma_f32_32x32x16_bf16 v[112:127], a[92:95], v[16:19], v[112:127]
    ds_read_b64_tr_b16 a[122:123], v226 offset:30720
    ds_read_b64_tr_b16 a[124:125], v227 offset:28672
    ds_read_b64_tr_b16 a[126:127], v227 offset:30720
    v_exp_f32 v134, v134
    s_waitcnt lgkmcnt(15)
    v_cmp_le_u32 vcc, 78, v246
    v_mfma_f32_16x16x32_bf16 v[48:51], v[52:55], v[16:19], v[48:51]
    s_cbranch_vccz L_rt_189
L_rb_190:
    s_waitcnt lgkmcnt(14)
    v_mfma_f32_32x32x16_bf16 v[64:79], a[96:99], v[20:23], v[64:79]
    v_exp_f32 v135, v135
    v_cvt_pk_bf16_f32 v218, v132, v133
    s_waitcnt lgkmcnt(12)
    v_mfma_f32_32x32x16_bf16 v[80:95], a[100:103], v[20:23], v[80:95]
    v_exp_f32 v136, v136
    v_exp_f32 v137, v137
    s_waitcnt lgkmcnt(10)
    v_mfma_f32_32x32x16_bf16 v[96:111], a[104:107], v[20:23], v[96:111]
    v_cvt_pk_bf16_f32 v219, v134, v135
    v_mov_b32 v249, 19
    s_waitcnt lgkmcnt(0)
    ds_write_b32 v248, v249
    v_mfma_f32_32x32x16_bf16 v[112:127], a[108:111], v[20:23], v[112:127]
    ds_read_b32 v246, v247
    ds_read_b64_tr_b16 a[64:65], v224 offset:32768
    v_exp_f32 v138, v138
    v_exp_f32 v139, v139
    v_mfma_f32_16x16x32_bf16 v[48:51], v[52:55], v[20:23], v[48:51]
    ds_read_b64_tr_b16 a[66:67], v224 offset:34816
    ds_read_b64_tr_b16 a[68:69], v225 offset:32768
    v_mfma_f32_32x32x16_bf16 v[64:79], a[112:115], v[24:27], v[64:79]
    ds_read_b64_tr_b16 a[70:71], v225 offset:34816
    ds_read_b64_tr_b16 a[72:73], v226 offset:32768
    ds_read_b64_tr_b16 a[74:75], v226 offset:34816
    v_cvt_pk_bf16_f32 v220, v136, v137
    v_exp_f32 v140, v140
    v_mfma_f32_32x32x16_bf16 v[80:95], a[116:119], v[24:27], v[80:95]
    ds_read_b64_tr_b16 a[76:77], v227 offset:32768
    ds_read_b64_tr_b16 a[78:79], v227 offset:34816
    ds_read_b64_tr_b16 a[80:81], v224 offset:36864
    ds_read_b64_tr_b16 a[82:83], v224 offset:38912
    v_exp_f32 v141, v141
    v_cvt_pk_bf16_f32 v221, v138, v139
    v_mfma_f32_32x32x16_bf16 v[96:111], a[120:123], v[24:27], v[96:111]
    ds_read_b64_tr_b16 a[84:85], v225 offset:36864
    ds_read_b64_tr_b16 a[86:87], v225 offset:38912
    ds_read_b64_tr_b16 a[88:89], v226 offset:36864
    v_exp_f32 v142, v142
    v_mfma_f32_32x32x16_bf16 v[112:127], a[124:127], v[24:27], v[112:127]
    ds_read_b64_tr_b16 a[90:91], v226 offset:38912
    ds_read_b64_tr_b16 a[92:93], v227 offset:36864
    ds_read_b64_tr_b16 a[94:95], v227 offset:38912
    v_exp_f32 v143, v143
    v_cvt_pk_bf16_f32 v222, v140, v141
    s_waitcnt lgkmcnt(15)
    v_cmp_le_u32 vcc, 82, v246
    v_mfma_f32_16x16x32_bf16 v[48:51], v[52:55], v[24:27], v[48:51]
    s_bitcmp1_b32 s4, 0
    s_cbranch_scc1 L_st_191
L_bk_192:
    s_cbranch_vccz L_rt_193
L_rb_194:
    s_waitcnt lgkmcnt(14)
    v_mfma_f32_32x32x16_bf16 v[64:79], a[64:67], v[160:163], v[64:79]
    ds_read_b64_tr_b16 a[232:233], v232 offset:8192
    ds_read_b64_tr_b16 a[234:235], v232 offset:10240
    ds_read_b64_tr_b16 a[236:237], v232 offset:8200
    ds_read_b64_tr_b16 a[238:239], v232 offset:10248
    s_waitcnt lgkmcnt(15)
    v_mfma_f32_32x32x16_bf16 v[80:95], a[68:71], v[160:163], v[80:95]
    v_cvt_pk_bf16_f32 v223, v142, v143
    v_exp_f32 v144, v144
    v_exp_f32 v145, v145
    s_waitcnt lgkmcnt(14)
    v_mfma_f32_32x32x16_bf16 v[96:111], a[72:75], v[160:163], v[96:111]
    v_exp_f32 v146, v146
    v_exp_f32 v147, v147
    s_waitcnt lgkmcnt(12)
    v_mfma_f32_32x32x16_bf16 v[112:127], a[76:79], v[160:163], v[112:127]
    ds_read_b32 v246, v247
    ds_read_b64_tr_b16 a[96:97], v224 offset:40960
    ds_read_b64_tr_b16 a[98:99], v224 offset:43008
    v_cvt_pk_bf16_f32 v56, v144, v145
    v_exp_f32 v148, v148
    v_mfma_f32_16x16x32_bf16 v[48:51], v[52:55], v[160:163], v[48:51]
    ds_read_b64_tr_b16 a[100:101], v225 offset:40960
    v_exp_f32 v149, v149
    s_waitcnt lgkmcnt(14)
    v_mfma_f32_32x32x16_bf16 v[64:79], a[80:83], v[164:167], v[64:79]
    ds_read_b64_tr_b16 a[102:103], v225 offset:43008
    ds_read_b64_tr_b16 a[104:105], v226 offset:40960
    ds_read_b64_tr_b16 a[106:107], v226 offset:43008
    ds_read_b64_tr_b16 a[108:109], v227 offset:40960
    v_cvt_pk_bf16_f32 v57, v146, v147
    s_waitcnt lgkmcnt(15)
    v_mfma_f32_32x32x16_bf16 v[80:95], a[84:87], v[164:167], v[80:95]
    ds_read_b64_tr_b16 a[110:111], v227 offset:43008
    ds_read_b64_tr_b16 a[112:113], v224 offset:45056
    ds_read_b64_tr_b16 a[114:115], v224 offset:47104
    v_exp_f32 v150, v150
    v_exp_f32 v151, v151
    s_waitcnt lgkmcnt(15)
    v_mfma_f32_32x32x16_bf16 v[96:111], a[88:91], v[164:167], v[96:111]
    ds_read_b64_tr_b16 a[116:117], v225 offset:45056
    ds_read_b64_tr_b16 a[118:119], v225 offset:47104
    ds_read_b64_tr_b16 a[120:121], v226 offset:45056
    v_cvt_pk_bf16_f32 v58, v148, v149
    v_exp_f32 v152, v152
    v_mfma_f32_32x32x16_bf16 v[112:127], a[92:95], v[164:167], v[112:127]
    ds_read_b64_tr_b16 a[122:123], v226 offset:47104
    ds_read_b64_tr_b16 a[124:125], v227 offset:45056
    ds_read_b64_tr_b16 a[126:127], v227 offset:47104
    v_exp_f32 v153, v153
    s_waitcnt lgkmcnt(15)
    v_cmp_le_u32 vcc, 83, v246
    v_mfma_f32_16x16x32_bf16 v[48:51], v[52:55], v[164:167], v[48:51]
    s_cbranch_vccz L_rt_195
L_rb_196:
    s_waitcnt lgkmcnt(14)
    v_mfma_f32_32x32x16_bf16 v[64:79], a[96:99], v[168:171], v[64:79]
    v_cvt_pk_bf16_f32 v59, v150, v151
    v_exp_f32 v154, v154
    s_waitcnt lgkmcnt(12)
    v_mfma_f32_32x32x16_bf16 v[80:95], a[100:103], v[168:171], v[80:95]
    v_exp_f32 v155, v155
    v_cvt_pk_bf16_f32 v60, v152, v153
    s_waitcnt lgkmcnt(10)
    v_mfma_f32_32x32x16_bf16 v[96:111], a[104:107], v[168:171], v[96:111]
    v_exp_f32 v156, v156
    v_exp_f32 v157, v157
    s_waitcnt lgkmcnt(8)
    v_mfma_f32_32x32x16_bf16 v[112:127], a[108:111], v[168:171], v[112:127]
    ds_read_b32 v246, v247
    ds_read_b64_tr_b16 a[64:65], v8 offset:0
    ds_read_b64_tr_b16 a[66:67], v8 offset:1024
    ds_read_b64_tr_b16 a[68:69], v8 offset:2048
    v_cvt_pk_bf16_f32 v61, v154, v155
    v_mfma_f32_16x16x32_bf16 v[48:51], v[52:55], v[168:171], v[48:51]
    v_exp_f32 v158, v158
    s_waitcnt lgkmcnt(10)
    v_mfma_f32_32x32x16_bf16 v[64:79], a[112:115], v[172:175], v[64:79]
    ds_read_b64_tr_b16 a[70:71], v8 offset:3072
    ds_read_b64_tr_b16 a[72:73], v8 offset:4096
    ds_read_b64_tr_b16 a[74:75], v8 offset:5120
    s_waitcnt lgkmcnt(11)
    v_mfma_f32_32x32x16_bf16 v[80:95], a[116:119], v[172:175], v[80:95]
    ds_read_b64_tr_b16 a[76:77], v8 offset:6144
    ds_read_b64_tr_b16 a[78:79], v8 offset:7168
    ds_read_b64_tr_b16 a[80:81], v9 offset:0
    ds_read_b64_tr_b16 a[82:83], v9 offset:1024
    v_exp_f32 v159, v159
    s_waitcnt lgkmcnt(13)
    v_mfma_f32_32x32x16_bf16 v[96:111], a[120:123], v[172:175], v[96:111]
    ds_read_b64_tr_b16 a[84:85], v9 offset:2048
    ds_read_b64_tr_b16 a[86:87], v9 offset:3072
    ds_read_b64_tr_b16 a[88:89], v9 offset:4096
    v_cvt_pk_bf16_f32 v62, v156, v157
    s_waitcnt lgkmcnt(14)
    v_mfma_f32_32x32x16_bf16 v[112:127], a[124:127], v[172:175], v[112:127]
    ds_read_b64_tr_b16 a[90:91], v9 offset:5120
    ds_read_b64_tr_b16 a[92:93], v9 offset:6144
    ds_read_b64_tr_b16 a[94:95], v9 offset:7168
    v_cvt_pk_bf16_f32 v63, v158, v159
    s_waitcnt lgkmcnt(15)
    v_cmp_le_u32 vcc, 87, v246
    v_mfma_f32_16x16x32_bf16 v[48:51], v[52:55], v[172:175], v[48:51]
    s_bitcmp1_b32 s4, 1
    s_cbranch_scc1 L_st_197
L_bk_198:
    v_mfma_f32_16x16x32_bf16 v[48:51], v[52:55], v[216:219], v[48:51]
    v_mfma_f32_16x16x32_bf16 v[48:51], v[52:55], v[220:223], v[48:51]
    v_mfma_f32_16x16x32_bf16 v[48:51], v[52:55], v[56:59], v[48:51]
    v_mfma_f32_16x16x32_bf16 v[48:51], v[52:55], v[60:63], v[48:51]
    s_lshl_b32 s66, s3, 13
    v_add_u32 v2, s66, v250
    s_cbranch_vccz L_rt_199
L_rb_200:
    s_waitcnt lgkmcnt(14)
    v_mfma_f32_32x32x16_bf16 v[64:79], a[64:67], v[216:219], v[64:79]
    ds_read_b64_tr_b16 a[240:241], v232 offset:16384
    s_waitcnt lgkmcnt(13)
    v_mfma_f32_32x32x16_bf16 v[64:79], a[68:71], v[220:223], v[64:79]
    ds_read_b64_tr_b16 a[242:243], v232 offset:18432
    ds_read_b64_tr_b16 a[244:245], v232 offset:16392
    s_waitcnt lgkmcnt(13)
    v_mfma_f32_32x32x16_bf16 v[64:79], a[72:75], v[56:59], v[64:79]
    ds_read_b64_tr_b16 a[246:247], v232 offset:18440
    s_waitcnt lgkmcnt(12)
    v_mfma_f32_32x32x16_bf16 v[64:79], a[76:79], v[60:63], v[64:79]
    v_rcp_f32 v244, v48
    s_cmp_eq_u32 s6, 0
    s_cbranch_scc1 L_far
    s_waitcnt lgkmcnt(10)
    v_mfma_f32_32x32x16_bf16 v[80:95], a[80:83], v[216:219], v[80:95]
    ds_read_b32 v246, v247
    ds_read_b64_tr_b16 a[96:97], v8 offset:8192
    ds_read_b64_tr_b16 a[98:99], v8 offset:9216
    ds_read_b64_tr_b16 a[100:101], v8 offset:10240
    ds_read_b64_tr_b16 a[102:103], v8 offset:11264
    ds_read_b64_tr_b16 a[104:105], v8 offset:12288
    s_waitcnt lgkmcnt(14)
    v_mfma_f32_32x32x16_bf16 v[80:95], a[84:87], v[220:223], v[80:95]
    ds_read_b64_tr_b16 a[106:107], v8 offset:13312
    ds_read_b64_tr_b16 a[108:109], v8 offset:14336
    ds_read_b64_tr_b16 a[110:111], v8 offset:15360
    ds_read_b64_tr_b16 a[112:113], v9 offset:8192
    ds_read_b64_tr_b16 a[114:115], v9 offset:9216
    ds_read_b64_tr_b16 a[116:117], v9 offset:10240
    s_waitcnt lgkmcnt(15)
    v_mfma_f32_32x32x16_bf16 v[80:95], a[88:91], v[56:59], v[80:95]
    ds_read_b64_tr_b16 a[118:119], v9 offset:11264
    ds_read_b64_tr_b16 a[120:121], v9 offset:12288
    ds_read_b64_tr_b16 a[122:123], v9 offset:13312
    ds_read_b64_tr_b16 a[124:125], v9 offset:14336
    ds_read_b64_tr_b16 a[126:127], v9 offset:15360
    v_pk_mul_f32 v[64:65], v[64:65], v[244:245] op_sel_hi:[1,0]
    v_pk_mul_f32 v[66:67], v[66:67], v[244:245] op_sel_hi:[1,0]
    v_pk_mul_f32 v[68:69], v[68:69], v[244:245] op_sel_hi:[1,0]
    v_pk_mul_f32 v[70:71], v[70:71], v[244:245] op_sel_hi:[1,0]
    v_cvt_pk_bf16_f32 v128, v64, v65
    v_cvt_pk_bf16_f32 v129, v66, v67
    v_cvt_pk_bf16_f32 v130, v68, v69
    v_cvt_pk_bf16_f32 v131, v70, v71
    v_mfma_f32_32x32x16_bf16 v[80:95], a[92:95], v[60:63], v[80:95]
    ds_write_b128 v2, v[128:131] offset:0
    s_waitcnt lgkmcnt(15)
    v_cmp_le_u32 vcc, 90, v246
    v_pk_mul_f32 v[72:73], v[72:73], v[244:245] op_sel_hi:[1,0]
    v_pk_mul_f32 v[74:75], v[74:75], v[244:245] op_sel_hi:[1,0]
    v_pk_mul_f32 v[76:77], v[76:77], v[244:245] op_sel_hi:[1,0]
    v_pk_mul_f32 v[78:79], v[78:79], v[244:245] op_sel_hi:[1,0]
    v_cvt_pk_bf16_f32 v132, v72, v73
    v_cvt_pk_bf16_f32 v133, v74, v75
    v_cvt_pk_bf16_f32 v134, v76, v77
    v_cvt_pk_bf16_f32 v135, v78, v79
    s_cbranch_vccz L_rt_201
L_rb_202:
    s_waitcnt lgkmcnt(14)
    v_mfma_f32_32x32x16_bf16 v[96:111], a[96:99], v[216:219], v[96:111]
    buffer_store_dwordx4 v[128:131], v250, s[40:43], s24 offen offset:0
    buffer_store_dwordx4 v[132:135], v250, s[40:43], s24 offen offset:1024
    ds_write_b128 v2, v[132:135] offset:1024
    v_pk_mul_f32 v[80:81], v[80:81], v[244:245] op_sel_hi:[1,0]
    v_pk_mul_f32 v[82:83], v[82:83], v[244:245] op_sel_hi:[1,0]
    v_pk_mul_f32 v[84:85], v[84:85], v[244:245] op_sel_hi:[1,0]
    v_pk_mul_f32 v[86:87], v[86:87], v[244:245] op_sel_hi:[1,0]
    v_cvt_pk_bf16_f32 v136, v80, v81
    v_cvt_pk_bf16_f32 v137, v82, v83
    v_cvt_pk_bf16_f32 v138, v84, v85
    v_cvt_pk_bf16_f32 v139, v86, v87
    s_waitcnt lgkmcnt(13)
    v_mfma_f32_32x32x16_bf16 v[96:111], a[100:103], v[220:223], v[96:111]
    buffer_store_dwordx4 v[136:139], v250, s[40:43], s24 offen offset:2048
    ds_write_b128 v2, v[136:139] offset:2048
    v_pk_mul_f32 v[88:89], v[88:89], v[244:245] op_sel_hi:[1,0]
    v_pk_mul_f32 v[90:91], v[90:91], v[244:245] op_sel_hi:[1,0]
    v_pk_mul_f32 v[92:93], v[92:93], v[244:245] op_sel_hi:[1,0]
    v_pk_mul_f32 v[94:95], v[94:95], v[244:245] op_sel_hi:[1,0]
    v_cvt_pk_bf16_f32 v140, v88, v89
    v_cvt_pk_bf16_f32 v141, v90, v91
    v_cvt_pk_bf16_f32 v142, v92, v93
    v_cvt_pk_bf16_f32 v143, v94, v95
    s_waitcnt lgkmcnt(12)
    v_mfma_f32_32x32x16_bf16 v[96:111], a[104:107], v[56:59], v[96:111]
    buffer_store_dwordx4 v[140:143], v250, s[40:43], s24 offen offset:3072
    ds_write_b128 v2, v[140:143] offset:3072
    s_waitcnt lgkmcnt(11)
    v_mfma_f32_32x32x16_bf16 v[96:111], a[108:111], v[60:63], v[96:111]
    s_waitcnt lgkmcnt(9)
    v_mfma_f32_32x32x16_bf16 v[112:127], a[112:115], v[216:219], v[112:127]
    s_waitcnt lgkmcnt(7)
    v_mfma_f32_32x32x16_bf16 v[112:127], a[116:119], v[220:223], v[112:127]
    s_waitcnt lgkmcnt(5)
    v_mfma_f32_32x32x16_bf16 v[112:127], a[120:123], v[56:59], v[112:127]
    s_nop 5
    v_pk_mul_f32 v[96:97], v[96:97], v[244:245] op_sel_hi:[1,0]
    v_pk_mul_f32 v[98:99], v[98:99], v[244:245] op_sel_hi:[1,0]
    v_pk_mul_f32 v[100:101], v[100:101], v[244:245] op_sel_hi:[1,0]
    v_pk_mul_f32 v[102:103], v[102:103], v[244:245] op_sel_hi:[1,0]
    v_cvt_pk_bf16_f32 v144, v96, v97
    v_cvt_pk_bf16_f32 v145, v98, v99
    v_cvt_pk_bf16_f32 v146, v100, v101
    v_cvt_pk_bf16_f32 v147, v102, v103
    s_waitcnt lgkmcnt(3)
    v_mfma_f32_32x32x16_bf16 v[112:127], a[124:127], v[60:63], v[112:127]
    buffer_store_dwordx4 v[144:147], v250, s[40:43], s25 offen offset:0
    ds_write_b128 v2, v[144:147] offset:4096
    v_pk_mul_f32 v[104:105], v[104:105], v[244:245] op_sel_hi:[1,0]
    v_pk_mul_f32 v[106:107], v[106:107], v[244:245] op_sel_hi:[1,0]
    v_pk_mul_f32 v[108:109], v[108:109], v[244:245] op_sel_hi:[1,0]
    v_pk_mul_f32 v[110:111], v[110:111], v[244:245] op_sel_hi:[1,0]
    v_cvt_pk_bf16_f32 v148, v104, v105
    v_cvt_pk_bf16_f32 v149, v106, v107
    v_cvt_pk_bf16_f32 v150, v108, v109
    v_cvt_pk_bf16_f32 v151, v110, v111
    buffer_store_dwordx4 v[148:151], v250, s[40:43], s25 offen offset:1024
    ds_write_b128 v2, v[148:151] offset:5120
    v_pk_mul_f32 v[112:113], v[112:113], v[244:245] op_sel_hi:[1,0]
    v_pk_mul_f32 v[114:115], v[114:115], v[244:245] op_sel_hi:[1,0]
    v_pk_mul_f32 v[116:117], v[116:117], v[244:245] op_sel_hi:[1,0]
    v_pk_mul_f32 v[118:119], v[118:119], v[244:245] op_sel_hi:[1,0]
    v_cvt_pk_bf16_f32 v152, v112, v113
    v_cvt_pk_bf16_f32 v153, v114, v115
    v_cvt_pk_bf16_f32 v154, v116, v117
    v_cvt_pk_bf16_f32 v155, v118, v119
    buffer_store_dwordx4 v[152:155], v250, s[40:43], s25 offen offset:2048
    ds_write_b128 v2, v[152:155] offset:6144
    v_pk_mul_f32 v[120:121], v[120:121], v[244:245] op_sel_hi:[1,0]
    v_pk_mul_f32 v[122:123], v[122:123], v[244:245] op_sel_hi:[1,0]
    v_pk_mul_f32 v[124:125], v[124:125], v[244:245] op_sel_hi:[1,0]
    v_pk_mul_f32 v[126:127], v[126:127], v[244:245] op_sel_hi:[1,0]
    v_cvt_pk_bf16_f32 v156, v120, v121
    v_cvt_pk_bf16_f32 v157, v122, v123
    v_cvt_pk_bf16_f32 v158, v124, v125
    v_cvt_pk_bf16_f32 v159, v126, v127
    buffer_store_dwordx4 v[156:159], v250, s[40:43], s25 offen offset:3072
    ds_write_b128 v2, v[156:159] offset:7168
L_tail:
    s_waitcnt lgkmcnt(0)
    s_barrier
    ds_read_b128 a[0:3], v252 offset:0
    ds_read_b128 a[4:7], v252 offset:256
    ds_read_b128 a[8:11], v252 offset:2048
    ds_read_b128 a[12:15], v252 offset:2304
    ds_read_b128 a[16:19], v252 offset:4096
    ds_read_b128 a[20:23], v252 offset:4352
    ds_read_b128 a[24:27], v252 offset:6144
    ds_read_b128 a[28:31], v252 offset:6400
    s_waitcnt lgkmcnt(7)
    v_mfma_f32_16x16x32_bf16 v[64:67], a[128:131], a[0:3], 0
    ds_read_b128 a[32:35], v252 offset:8192
    ds_read_b128 a[36:39], v252 offset:8448
    v_mfma_f32_16x16x32_bf16 v[68:71], a[132:135], a[0:3], 0
    s_waitcnt lgkmcnt(8)
    v_mfma_f32_16x16x32_bf16 v[72:75], a[128:131], a[4:7], 0
    ds_read_b128 a[40:43], v252 offset:10240
    ds_read_b128 a[44:47], v252 offset:10496
    v_mfma_f32_16x16x32_bf16 v[76:79], a[132:135], a[4:7], 0
    s_waitcnt lgkmcnt(9)
    v_mfma_f32_16x16x32_bf16 v[64:67], a[136:139], a[8:11], v[64:67]
    ds_read_b128 a[48:51], v252 offset:12288
    ds_read_b128 a[52:55], v252 offset:12544
    v_mfma_f32_16x16x32_bf16 v[68:71], a[140:143], a[8:11], v[68:71]
    s_waitcnt lgkmcnt(10)
    v_mfma_f32_16x16x32_bf16 v[72:75], a[136:139], a[12:15], v[72:75]
    ds_read_b128 a[56:59], v252 offset:14336
    ds_read_b128 a[60:63], v252 offset:14592
    v_mfma_f32_16x16x32_bf16 v[76:79], a[140:143], a[12:15], v[76:79]
    s_waitcnt lgkmcnt(11)
    v_mfma_f32_16x16x32_bf16 v[64:67], a[144:147], a[16:19], v[64:67]
    ds_read_b128 a[64:67], v252 offset:16384
    v_mfma_f32_16x16x32_bf16 v[68:71], a[148:151], a[16:19], v[68:71]
    s_waitcnt lgkmcnt(11)
    v_mfma_f32_16x16x32_bf16 v[72:75], a[144:147], a[20:23], v[72:75]
    ds_read_b128 a[68:71], v252 offset:16640
    v_mfma_f32_16x16x32_bf16 v[76:79], a[148:151], a[20:23], v[76:79]
    s_waitcnt vmcnt(0)
    buffer_store_dword v237, v235, s[48:51], 0 offen
    buffer_store_dword v237, v236, s[48:51], 0 offen sc1
    s_waitcnt lgkmcnt(11)
    v_mfma_f32_16x16x32_bf16 v[64:67], a[152:155], a[24:27], v[64:67]
    ds_read_b128 a[72:75], v252 offset:18432
    v_mfma_f32_16x16x32_bf16 v[68:71], a[156:159], a[24:27], v[68:71]
    s_cmp_eq_u32 s11, 32
    s_cbranch_scc1 L_np_203
    buffer_load_dword v253, v234, s[48:51], s9 offen sc1
L_np_203:
    s_waitcnt lgkmcnt(11)
    v_mfma_f32_16x16x32_bf16 v[72:75], a[152:155], a[28:31], v[72:75]
    ds_read_b128 a[76:79], v252 offset:18688
    v_mfma_f32_16x16x32_bf16 v[76:79], a[156:159], a[28:31], v[76:79]
    s_waitcnt lgkmcnt(8)
    v_mfma_f32_16x16x32_bf16 v[80:83], a[128:131], a[32:35], 0
    ds_read_b128 a[80:83], v252 offset:20480
    v_mfma_f32_16x16x32_bf16 v[84:87], a[132:135], a[32:35], 0
    v_bfe_u32 v7, v0, 2, 2
    v_and_b32 v2, 1, v0
    v_mfma_f32_16x16x32_bf16 v[88:91], a[128:131], a[36:39], 0
    ds_read_b128 a[84:87], v252 offset:20736
    v_mfma_f32_16x16x32_bf16 v[92:95], a[132:135], a[36:39], 0
    v_lshl_add_u32 v2, v2, 2, v7
    v_lshlrev_b32 v3, 2, v2
    v_mfma_f32_16x16x32_bf16 v[80:83], a[136:139], a[40:43], v[80:83]
    ds_read_b128 a[88:91], v252 offset:22528
    v_mfma_f32_16x16x32_bf16 v[84:87], a[140:143], a[40:43], v[84:87]
    ds_bpermute_b32 v6, v3, v233
    v_lshlrev_b32 v5, 15, v2
    v_mfma_f32_16x16x32_bf16 v[88:91], a[136:139], a[44:47], v[88:91]
    ds_read_b128 a[92:95], v252 offset:22784
    v_mfma_f32_16x16x32_bf16 v[92:95], a[140:143], a[44:47], v[92:95]
    v_lshrrev_b32 v3, 4, v0
    v_lshl_add_u32 v5, v3, 3, v5
    s_waitcnt lgkmcnt(9)
    v_mfma_f32_16x16x32_bf16 v[80:83], a[144:147], a[48:51], v[80:83]
    ds_read_b64_tr_b16 a[248:249], v232 offset:0
    v_mfma_f32_16x16x32_bf16 v[84:87], a[148:151], a[48:51], v[84:87]
    s_cmp_eq_u32 s11, 32
    s_cbranch_scc1 L_np_204
    s_call_b64 s[14:15], L_inc
L_np_204:
    v_bfe_u32 v2, v0, 1, 1
    v_lshl_add_u32 v5, v2, 2, v5
    v_mfma_f32_16x16x32_bf16 v[88:91], a[144:147], a[52:55], v[88:91]
    ds_read_b64_tr_b16 a[250:251], v232 offset:2048
    v_mfma_f32_16x16x32_bf16 v[92:95], a[148:151], a[52:55], v[92:95]
    v_lshlrev_b32 v4, 15, v7
    v_lshl_add_u32 v4, v3, 6, v4
    v_mfma_f32_16x16x32_bf16 v[80:83], a[152:155], a[56:59], v[80:83]
    ds_read_b64_tr_b16 a[252:253], v232 offset:8
    v_mfma_f32_16x16x32_bf16 v[84:87], a[156:159], a[56:59], v[84:87]
    v_and_b32 v2, 3, v0
    v_lshl_add_u32 v4, v2, 4, v4
    v_mfma_f32_16x16x32_bf16 v[88:91], a[152:155], a[60:63], v[88:91]
    ds_read_b64_tr_b16 a[254:255], v232 offset:2056
    v_mfma_f32_16x16x32_bf16 v[92:95], a[156:159], a[60:63], v[92:95]
    v_cmp_eq_u32 vcc, 0, v2
    s_nop 1
    v_cndmask_b32 v10, 0, -1, vcc
    s_waitcnt lgkmcnt(9)
    v_mfma_f32_16x16x32_bf16 v[96:99], a[128:131], a[64:67], 0
    v_mfma_f32_16x16x32_bf16 v[100:103], a[132:135], a[64:67], 0
    s_cmp_eq_u32 s11, 32
    s_cbranch_scc1 L_np_205
    buffer_load_dword v253, v234, s[48:51], s9 offen sc1
L_np_205:
    v_cmp_eq_u32 vcc, 1, v2
    s_nop 1
    v_cndmask_b32 v11, 0, -1, vcc
    v_mfma_f32_16x16x32_bf16 v[104:107], a[128:131], a[68:71], 0
    v_mfma_f32_16x16x32_bf16 v[108:111], a[132:135], a[68:71], 0
    v_add_u32 v9, 49152, v252
    s_add_u32 s17, s68, 131072
    v_mfma_f32_16x16x32_bf16 v[96:99], a[136:139], a[72:75], v[96:99]
    v_mfma_f32_16x16x32_bf16 v[100:103], a[140:143], a[72:75], v[100:103]
    v_lshrrev_b32 v7, 3, v0
    v_lshlrev_b32 v3, 2, v7
    v_mfma_f32_16x16x32_bf16 v[104:107], a[136:139], a[76:79], v[104:107]
    v_mfma_f32_16x16x32_bf16 v[108:111], a[140:143], a[76:79], v[108:111]
    ds_bpermute_b32 v17, v3, v233
    v_and_b32 v13, 0x70, v250
    s_waitcnt lgkmcnt(5)
    v_mfma_f32_16x16x32_bf16 v[96:99], a[144:147], a[80:83], v[96:99]
    v_mfma_f32_16x16x32_bf16 v[100:103], a[148:151], a[80:83], v[100:103]
    v_lshl_add_u32 v13, v7, 15, v13
    v_mfma_f32_16x16x32_bf16 v[104:107], a[144:147], a[84:87], v[104:107]
    v_mfma_f32_16x16x32_bf16 v[108:111], a[148:151], a[84:87], v[108:111]
    v_mfma_f32_16x16x32_bf16 v[96:99], a[152:155], a[88:91], v[96:99]
    v_mfma_f32_16x16x32_bf16 v[100:103], a[156:159], a[88:91], v[100:103]
    s_cmp_eq_u32 s11, 32
    s_cbranch_scc0 L_dec
L_decb:
    s_waitcnt vmcnt(0)
    s_barrier
    ds_read_b128 a[0:3], v252 offset:24576
    ds_read_b128 a[4:7], v252 offset:24832
    ds_read_b128 a[8:11], v252 offset:26624
    ds_read_b128 a[12:15], v252 offset:26880
    v_mfma_f32_16x16x32_bf16 v[104:107], a[152:155], a[92:95], v[104:107]
    v_mfma_f32_16x16x32_bf16 v[108:111], a[156:159], a[92:95], v[108:111]
    ds_read_b128 a[16:19], v252 offset:28672
    ds_read_b128 a[20:23], v252 offset:28928
    ds_read_b128 a[24:27], v252 offset:30720
    ds_read_b128 a[28:31], v252 offset:30976
    s_waitcnt lgkmcnt(7)
    v_mfma_f32_16x16x32_bf16 v[64:67], a[160:163], a[0:3], v[64:67]
    ds_read_b128 a[32:35], v252 offset:32768
    v_mfma_f32_16x16x32_bf16 v[68:71], a[164:167], a[0:3], v[68:71]
    s_add_u32 m0, s70, 49152
    s_add_u32 s67, s71, 8192
    buffer_load_dwordx4 v250, s[40:43], s67 offen offset:0 sc1 lds
    s_waitcnt lgkmcnt(7)
    v_mfma_f32_16x16x32_bf16 v[72:75], a[160:163], a[4:7], v[72:75]
    ds_read_b128 a[36:39], v252 offset:33024
    v_mfma_f32_16x16x32_bf16 v[76:79], a[164:167], a[4:7], v[76:79]
    v_add_u32 v16, 0x5bd1e995, v17
    v_mov_b32 v19, v17
    s_waitcnt lgkmcnt(7)
    v_mfma_f32_16x16x32_bf16 v[64:67], a[168:171], a[8:11], v[64:67]
    ds_read_b128 a[40:43], v252 offset:34816
    v_mfma_f32_16x16x32_bf16 v[68:71], a[172:175], a[8:11], v[68:71]
    buffer_load_dwordx4 v250, s[40:43], s67 offen offset:1024 sc1 lds
    s_waitcnt lgkmcnt(7)
    v_mfma_f32_16x16x32_bf16 v[72:75], a[168:171], a[12:15], v[72:75]
    ds_read_b128 a[44:47], v252 offset:35072
    v_mfma_f32_16x16x32_bf16 v[76:79], a[172:175], a[12:15], v[76:79]
    v_mov_b32 v18, v16
    s_waitcnt lgkmcnt(7)
    v_mfma_f32_16x16x32_bf16 v[64:67], a[176:179], a[16:19], v[64:67]
    ds_read_b128 a[48:51], v252 offset:36864
    v_mfma_f32_16x16x32_bf16 v[68:71], a[180:183], a[16:19], v[68:71]
    s_add_u32 m0, s70, 57344
    s_add_u32 s67, s72, 8192
    buffer_load_dwordx4 v250, s[40:43], s67 offen offset:0 sc1 lds
    s_waitcnt lgkmcnt(7)
    v_mfma_f32_16x16x32_bf16 v[72:75], a[176:179], a[20:23], v[72:75]
    ds_read_b128 a[52:55], v252 offset:37120
    v_mfma_f32_16x16x32_bf16 v[76:79], a[180:183], a[20:23], v[76:79]
    s_waitcnt lgkmcnt(7)
    v_mfma_f32_16x16x32_bf16 v[64:67], a[184:187], a[24:27], v[64:67]
    ds_read_b128 a[56:59], v252 offset:38912
    v_mfma_f32_16x16x32_bf16 v[68:71], a[188:191], a[24:27], v[68:71]
    buffer_load_dwordx4 v250, s[40:43], s67 offen offset:1024 sc1 lds
    s_waitcnt lgkmcnt(7)
    v_mfma_f32_16x16x32_bf16 v[72:75], a[184:187], a[28:31], v[72:75]
    ds_read_b128 a[60:63], v252 offset:39168
    v_mfma_f32_16x16x32_bf16 v[76:79], a[188:191], a[28:31], v[76:79]
    s_waitcnt lgkmcnt(4)
    v_mfma_f32_16x16x32_bf16 v[64:67], a[192:195], a[32:35], v[64:67]
    ds_read_b128 a[64:67], v252 offset:40960
    v_mfma_f32_16x16x32_bf16 v[68:71], a[196:199], a[32:35], v[68:71]
    s_add_u32 m0, s70, 65536
    s_add_u32 s67, s73, 8192
    buffer_load_dwordx4 v250, s[40:43], s67 offen offset:0 sc1 lds
    v_mfma_f32_16x16x32_bf16 v[72:75], a[192:195], a[36:39], v[72:75]
    ds_read_b128 a[68:71], v252 offset:41216
    v_mfma_f32_16x16x32_bf16 v[76:79], a[196:199], a[36:39], v[76:79]
    v_mfma_f32_16x16x32_bf16 v[64:67], a[200:203], a[40:43], v[64:67]
    ds_read_b128 a[72:75], v252 offset:43008
    v_mfma_f32_16x16x32_bf16 v[68:71], a[204:207], a[40:43], v[68:71]
    buffer_load_dwordx4 v250, s[40:43], s67 offen offset:1024 sc1 lds
    v_mfma_f32_16x16x32_bf16 v[72:75], a[200:203], a[44:47], v[72:75]
    ds_read_b128 a[76:79], v252 offset:43264
    v_mfma_f32_16x16x32_bf16 v[76:79], a[204:207], a[44:47], v[76:79]
    s_waitcnt lgkmcnt(4)
    v_mfma_f32_16x16x32_bf16 v[64:67], a[208:211], a[48:51], v[64:67]
    ds_read_b128 a[80:83], v252 offset:45056
    v_mfma_f32_16x16x32_bf16 v[68:71], a[212:215], a[48:51], v[68:71]
    s_add_u32 m0, s70, 73728
    s_add_u32 s67, s71, 16384
    buffer_load_dwordx4 v250, s[40:43], s67 offen offset:0 sc1 lds
    v_mfma_f32_16x16x32_bf16 v[72:75], a[208:211], a[52:55], v[72:75]
    ds_read_b128 a[84:87], v252 offset:45312
    v_mfma_f32_16x16x32_bf16 v[76:79], a[212:215], a[52:55], v[76:79]
    v_mfma_f32_16x16x32_bf16 v[64:67], a[216:219], a[56:59], v[64:67]
    ds_read_b128 a[88:91], v252 offset:47104
    v_mfma_f32_16x16x32_bf16 v[68:71], a[220:223], a[56:59], v[68:71]
    buffer_load_dwordx4 v250, s[40:43], s67 offen offset:1024 sc1 lds
    v_mfma_f32_16x16x32_bf16 v[72:75], a[216:219], a[60:63], v[72:75]
    ds_read_b128 a[92:95], v252 offset:47360
    v_mfma_f32_16x16x32_bf16 v[76:79], a[220:223], a[60:63], v[76:79]
    s_waitcnt lgkmcnt(4)
    v_mfma_f32_16x16x32_bf16 v[64:67], a[224:227], a[64:67], v[64:67]
    v_mfma_f32_16x16x32_bf16 v[68:71], a[228:231], a[64:67], v[68:71]
    s_add_u32 m0, s70, 81920
    s_add_u32 s67, s72, 16384
    buffer_load_dwordx4 v250, s[40:43], s67 offen offset:0 sc1 lds
    v_mfma_f32_16x16x32_bf16 v[72:75], a[224:227], a[68:71], v[72:75]
    v_mfma_f32_16x16x32_bf16 v[76:79], a[228:231], a[68:71], v[76:79]
    v_mfma_f32_16x16x32_bf16 v[64:67], a[232:235], a[72:75], v[64:67]
    v_mfma_f32_16x16x32_bf16 v[68:71], a[236:239], a[72:75], v[68:71]
    buffer_load_dwordx4 v250, s[40:43], s67 offen offset:1024 sc1 lds
    v_mfma_f32_16x16x32_bf16 v[72:75], a[232:235], a[76:79], v[72:75]
    v_mfma_f32_16x16x32_bf16 v[76:79], a[236:239], a[76:79], v[76:79]
    s_waitcnt vmcnt(4)
    s_barrier
    ds_read_b128 a[0:3], v9 offset:0
    ds_read_b128 a[4:7], v9 offset:256
    s_waitcnt lgkmcnt(2)
    v_mfma_f32_16x16x32_bf16 v[64:67], a[240:243], a[80:83], v[64:67]
    v_mfma_f32_16x16x32_bf16 v[68:71], a[244:247], a[80:83], v[68:71]
    s_add_u32 m0, s70, 90112
    s_add_u32 s67, s73, 16384
    buffer_load_dwordx4 v250, s[40:43], s67 offen offset:0 sc1 lds
    ds_read_b128 a[8:11], v9 offset:2048
    ds_read_b128 a[12:15], v9 offset:2304
    v_mfma_f32_16x16x32_bf16 v[72:75], a[240:243], a[84:87], v[72:75]
    v_mfma_f32_16x16x32_bf16 v[76:79], a[244:247], a[84:87], v[76:79]
    ds_read_b128 a[16:19], v9 offset:4096
    ds_read_b128 a[20:23], v9 offset:4352
    v_mfma_f32_16x16x32_bf16 v[64:67], a[248:251], a[88:91], v[64:67]
    v_mfma_f32_16x16x32_bf16 v[68:71], a[252:255], a[88:91], v[68:71]
    buffer_load_dwordx4 v250, s[40:43], s67 offen offset:1024 sc1 lds
    ds_read_b128 a[24:27], v9 offset:6144
    ds_read_b128 a[28:31], v9 offset:6400
    v_mfma_f32_16x16x32_bf16 v[72:75], a[248:251], a[92:95], v[72:75]
    v_mfma_f32_16x16x32_bf16 v[76:79], a[252:255], a[92:95], v[76:79]
    s_waitcnt lgkmcnt(7)
    v_mfma_f32_16x16x32_bf16 v[80:83], a[160:163], a[0:3], v[80:83]
    ds_read_b128 a[32:35], v9 offset:8192
    v_mfma_f32_16x16x32_bf16 v[84:87], a[164:167], a[0:3], v[84:87]
    s_waitcnt lgkmcnt(7)
    v_mfma_f32_16x16x32_bf16 v[88:91], a[160:163], a[4:7], v[88:91]
    ds_read_b128 a[36:39], v9 offset:8448
    v_mfma_f32_16x16x32_bf16 v[92:95], a[164:167], a[4:7], v[92:95]
    s_waitcnt lgkmcnt(7)
    v_mfma_f32_16x16x32_bf16 v[80:83], a[168:171], a[8:11], v[80:83]
    ds_read_b128 a[40:43], v9 offset:10240
    v_mfma_f32_16x16x32_bf16 v[84:87], a[172:175], a[8:11], v[84:87]
    s_waitcnt lgkmcnt(7)
    v_mfma_f32_16x16x32_bf16 v[88:91], a[168:171], a[12:15], v[88:91]
    ds_read_b128 a[44:47], v9 offset:10496
    v_mfma_f32_16x16x32_bf16 v[92:95], a[172:175], a[12:15], v[92:95]
    s_waitcnt lgkmcnt(7)
    v_mfma_f32_16x16x32_bf16 v[80:83], a[176:179], a[16:19], v[80:83]
    ds_read_b128 a[48:51], v9 offset:12288
    v_mfma_f32_16x16x32_bf16 v[84:87], a[180:183], a[16:19], v[84:87]
    s_waitcnt lgkmcnt(7)
    v_mfma_f32_16x16x32_bf16 v[88:91], a[176:179], a[20:23], v[88:91]
    ds_read_b128 a[52:55], v9 offset:12544
    v_mfma_f32_16x16x32_bf16 v[92:95], a[180:183], a[20:23], v[92:95]
    s_waitcnt lgkmcnt(7)
    v_mfma_f32_16x16x32_bf16 v[80:83], a[184:187], a[24:27], v[80:83]
    ds_read_b128 a[56:59], v9 offset:14336
    v_mfma_f32_16x16x32_bf16 v[84:87], a[188:191], a[24:27], v[84:87]
    s_waitcnt lgkmcnt(7)
    v_mfma_f32_16x16x32_bf16 v[88:91], a[184:187], a[28:31], v[88:91]
    ds_read_b128 a[60:63], v9 offset:14592
    v_mfma_f32_16x16x32_bf16 v[92:95], a[188:191], a[28:31], v[92:95]
    s_waitcnt lgkmcnt(4)
    v_mfma_f32_16x16x32_bf16 v[80:83], a[192:195], a[32:35], v[80:83]
    ds_read_b128 a[64:67], v9 offset:16384
    v_mfma_f32_16x16x32_bf16 v[84:87], a[196:199], a[32:35], v[84:87]
    v_cvt_pk_bf16_f32 v176, v64, v65
    v_cvt_pk_bf16_f32 v177, v66, v67
    v_cvt_pk_bf16_f32 v178, v68, v69
    v_mfma_f32_16x16x32_bf16 v[88:91], a[192:195], a[36:39], v[88:91]
    ds_read_b128 a[68:71], v9 offset:16640
    v_cvt_pk_bf16_f32 v179, v70, v71
    v_mfma_f32_16x16x32_bf16 v[92:95], a[196:199], a[36:39], v[92:95]
    s_waitcnt vmcnt(0)
    buffer_store_dwordx4 v[176:179], v4, s[44:47], s68 offen offset:0 sc1
    v_cvt_pk_bf16_f32 v180, v72, v73
    v_cvt_pk_bf16_f32 v181, v74, v75
    v_mfma_f32_16x16x32_bf16 v[80:83], a[200:203], a[40:43], v[80:83]
    ds_read_b128 a[72:75], v9 offset:18432
    v_cvt_pk_bf16_f32 v182, v76, v77
    v_mfma_f32_16x16x32_bf16 v[84:87], a[204:207], a[40:43], v[84:87]
    v_cvt_pk_bf16_f32 v183, v78, v79
    v_mfma_f32_16x16x32_bf16 v[88:91], a[200:203], a[44:47], v[88:91]
    ds_read_b128 a[76:79], v9 offset:18688
    v_mfma_f32_16x16x32_bf16 v[92:95], a[204:207], a[44:47], v[92:95]
    buffer_store_dwordx4 v[180:183], v4, s[44:47], s17 offen offset:0 sc1
    v_add3_u32 v160, v176, v177, v178
    v_add3_u32 v161, v180, v181, v182
    s_waitcnt lgkmcnt(4)
    v_mfma_f32_16x16x32_bf16 v[80:83], a[208:211], a[48:51], v[80:83]
    ds_read_b128 a[80:83], v9 offset:20480
    v_lshl_add_u32 v160, v179, 1, v160
    v_mfma_f32_16x16x32_bf16 v[84:87], a[212:215], a[48:51], v[84:87]
    v_lshl_add_u32 v161, v183, 1, v161
    v_add_u32_dpp v160, v160, v160 quad_perm:[1,0,3,2] row_mask:0xf bank_mask:0xf
    s_nop 0
    v_add_u32_dpp v161, v161, v161 quad_perm:[1,0,3,2] row_mask:0xf bank_mask:0xf
    v_mfma_f32_16x16x32_bf16 v[88:91], a[208:211], a[52:55], v[88:91]
    ds_read_b128 a[84:87], v9 offset:20736
    v_add_u32_dpp v160, v160, v160 quad_perm:[2,3,0,1] row_mask:0xf bank_mask:0xf
    v_mfma_f32_16x16x32_bf16 v[92:95], a[212:215], a[52:55], v[92:95]
    v_add_u32_dpp v161, v161, v161 quad_perm:[2,3,0,1] row_mask:0xf bank_mask:0xf
    v_and_b32 v160, v10, v160
    v_and_b32 v161, v11, v161
    v_mfma_f32_16x16x32_bf16 v[80:83], a[216:219], a[56:59], v[80:83]
    ds_read_b128 a[88:91], v9 offset:22528
    v_add3_u32 v160, v160, v161, v6
    v_mfma_f32_16x16x32_bf16 v[84:87], a[220:223], a[56:59], v[84:87]
    buffer_store_dword v160, v5, s[44:47], s75 offen offset:3072 sc1
    v_mfma_f32_16x16x32_bf16 v[88:91], a[216:219], a[60:63], v[88:91]
    ds_read_b128 a[92:95], v9 offset:22784
    v_mfma_f32_16x16x32_bf16 v[92:95], a[220:223], a[60:63], v[92:95]
    s_waitcnt lgkmcnt(4)
    v_mfma_f32_16x16x32_bf16 v[80:83], a[224:227], a[64:67], v[80:83]
    v_mfma_f32_16x16x32_bf16 v[84:87], a[228:231], a[64:67], v[84:87]
    v_mfma_f32_16x16x32_bf16 v[88:91], a[224:227], a[68:71], v[88:91]
    v_mfma_f32_16x16x32_bf16 v[92:95], a[228:231], a[68:71], v[92:95]
    v_mfma_f32_16x16x32_bf16 v[80:83], a[232:235], a[72:75], v[80:83]
    v_mfma_f32_16x16x32_bf16 v[84:87], a[236:239], a[72:75], v[84:87]
    v_mfma_f32_16x16x32_bf16 v[88:91], a[232:235], a[76:79], v[88:91]
    v_mfma_f32_16x16x32_bf16 v[92:95], a[236:239], a[76:79], v[92:95]
    s_barrier
    ds_read_b128 a[0:3], v9 offset:24576
    ds_read_b128 a[4:7], v9 offset:24832
    s_waitcnt lgkmcnt(2)
    v_mfma_f32_16x16x32_bf16 v[80:83], a[240:243], a[80:83], v[80:83]
    v_mfma_f32_16x16x32_bf16 v[84:87], a[244:247], a[80:83], v[84:87]
    ds_read_b128 a[8:11], v9 offset:26624
    ds_read_b128 a[12:15], v9 offset:26880
    v_mfma_f32_16x16x32_bf16 v[88:91], a[240:243], a[84:87], v[88:91]
    v_mfma_f32_16x16x32_bf16 v[92:95], a[244:247], a[84:87], v[92:95]
    ds_read_b128 a[16:19], v9 offset:28672
    ds_read_b128 a[20:23], v9 offset:28928
    v_mfma_f32_16x16x32_bf16 v[80:83], a[248:251], a[88:91], v[80:83]
    v_mfma_f32_16x16x32_bf16 v[84:87], a[252:255], a[88:91], v[84:87]
    ds_read_b128 a[24:27], v9 offset:30720
    ds_read_b128 a[28:31], v9 offset:30976
    v_mfma_f32_16x16x32_bf16 v[88:91], a[248:251], a[92:95], v[88:91]
    v_mfma_f32_16x16x32_bf16 v[92:95], a[252:255], a[92:95], v[92:95]
    s_waitcnt lgkmcnt(7)
    v_mfma_f32_16x16x32_bf16 v[96:99], a[160:163], a[0:3], v[96:99]
    ds_read_b128 a[32:35], v9 offset:32768
    v_mfma_f32_16x16x32_bf16 v[100:103], a[164:167], a[0:3], v[100:103]
    s_waitcnt lgkmcnt(7)
    v_mfma_f32_16x16x32_bf16 v[104:107], a[160:163], a[4:7], v[104:107]
    ds_read_b128 a[36:39], v9 offset:33024
    v_mfma_f32_16x16x32_bf16 v[108:111], a[164:167], a[4:7], v[108:111]
    s_waitcnt lgkmcnt(7)
    v_mfma_f32_16x16x32_bf16 v[96:99], a[168:171], a[8:11], v[96:99]
    ds_read_b128 a[40:43], v9 offset:34816
    v_mfma_f32_16x16x32_bf16 v[100:103], a[172:175], a[8:11], v[100:103]
    v_cvt_pk_bf16_f32 v184, v80, v81
    v_cvt_pk_bf16_f32 v185, v82, v83
    v_cvt_pk_bf16_f32 v186, v84, v85
    s_waitcnt lgkmcnt(7)
    v_mfma_f32_16x16x32_bf16 v[104:107], a[168:171], a[12:15], v[104:107]
    ds_read_b128 a[44:47], v9 offset:35072
    v_cvt_pk_bf16_f32 v187, v86, v87
    v_mfma_f32_16x16x32_bf16 v[108:111], a[172:175], a[12:15], v[108:111]
    buffer_store_dwordx4 v[184:187], v4, s[44:47], s68 offen offset:1024 sc1
    v_cvt_pk_bf16_f32 v188, v88, v89
    v_cvt_pk_bf16_f32 v189, v90, v91
    s_waitcnt lgkmcnt(7)
    v_mfma_f32_16x16x32_bf16 v[96:99], a[176:179], a[16:19], v[96:99]
    ds_read_b128 a[48:51], v9 offset:36864
    v_cvt_pk_bf16_f32 v190, v92, v93
    v_mfma_f32_16x16x32_bf16 v[100:103], a[180:183], a[16:19], v[100:103]
    v_cvt_pk_bf16_f32 v191, v94, v95
    s_waitcnt lgkmcnt(7)
    v_mfma_f32_16x16x32_bf16 v[104:107], a[176:179], a[20:23], v[104:107]
    ds_read_b128 a[52:55], v9 offset:37120
    v_mfma_f32_16x16x32_bf16 v[108:111], a[180:183], a[20:23], v[108:111]
    buffer_store_dwordx4 v[188:191], v4, s[44:47], s17 offen offset:1024 sc1
    v_add3_u32 v162, v184, v185, v186
    v_add3_u32 v163, v188, v189, v190
    s_waitcnt lgkmcnt(7)
    v_mfma_f32_16x16x32_bf16 v[96:99], a[184:187], a[24:27], v[96:99]
    ds_read_b128 a[56:59], v9 offset:38912
    v_lshl_add_u32 v162, v187, 1, v162
    v_mfma_f32_16x16x32_bf16 v[100:103], a[188:191], a[24:27], v[100:103]
    v_lshl_add_u32 v163, v191, 1, v163
    v_add_u32_dpp v162, v162, v162 quad_perm:[1,0,3,2] row_mask:0xf bank_mask:0xf
    s_nop 0
    v_add_u32_dpp v163, v163, v163 quad_perm:[1,0,3,2] row_mask:0xf bank_mask:0xf
    s_waitcnt lgkmcnt(7)
    v_mfma_f32_16x16x32_bf16 v[104:107], a[184:187], a[28:31], v[104:107]
    ds_read_b128 a[60:63], v9 offset:39168
    v_add_u32_dpp v162, v162, v162 quad_perm:[2,3,0,1] row_mask:0xf bank_mask:0xf
    v_mfma_f32_16x16x32_bf16 v[108:111], a[188:191], a[28:31], v[108:111]
    v_add_u32_dpp v163, v163, v163 quad_perm:[2,3,0,1] row_mask:0xf bank_mask:0xf
    v_and_b32 v162, v10, v162
    v_and_b32 v163, v11, v163
    s_waitcnt lgkmcnt(4)
    v_mfma_f32_16x16x32_bf16 v[96:99], a[192:195], a[32:35], v[96:99]
    ds_read_b128 a[64:67], v9 offset:40960
    v_add3_u32 v162, v162, v163, v6
    v_mfma_f32_16x16x32_bf16 v[100:103], a[196:199], a[32:35], v[100:103]
    buffer_store_dword v162, v5, s[44:47], s75 offen offset:3200 sc1
    v_mfma_f32_16x16x32_bf16 v[104:107], a[192:195], a[36:39], v[104:107]
    ds_read_b128 a[68:71], v9 offset:41216
    v_mfma_f32_16x16x32_bf16 v[108:111], a[196:199], a[36:39], v[108:111]
    v_mfma_f32_16x16x32_bf16 v[96:99], a[200:203], a[40:43], v[96:99]
    ds_read_b128 a[72:75], v9 offset:43008
    v_mfma_f32_16x16x32_bf16 v[100:103], a[204:207], a[40:43], v[100:103]
    s_cmp_eq_u32 s3, 3
    s_cbranch_scc0 L_eh_206
    buffer_store_dwordx4 v[16:19], v13, s[44:47], s75 offen offset:3232 sc1
L_eh_206:
    v_mfma_f32_16x16x32_bf16 v[104:107], a[200:203], a[44:47], v[104:107]
    ds_read_b128 a[76:79], v9 offset:43264
    v_mfma_f32_16x16x32_bf16 v[108:111], a[204:207], a[44:47], v[108:111]
    s_waitcnt lgkmcnt(4)
    v_mfma_f32_16x16x32_bf16 v[96:99], a[208:211], a[48:51], v[96:99]
    ds_read_b128 a[80:83], v9 offset:45056
    v_mfma_f32_16x16x32_bf16 v[100:103], a[212:215], a[48:51], v[100:103]
    v_mfma_f32_16x16x32_bf16 v[104:107], a[208:211], a[52:55], v[104:107]
    ds_read_b128 a[84:87], v9 offset:45312
    v_mfma_f32_16x16x32_bf16 v[108:111], a[212:215], a[52:55], v[108:111]
    v_mfma_f32_16x16x32_bf16 v[96:99], a[216:219], a[56:59], v[96:99]
    ds_read_b128 a[88:91], v9 offset:47104
    v_mfma_f32_16x16x32_bf16 v[100:103], a[220:223], a[56:59], v[100:103]
    v_mfma_f32_16x16x32_bf16 v[104:107], a[216:219], a[60:63], v[104:107]
    ds_read_b128 a[92:95], v9 offset:47360
    v_mfma_f32_16x16x32_bf16 v[108:111], a[220:223], a[60:63], v[108:111]
    s_waitcnt lgkmcnt(4)
    v_mfma_f32_16x16x32_bf16 v[96:99], a[224:227], a[64:67], v[96:99]
    v_mfma_f32_16x16x32_bf16 v[100:103], a[228:231], a[64:67], v[100:103]
    s_barrier
    v_mfma_f32_16x16x32_bf16 v[104:107], a[224:227], a[68:71], v[104:107]
    v_mfma_f32_16x16x32_bf16 v[108:111], a[228:231], a[68:71], v[108:111]
    v_mfma_f32_16x16x32_bf16 v[96:99], a[232:235], a[72:75], v[96:99]
    v_mfma_f32_16x16x32_bf16 v[100:103], a[236:239], a[72:75], v[100:103]
    v_mfma_f32_16x16x32_bf16 v[104:107], a[232:235], a[76:79], v[104:107]
    v_mfma_f32_16x16x32_bf16 v[108:111], a[236:239], a[76:79], v[108:111]
    s_waitcnt lgkmcnt(0)
    v_mfma_f32_16x16x32_bf16 v[96:99], a[240:243], a[80:83], v[96:99]
    v_mfma_f32_16x16x32_bf16 v[100:103], a[244:247], a[80:83], v[100:103]
    v_mfma_f32_16x16x32_bf16 v[104:107], a[240:243], a[84:87], v[104:107]
    v_mfma_f32_16x16x32_bf16 v[108:111], a[244:247], a[84:87], v[108:111]
    v_mfma_f32_16x16x32_bf16 v[96:99], a[248:251], a[88:91], v[96:99]
    v_mfma_f32_16x16x32_bf16 v[100:103], a[252:255], a[88:91], v[100:103]
    v_mfma_f32_16x16x32_bf16 v[104:107], a[248:251], a[92:95], v[104:107]
    v_mfma_f32_16x16x32_bf16 v[108:111], a[252:255], a[92:95], v[108:111]
    s_nop 4
    v_cvt_pk_bf16_f32 v192, v96, v97
    v_cvt_pk_bf16_f32 v193, v98, v99
    v_cvt_pk_bf16_f32 v194, v100, v101
    v_cvt_pk_bf16_f32 v195, v102, v103
    buffer_store_dwordx4 v[192:195], v4, s[44:47], s68 offen offset:2048 sc1
    v_cvt_pk_bf16_f32 v196, v104, v105
    v_cvt_pk_bf16_f32 v197, v106, v107
    v_cvt_pk_bf16_f32 v198, v108, v109
    v_cvt_pk_bf16_f32 v199, v110, v111
    buffer_store_dwordx4 v[196:199], v4, s[44:47], s17 offen offset:2048 sc1
    v_add3_u32 v164, v192, v193, v194
    v_add3_u32 v165, v196, v197, v198
    v_lshl_add_u32 v164, v195, 1, v164
    v_lshl_add_u32 v165, v199, 1, v165
    s_nop 0
    v_add_u32_dpp v164, v164, v164 quad_perm:[1,0,3,2] row_mask:0xf bank_mask:0xf
    v_add_u32_dpp v165, v165, v165 quad_perm:[1,0,3,2] row_mask:0xf bank_mask:0xf
    s_nop 0
    v_add_u32_dpp v164, v164, v164 quad_perm:[2,3,0,1] row_mask:0xf bank_mask:0xf
    v_add_u32_dpp v165, v165, v165 quad_perm:[2,3,0,1] row_mask:0xf bank_mask:0xf
    v_and_b32 v164, v10, v164
    v_and_b32 v165, v11, v165
    v_add3_u32 v164, v164, v165, v6
    buffer_store_dword v164, v5, s[44:47], s75 offen offset:3328 sc1
L_st2:
    s_barrier
    s_cmp_eq_u32 s3, 3
    s_cbranch_scc1 L_fin
    s_mov_b32 s74, 524288
    s_lshl_b32 s67, s3, 7
    v_bfe_u32 v7, v0, 2, 3
    v_lshl_add_u32 v3, v7, 12, s67
    v_and_b32 v7, 3, v0
    v_lshl_add_u32 v3, v7, 5, v3
    s_lshl_b32 s65, s62, 2
    s_lshl_b32 s65, 15, s65
L_h:
    buffer_load_dword v2, v3, s[44:47], s28 offen offset:3100 sc1
    s_sub_u32 s74, s74, 1
    s_cmp_le_u32 s74, 1
    s_cbranch_scc1 L_gd
    s_waitcnt vmcnt(0)
    v_cmp_ne_u32 vcc, s22, v2
    s_nop 0
    s_andn2_b32 s66, vcc_lo, s65
    s_cbranch_scc1 L_h
L_g:
    buffer_load_dwordx4 v[128:131], v239, s[44:47], s28 offen sc1
    buffer_load_dword v32, v240, s[44:47], s28 offen offset:3072 sc1
    buffer_load_dwordx4 v[132:135], v239, s[44:47], s29 offen sc1
    buffer_load_dword v33, v240, s[44:47], s29 offen offset:3072 sc1
    buffer_load_dwordx4 v[136:139], v239, s[44:47], s30 offen sc1
    buffer_load_dword v34, v240, s[44:47], s30 offen offset:3072 sc1
    buffer_load_dwordx4 v[140:143], v239, s[44:47], s31 offen sc1
    buffer_load_dword v35, v240, s[44:47], s31 offen offset:3072 sc1
    buffer_load_dwordx4 v[144:147], v239, s[44:47], s32 offen sc1
    buffer_load_dword v36, v240, s[44:47], s32 offen offset:3072 sc1
    buffer_load_dwordx4 v[148:151], v239, s[44:47], s33 offen sc1
    buffer_load_dword v37, v240, s[44:47], s33 offen offset:3072 sc1
    buffer_load_dwordx4 v[152:155], v239, s[44:47], s34 offen sc1
    buffer_load_dword v38, v240, s[44:47], s34 offen offset:3072 sc1
    buffer_load_dwordx4 v[156:159], v239, s[44:47], s35 offen sc1
    buffer_load_dword v39, v240, s[44:47], s35 offen offset:3072 sc1
L_g2:
    s_sub_u32 s74, s74, 1
    s_cmp_le_u32 s74, 1
    s_waitcnt vmcnt(14)
    v_mfma_f32_32x32x16_bf16 v[64:79], v[28:31], v[128:131], 0
    v_add3_u32 v6, v128, v129, v130
    v_lshl_add_u32 v6, v131, 1, v6
    v_add_u32 v7, s23, v32
    s_waitcnt vmcnt(12)
    v_mfma_f32_32x32x16_bf16 v[64:79], v[28:31], v[132:135], v[64:79]
    v_add3_u32 v6, v132, v133, v6
    v_add_u32 v6, v134, v6
    v_lshl_add_u32 v6, v135, 1, v6
    v_add_u32 v7, v33, v7
    s_waitcnt vmcnt(10)
    v_mfma_f32_32x32x16_bf16 v[64:79], v[28:31], v[136:139], v[64:79]
    v_add3_u32 v6, v136, v137, v6
    v_add_u32 v6, v138, v6
    v_lshl_add_u32 v6, v139, 1, v6
    v_add_u32 v7, v34, v7
    s_waitcnt vmcnt(8)
    v_mfma_f32_32x32x16_bf16 v[64:79], v[28:31], v[140:143], v[64:79]
    v_add3_u32 v6, v140, v141, v6
    v_add_u32 v6, v142, v6
    v_lshl_add_u32 v6, v143, 1, v6
    v_add_u32 v7, v35, v7
    s_waitcnt vmcnt(6)
    v_mfma_f32_32x32x16_bf16 v[64:79], v[28:31], v[144:147], v[64:79]
    v_add3_u32 v6, v144, v145, v6
    v_add_u32 v6, v146, v6
    v_lshl_add_u32 v6, v147, 1, v6
    v_add_u32 v7, v36, v7
    s_waitcnt vmcnt(4)
    v_mfma_f32_32x32x16_bf16 v[64:79], v[28:31], v[148:151], v[64:79]
    v_add3_u32 v6, v148, v149, v6
    v_add_u32 v6, v150, v6
    v_lshl_add_u32 v6, v151, 1, v6
    v_add_u32 v7, v37, v7
    s_waitcnt vmcnt(2)
    v_mfma_f32_32x32x16_bf16 v[64:79], v[28:31], v[152:155], v[64:79]
    v_add3_u32 v6, v152, v153, v6
    v_add_u32 v6, v154, v6
    v_lshl_add_u32 v6, v155, 1, v6
    v_add_u32 v7, v38, v7
    s_waitcnt vmcnt(0)
    v_mfma_f32_32x32x16_bf16 v[64:79], v[28:31], v[156:159], v[64:79]
    v_add3_u32 v6, v156, v157, v6
    v_add_u32 v6, v158, v6
    v_lshl_add_u32 v6, v159, 1, v6
    v_add_u32 v7, v39, v7
    s_nop 0
    v_add_u32_dpp v6, v6, v6 quad_perm:[1,0,3,2] row_mask:0xf bank_mask:0xf
    s_nop 1
    v_add_u32_dpp v6, v6, v6 quad_perm:[2,3,0,1] row_mask:0xf bank_mask:0xf
    s_cbranch_scc1 L_gd
    v_cmp_ne_u32 vcc, v6, v7
    s_cbranch_vccnz L_g
L_gd:
    s_nop 1
    v_cvt_pk_bf16_f32 v8, v64, v65
    v_cvt_pk_bf16_f32 v9, v66, v67
    v_cvt_pk_bf16_f32 v10, v68, v69
    v_cvt_pk_bf16_f32 v11, v70, v71
    buffer_store_dwordx4 v[8:11], v255, s[52:55], s36 offen
L_fin:
    s_endpgm
L_dec:
    s_mov_b32 s74, 524288
L_dec1:
    s_waitcnt vmcnt(0)
    v_cmp_ne_u32 vcc, 1, v253
    s_nop 0
    s_quadmask_b32 s12, vcc_lo
    s_or_b32 s12, s12, s10
    s_andn2_b32 s66, 14, s12
    s_cbranch_scc1 L_dec3
L_dec2:
    buffer_load_dword v253, v234, s[48:51], s9 offen sc1
    s_sub_u32 s74, s74, 1
    s_cmp_eq_u32 s74, 0
    s_cbranch_scc0 L_dec1
    s_branch L_decb
L_dec3:
    s_call_b64 s[14:15], L_inc1
    s_cbranch_scc0 L_dec2
    s_branch L_decb
L_inc:
    s_waitcnt vmcnt(0)
    v_cmp_ne_u32 vcc, 1, v253
    s_nop 0
    s_quadmask_b32 s12, vcc_lo
    s_or_b32 s12, s12, s10
L_inc1:
    s_bitcmp1_b32 s12, 1
    s_cbranch_scc1 L_in_207
    s_bitset1_b32 s10, 1
    s_mov_b32 m0, 24576
    s_sub_u32 s67, s71, 6144
    buffer_load_dwordx4 v250, s[40:43], s67 offen offset:0 sc1 lds
    buffer_load_dwordx4 v250, s[40:43], s67 offen offset:1024 sc1 lds
    buffer_load_dwordx4 v250, s[40:43], s67 offen offset:2048 sc1 lds
    buffer_load_dwordx4 v250, s[40:43], s67 offen offset:3072 sc1 lds
    s_mov_b32 m0, 28672
    s_sub_u32 s67, s71, 2048
    buffer_load_dwordx4 v250, s[40:43], s67 offen offset:0 sc1 lds
    buffer_load_dwordx4 v250, s[40:43], s67 offen offset:1024 sc1 lds
    buffer_load_dwordx4 v250, s[40:43], s67 offen offset:2048 sc1 lds
    buffer_load_dwordx4 v250, s[40:43], s67 offen offset:3072 sc1 lds
L_in_207:
    s_bitcmp1_b32 s12, 2
    s_cbranch_scc1 L_in_208
    s_bitset1_b32 s10, 2
    s_mov_b32 m0, 32768
    s_sub_u32 s67, s72, 6144
    buffer_load_dwordx4 v250, s[40:43], s67 offen offset:0 sc1 lds
    buffer_load_dwordx4 v250, s[40:43], s67 offen offset:1024 sc1 lds
    buffer_load_dwordx4 v250, s[40:43], s67 offen offset:2048 sc1 lds
    buffer_load_dwordx4 v250, s[40:43], s67 offen offset:3072 sc1 lds
    s_mov_b32 m0, 36864
    s_sub_u32 s67, s72, 2048
    buffer_load_dwordx4 v250, s[40:43], s67 offen offset:0 sc1 lds
    buffer_load_dwordx4 v250, s[40:43], s67 offen offset:1024 sc1 lds
    buffer_load_dwordx4 v250, s[40:43], s67 offen offset:2048 sc1 lds
    buffer_load_dwordx4 v250, s[40:43], s67 offen offset:3072 sc1 lds
L_in_208:
    s_bitcmp1_b32 s12, 3
    s_cbranch_scc1 L_in_209
    s_bitset1_b32 s10, 3
    s_mov_b32 m0, 40960
    s_sub_u32 s67, s73, 6144
    buffer_load_dwordx4 v250, s[40:43], s67 offen offset:0 sc1 lds
    buffer_load_dwordx4 v250, s[40:43], s67 offen offset:1024 sc1 lds
    buffer_load_dwordx4 v250, s[40:43], s67 offen offset:2048 sc1 lds
    buffer_load_dwordx4 v250, s[40:43], s67 offen offset:3072 sc1 lds
    s_mov_b32 m0, 45056
    s_sub_u32 s67, s73, 2048
    buffer_load_dwordx4 v250, s[40:43], s67 offen offset:0 sc1 lds
    buffer_load_dwordx4 v250, s[40:43], s67 offen offset:1024 sc1 lds
    buffer_load_dwordx4 v250, s[40:43], s67 offen offset:2048 sc1 lds
    buffer_load_dwordx4 v250, s[40:43], s67 offen offset:3072 sc1 lds
L_in_209:
    s_cmp_eq_u32 s10, 14
    s_cselect_b32 s11, 32, 0
    s_setpc_b64 s[14:15]
L_far:
    s_nop 11
    s_waitcnt lgkmcnt(10)
    v_mfma_f32_32x32x16_bf16 v[80:95], a[80:83], v[216:219], v[80:95]
    ds_read_b32 v246, v247
    ds_read_b64_tr_b16 a[96:97], v8 offset:8192
    ds_read_b64_tr_b16 a[98:99], v8 offset:9216
    ds_read_b64_tr_b16 a[100:101], v8 offset:10240
    ds_read_b64_tr_b16 a[102:103], v8 offset:11264
    ds_read_b64_tr_b16 a[104:105], v8 offset:12288
    s_waitcnt lgkmcnt(14)
    v_mfma_f32_32x32x16_bf16 v[80:95], a[84:87], v[220:223], v[80:95]
    ds_read_b64_tr_b16 a[106:107], v8 offset:13312
    ds_read_b64_tr_b16 a[108:109], v8 offset:14336
    ds_read_b64_tr_b16 a[110:111], v8 offset:15360
    ds_read_b64_tr_b16 a[112:113], v9 offset:8192
    ds_read_b64_tr_b16 a[114:115], v9 offset:9216
    ds_read_b64_tr_b16 a[116:117], v9 offset:10240
    s_waitcnt lgkmcnt(15)
    v_mfma_f32_32x32x16_bf16 v[80:95], a[88:91], v[56:59], v[80:95]
    ds_read_b64_tr_b16 a[118:119], v9 offset:11264
    ds_read_b64_tr_b16 a[120:121], v9 offset:12288
    ds_read_b64_tr_b16 a[122:123], v9 offset:13312
    ds_read_b64_tr_b16 a[124:125], v9 offset:14336
    ds_read_b64_tr_b16 a[126:127], v9 offset:15360
    v_pk_mul_f32 v[64:65], v[64:65], v[244:245] op_sel_hi:[1,0]
    v_pk_mul_f32 v[66:67], v[66:67], v[244:245] op_sel_hi:[1,0]
    v_pk_mul_f32 v[68:69], v[68:69], v[244:245] op_sel_hi:[1,0]
    v_pk_mul_f32 v[70:71], v[70:71], v[244:245] op_sel_hi:[1,0]
    v_cvt_pk_bf16_f32 v128, v64, v65
    v_cvt_pk_bf16_f32 v129, v66, v67
    v_cvt_pk_bf16_f32 v130, v68, v69
    v_cvt_pk_bf16_f32 v131, v70, v71
    v_mfma_f32_32x32x16_bf16 v[80:95], a[92:95], v[60:63], v[80:95]
    ds_write_b128 v2, v[128:131] offset:0
    s_waitcnt lgkmcnt(15)
    v_cmp_le_u32 vcc, 90, v246
    v_pk_mul_f32 v[72:73], v[72:73], v[244:245] op_sel_hi:[1,0]
    v_pk_mul_f32 v[74:75], v[74:75], v[244:245] op_sel_hi:[1,0]
    v_pk_mul_f32 v[76:77], v[76:77], v[244:245] op_sel_hi:[1,0]
    v_pk_mul_f32 v[78:79], v[78:79], v[244:245] op_sel_hi:[1,0]
    v_cvt_pk_bf16_f32 v132, v72, v73
    v_cvt_pk_bf16_f32 v133, v74, v75
    v_cvt_pk_bf16_f32 v134, v76, v77
    v_cvt_pk_bf16_f32 v135, v78, v79
    s_cbranch_vccz L_rt_210
L_rb_211:
    s_waitcnt lgkmcnt(14)
    v_mfma_f32_32x32x16_bf16 v[96:111], a[96:99], v[216:219], v[96:111]
    buffer_store_dwordx4 v[128:131], v250, s[40:43], s24 offen offset:0 sc1
    buffer_store_dwordx4 v[132:135], v250, s[40:43], s24 offen offset:1024 sc1
    ds_write_b128 v2, v[132:135] offset:1024
    v_pk_mul_f32 v[80:81], v[80:81], v[244:245] op_sel_hi:[1,0]
    v_pk_mul_f32 v[82:83], v[82:83], v[244:245] op_sel_hi:[1,0]
    v_pk_mul_f32 v[84:85], v[84:85], v[244:245] op_sel_hi:[1,0]
    v_pk_mul_f32 v[86:87], v[86:87], v[244:245] op_sel_hi:[1,0]
    v_cvt_pk_bf16_f32 v136, v80, v81
    v_cvt_pk_bf16_f32 v137, v82, v83
    v_cvt_pk_bf16_f32 v138, v84, v85
    v_cvt_pk_bf16_f32 v139, v86, v87
    s_waitcnt lgkmcnt(13)
    v_mfma_f32_32x32x16_bf16 v[96:111], a[100:103], v[220:223], v[96:111]
    buffer_store_dwordx4 v[136:139], v250, s[40:43], s24 offen offset:2048 sc1
    ds_write_b128 v2, v[136:139] offset:2048
    v_pk_mul_f32 v[88:89], v[88:89], v[244:245] op_sel_hi:[1,0]
    v_pk_mul_f32 v[90:91], v[90:91], v[244:245] op_sel_hi:[1,0]
    v_pk_mul_f32 v[92:93], v[92:93], v[244:245] op_sel_hi:[1,0]
    v_pk_mul_f32 v[94:95], v[94:95], v[244:245] op_sel_hi:[1,0]
    v_cvt_pk_bf16_f32 v140, v88, v89
    v_cvt_pk_bf16_f32 v141, v90, v91
    v_cvt_pk_bf16_f32 v142, v92, v93
    v_cvt_pk_bf16_f32 v143, v94, v95
    s_waitcnt lgkmcnt(12)
    v_mfma_f32_32x32x16_bf16 v[96:111], a[104:107], v[56:59], v[96:111]
    buffer_store_dwordx4 v[140:143], v250, s[40:43], s24 offen offset:3072 sc1
    ds_write_b128 v2, v[140:143] offset:3072
    s_waitcnt lgkmcnt(11)
    v_mfma_f32_32x32x16_bf16 v[96:111], a[108:111], v[60:63], v[96:111]
    s_waitcnt lgkmcnt(9)
    v_mfma_f32_32x32x16_bf16 v[112:127], a[112:115], v[216:219], v[112:127]
    s_waitcnt lgkmcnt(7)
    v_mfma_f32_32x32x16_bf16 v[112:127], a[116:119], v[220:223], v[112:127]
    s_waitcnt lgkmcnt(5)
    v_mfma_f32_32x32x16_bf16 v[112:127], a[120:123], v[56:59], v[112:127]
    s_nop 5
    v_pk_mul_f32 v[96:97], v[96:97], v[244:245] op_sel_hi:[1,0]
    v_pk_mul_f32 v[98:99], v[98:99], v[244:245] op_sel_hi:[1,0]
    v_pk_mul_f32 v[100:101], v[100:101], v[244:245] op_sel_hi:[1,0]
    v_pk_mul_f32 v[102:103], v[102:103], v[244:245] op_sel_hi:[1,0]
    v_cvt_pk_bf16_f32 v144, v96, v97
    v_cvt_pk_bf16_f32 v145, v98, v99
    v_cvt_pk_bf16_f32 v146, v100, v101
    v_cvt_pk_bf16_f32 v147, v102, v103
    s_waitcnt lgkmcnt(3)
    v_mfma_f32_32x32x16_bf16 v[112:127], a[124:127], v[60:63], v[112:127]
    buffer_store_dwordx4 v[144:147], v250, s[40:43], s25 offen offset:0 sc1
    ds_write_b128 v2, v[144:147] offset:4096
    v_pk_mul_f32 v[104:105], v[104:105], v[244:245] op_sel_hi:[1,0]
    v_pk_mul_f32 v[106:107], v[106:107], v[244:245] op_sel_hi:[1,0]
    v_pk_mul_f32 v[108:109], v[108:109], v[244:245] op_sel_hi:[1,0]
    v_pk_mul_f32 v[110:111], v[110:111], v[244:245] op_sel_hi:[1,0]
    v_cvt_pk_bf16_f32 v148, v104, v105
    v_cvt_pk_bf16_f32 v149, v106, v107
    v_cvt_pk_bf16_f32 v150, v108, v109
    v_cvt_pk_bf16_f32 v151, v110, v111
    buffer_store_dwordx4 v[148:151], v250, s[40:43], s25 offen offset:1024 sc1
    ds_write_b128 v2, v[148:151] offset:5120
    v_pk_mul_f32 v[112:113], v[112:113], v[244:245] op_sel_hi:[1,0]
    v_pk_mul_f32 v[114:115], v[114:115], v[244:245] op_sel_hi:[1,0]
    v_pk_mul_f32 v[116:117], v[116:117], v[244:245] op_sel_hi:[1,0]
    v_pk_mul_f32 v[118:119], v[118:119], v[244:245] op_sel_hi:[1,0]
    v_cvt_pk_bf16_f32 v152, v112, v113
    v_cvt_pk_bf16_f32 v153, v114, v115
    v_cvt_pk_bf16_f32 v154, v116, v117
    v_cvt_pk_bf16_f32 v155, v118, v119
    buffer_store_dwordx4 v[152:155], v250, s[40:43], s25 offen offset:2048 sc1
    ds_write_b128 v2, v[152:155] offset:6144
    v_pk_mul_f32 v[120:121], v[120:121], v[244:245] op_sel_hi:[1,0]
    v_pk_mul_f32 v[122:123], v[122:123], v[244:245] op_sel_hi:[1,0]
    v_pk_mul_f32 v[124:125], v[124:125], v[244:245] op_sel_hi:[1,0]
    v_pk_mul_f32 v[126:127], v[126:127], v[244:245] op_sel_hi:[1,0]
    v_cvt_pk_bf16_f32 v156, v120, v121
    v_cvt_pk_bf16_f32 v157, v122, v123
    v_cvt_pk_bf16_f32 v158, v124, v125
    v_cvt_pk_bf16_f32 v159, v126, v127
    buffer_store_dwordx4 v[156:159], v250, s[40:43], s25 offen offset:3072 sc1
    ds_write_b128 v2, v[156:159] offset:7168
    s_branch L_tail
L_rt_185:
    s_mov_b32 s74, 4194304
L_rt_212:
    ds_read_b32 v246, v247
    s_sub_u32 s74, s74, 1
    s_cmp_eq_u32 s74, 0
    s_cbranch_scc1 L_rt_213
    s_waitcnt lgkmcnt(0)
    v_cmp_le_u32 vcc, 77, v246
    s_cbranch_vccz L_rt_212
L_rt_213:
    ds_read_b64_tr_b16 a[64:65], v224 offset:16384
    ds_read_b64_tr_b16 a[66:67], v224 offset:18432
    ds_read_b64_tr_b16 a[68:69], v225 offset:16384
    ds_read_b64_tr_b16 a[70:71], v225 offset:18432
    ds_read_b64_tr_b16 a[72:73], v226 offset:16384
    ds_read_b64_tr_b16 a[74:75], v226 offset:18432
    ds_read_b64_tr_b16 a[76:77], v227 offset:16384
    ds_read_b64_tr_b16 a[78:79], v227 offset:18432
    ds_read_b64_tr_b16 a[80:81], v224 offset:20480
    ds_read_b64_tr_b16 a[82:83], v224 offset:22528
    ds_read_b64_tr_b16 a[84:85], v225 offset:20480
    ds_read_b64_tr_b16 a[86:87], v225 offset:22528
    ds_read_b64_tr_b16 a[88:89], v226 offset:20480
    ds_read_b64_tr_b16 a[90:91], v226 offset:22528
    ds_read_b64_tr_b16 a[92:93], v227 offset:20480
    ds_read_b64_tr_b16 a[94:95], v227 offset:22528
    s_branch L_rb_186
L_rt_189:
    s_mov_b32 s74, 4194304
L_rt_214:
    ds_read_b32 v246, v247
    s_sub_u32 s74, s74, 1
    s_cmp_eq_u32 s74, 0
    s_cbranch_scc1 L_rt_215
    s_waitcnt lgkmcnt(0)
    v_cmp_le_u32 vcc, 78, v246
    s_cbranch_vccz L_rt_214
L_rt_215:
    ds_read_b64_tr_b16 a[96:97], v224 offset:24576
    ds_read_b64_tr_b16 a[98:99], v224 offset:26624
    ds_read_b64_tr_b16 a[100:101], v225 offset:24576
    ds_read_b64_tr_b16 a[102:103], v225 offset:26624
    ds_read_b64_tr_b16 a[104:105], v226 offset:24576
    ds_read_b64_tr_b16 a[106:107], v226 offset:26624
    ds_read_b64_tr_b16 a[108:109], v227 offset:24576
    ds_read_b64_tr_b16 a[110:111], v227 offset:26624
    ds_read_b64_tr_b16 a[112:113], v224 offset:28672
    ds_read_b64_tr_b16 a[114:115], v224 offset:30720
    ds_read_b64_tr_b16 a[116:117], v225 offset:28672
    ds_read_b64_tr_b16 a[118:119], v225 offset:30720
    ds_read_b64_tr_b16 a[120:121], v226 offset:28672
    ds_read_b64_tr_b16 a[122:123], v226 offset:30720
    ds_read_b64_tr_b16 a[124:125], v227 offset:28672
    ds_read_b64_tr_b16 a[126:127], v227 offset:30720
    s_branch L_rb_190
L_rt_193:
    s_mov_b32 s74, 4194304
L_rt_216:
    ds_read_b32 v246, v247
    s_sub_u32 s74, s74, 1
    s_cmp_eq_u32 s74, 0
    s_cbranch_scc1 L_rt_217
    s_waitcnt lgkmcnt(0)
    v_cmp_le_u32 vcc, 82, v246
    s_cbranch_vccz L_rt_216
L_rt_217:
    ds_read_b64_tr_b16 a[64:65], v224 offset:32768
    ds_read_b64_tr_b16 a[66:67], v224 offset:34816
    ds_read_b64_tr_b16 a[68:69], v225 offset:32768
    ds_read_b64_tr_b16 a[70:71], v225 offset:34816
    ds_read_b64_tr_b16 a[72:73], v226 offset:32768
    ds_read_b64_tr_b16 a[74:75], v226 offset:34816
    ds_read_b64_tr_b16 a[76:77], v227 offset:32768
    ds_read_b64_tr_b16 a[78:79], v227 offset:34816
    ds_read_b64_tr_b16 a[80:81], v224 offset:36864
    ds_read_b64_tr_b16 a[82:83], v224 offset:38912
    ds_read_b64_tr_b16 a[84:85], v225 offset:36864
    ds_read_b64_tr_b16 a[86:87], v225 offset:38912
    ds_read_b64_tr_b16 a[88:89], v226 offset:36864
    ds_read_b64_tr_b16 a[90:91], v226 offset:38912
    ds_read_b64_tr_b16 a[92:93], v227 offset:36864
    ds_read_b64_tr_b16 a[94:95], v227 offset:38912
    s_branch L_rb_194
L_rt_195:
    s_mov_b32 s74, 4194304
L_rt_218:
    ds_read_b32 v246, v247
    s_sub_u32 s74, s74, 1
    s_cmp_eq_u32 s74, 0
    s_cbranch_scc1 L_rt_219
    s_waitcnt lgkmcnt(0)
    v_cmp_le_u32 vcc, 83, v246
    s_cbranch_vccz L_rt_218
L_rt_219:
    ds_read_b64_tr_b16 a[96:97], v224 offset:40960
    ds_read_b64_tr_b16 a[98:99], v224 offset:43008
    ds_read_b64_tr_b16 a[100:101], v225 offset:40960
    ds_read_b64_tr_b16 a[102:103], v225 offset:43008
    ds_read_b64_tr_b16 a[104:105], v226 offset:40960
    ds_read_b64_tr_b16 a[106:107], v226 offset:43008
    ds_read_b64_tr_b16 a[108:109], v227 offset:40960
    ds_read_b64_tr_b16 a[110:111], v227 offset:43008
    ds_read_b64_tr_b16 a[112:113], v224 offset:45056
    ds_read_b64_tr_b16 a[114:115], v224 offset:47104
    ds_read_b64_tr_b16 a[116:117], v225 offset:45056
    ds_read_b64_tr_b16 a[118:119], v225 offset:47104
    ds_read_b64_tr_b16 a[120:121], v226 offset:45056
    ds_read_b64_tr_b16 a[122:123], v226 offset:47104
    ds_read_b64_tr_b16 a[124:125], v227 offset:45056
    ds_read_b64_tr_b16 a[126:127], v227 offset:47104
    s_branch L_rb_196
L_rt_199:
    s_mov_b32 s74, 4194304
L_rt_220:
    ds_read_b32 v246, v247
    ds_read_b64_tr_b16 a[64:65], v8 offset:0
    ds_read_b64_tr_b16 a[66:67], v8 offset:1024
    ds_read_b64_tr_b16 a[68:69], v8 offset:2048
    ds_read_b64_tr_b16 a[70:71], v8 offset:3072
    ds_read_b64_tr_b16 a[72:73], v8 offset:4096
    ds_read_b64_tr_b16 a[74:75], v8 offset:5120
    ds_read_b64_tr_b16 a[76:77], v8 offset:6144
    ds_read_b64_tr_b16 a[78:79], v8 offset:7168
    ds_read_b64_tr_b16 a[80:81], v9 offset:0
    ds_read_b64_tr_b16 a[82:83], v9 offset:1024
    ds_read_b64_tr_b16 a[84:85], v9 offset:2048
    ds_read_b64_tr_b16 a[86:87], v9 offset:3072
    ds_read_b64_tr_b16 a[88:89], v9 offset:4096
    ds_read_b64_tr_b16 a[90:91], v9 offset:5120
    ds_read_b64_tr_b16 a[92:93], v9 offset:6144
    ds_read_b64_tr_b16 a[94:95], v9 offset:7168
    s_sub_u32 s74, s74, 1
    s_waitcnt lgkmcnt(15)
    v_cmp_le_u32 vcc, 87, v246
    s_cmp_eq_u32 s74, 0
    s_cbranch_vccnz L_rb_200
    s_cbranch_scc0 L_rt_220
    s_branch L_rb_200
L_rt_201:
    s_mov_b32 s74, 4194304
L_rt_221:
    ds_read_b32 v246, v247
    ds_read_b64_tr_b16 a[96:97], v8 offset:8192
    ds_read_b64_tr_b16 a[98:99], v8 offset:9216
    ds_read_b64_tr_b16 a[100:101], v8 offset:10240
    ds_read_b64_tr_b16 a[102:103], v8 offset:11264
    ds_read_b64_tr_b16 a[104:105], v8 offset:12288
    ds_read_b64_tr_b16 a[106:107], v8 offset:13312
    ds_read_b64_tr_b16 a[108:109], v8 offset:14336
    ds_read_b64_tr_b16 a[110:111], v8 offset:15360
    ds_read_b64_tr_b16 a[112:113], v9 offset:8192
    ds_read_b64_tr_b16 a[114:115], v9 offset:9216
    ds_read_b64_tr_b16 a[116:117], v9 offset:10240
    ds_read_b64_tr_b16 a[118:119], v9 offset:11264
    ds_read_b64_tr_b16 a[120:121], v9 offset:12288
    ds_read_b64_tr_b16 a[122:123], v9 offset:13312
    ds_read_b64_tr_b16 a[124:125], v9 offset:14336
    ds_read_b64_tr_b16 a[126:127], v9 offset:15360
    s_sub_u32 s74, s74, 1
    s_waitcnt lgkmcnt(15)
    v_cmp_le_u32 vcc, 90, v246
    s_cmp_eq_u32 s74, 0
    s_cbranch_vccnz L_rb_202
    s_cbranch_scc0 L_rt_221
    s_branch L_rb_202
L_rt_210:
    s_mov_b32 s74, 4194304
L_rt_222:
    ds_read_b32 v246, v247
    ds_read_b64_tr_b16 a[96:97], v8 offset:8192
    ds_read_b64_tr_b16 a[98:99], v8 offset:9216
    ds_read_b64_tr_b16 a[100:101], v8 offset:10240
    ds_read_b64_tr_b16 a[102:103], v8 offset:11264
    ds_read_b64_tr_b16 a[104:105], v8 offset:12288
    ds_read_b64_tr_b16 a[106:107], v8 offset:13312
    ds_read_b64_tr_b16 a[108:109], v8 offset:14336
    ds_read_b64_tr_b16 a[110:111], v8 offset:15360
    ds_read_b64_tr_b16 a[112:113], v9 offset:8192
    ds_read_b64_tr_b16 a[114:115], v9 offset:9216
    ds_read_b64_tr_b16 a[116:117], v9 offset:10240
    ds_read_b64_tr_b16 a[118:119], v9 offset:11264
    ds_read_b64_tr_b16 a[120:121], v9 offset:12288
    ds_read_b64_tr_b16 a[122:123], v9 offset:13312
    ds_read_b64_tr_b16 a[124:125], v9 offset:14336
    ds_read_b64_tr_b16 a[126:127], v9 offset:15360
    s_sub_u32 s74, s74, 1
    s_waitcnt lgkmcnt(15)
    v_cmp_le_u32 vcc, 90, v246
    s_cmp_eq_u32 s74, 0
    s_cbranch_vccnz L_rb_211
    s_cbranch_scc0 L_rt_222
    s_branch L_rb_211
L_st_65:
    v_mov_b32 v243, 1
    s_call_b64 s[14:15], L_spin
    s_branch L_bk_66
L_st_67:
    v_mov_b32 v243, 2
    s_call_b64 s[14:15], L_spin
    s_branch L_bk_68
L_st_69:
    v_mov_b32 v243, 3
    s_call_b64 s[14:15], L_spin
    s_branch L_bk_70
L_st_71:
    v_mov_b32 v243, 4
    s_call_b64 s[14:15], L_spin
    s_branch L_bk_72
L_st_73:
    s_call_b64 s[14:15], L_checkin
    s_branch L_bk_74
L_st_75:
    v_mov_b32 v243, 11
    s_call_b64 s[14:15], L_spin
    s_branch L_bk_76
L_st_77:
    s_call_b64 s[14:15], L_newref
    v_exp_f32 v242, v245
    s_bitset1_b32 s4, 1
    s_branch L_bk_78
L_st_79:
    v_mov_b32 v243, 22
    s_call_b64 s[14:15], L_spin
    s_branch L_bk_80
L_st_81:
    s_call_b64 s[14:15], L_newref
    v_exp_f32 v241, v245
    s_bitset1_b32 s4, 0
    s_branch L_bk_82
L_st_83:
    v_mov_b32 v243, 23
    s_call_b64 s[14:15], L_spin
    s_branch L_bk_84
L_st_85:
    v_mov_b32 v245, v242
    s_bitset0_b32 s4, 1
    s_call_b64 s[14:15], L_rescale
    s_branch L_bk_86
L_st_87:
    v_mov_b32 v243, 26
    s_call_b64 s[14:15], L_spin
    s_branch L_bk_88
L_st_89:
    s_call_b64 s[14:15], L_newref
    v_exp_f32 v242, v245
    s_bitset1_b32 s4, 1
    s_branch L_bk_90
L_st_91:
    v_mov_b32 v243, 28
    s_call_b64 s[14:15], L_spin
    s_branch L_bk_92
L_st_93:
    v_mov_b32 v245, v241
    s_bitset0_b32 s4, 0
    s_call_b64 s[14:15], L_rescale
    s_branch L_bk_94
L_st_95:
    v_mov_b32 v243, 31
    s_call_b64 s[14:15], L_spin
    s_branch L_bk_96
L_st_97:
    s_call_b64 s[14:15], L_newref
    v_exp_f32 v241, v245
    s_bitset1_b32 s4, 0
    s_branch L_bk_98
L_st_99:
    v_mov_b32 v243, 32
    s_call_b64 s[14:15], L_spin
    s_branch L_bk_100
L_st_101:
    v_mov_b32 v245, v242
    s_bitset0_b32 s4, 1
    s_call_b64 s[14:15], L_rescale
    s_branch L_bk_102
L_st_103:
    v_mov_b32 v243, 35
    s_call_b64 s[14:15], L_spin
    s_branch L_bk_104
L_st_105:
    s_call_b64 s[14:15], L_newref
    v_exp_f32 v242, v245
    s_bitset1_b32 s4, 1
    s_branch L_bk_106
L_st_107:
    v_mov_b32 v243, 37
    s_call_b64 s[14:15], L_spin
    s_branch L_bk_108
L_st_109:
    v_mov_b32 v245, v241
    s_bitset0_b32 s4, 0
    s_call_b64 s[14:15], L_rescale
    s_branch L_bk_110
L_st_111:
    v_mov_b32 v243, 39
    s_call_b64 s[14:15], L_spin
    s_branch L_bk_112
L_st_113:
    s_call_b64 s[14:15], L_newref
    v_exp_f32 v241, v245
    s_bitset1_b32 s4, 0
    s_branch L_bk_114
L_st_115:
    v_mov_b32 v243, 41
    s_call_b64 s[14:15], L_spin
    s_branch L_bk_116
L_st_117:
    v_mov_b32 v245, v242
    s_bitset0_b32 s4, 1
    s_call_b64 s[14:15], L_rescale
    s_branch L_bk_118
L_st_119:
    v_mov_b32 v243, 44
    s_call_b64 s[14:15], L_spin
    s_branch L_bk_120
L_st_121:
    s_call_b64 s[14:15], L_newref
    v_exp_f32 v242, v245
    s_bitset1_b32 s4, 1
    s_branch L_bk_122
L_st_123:
    v_mov_b32 v243, 45
    s_call_b64 s[14:15], L_spin
    s_branch L_bk_124
L_st_125:
    v_mov_b32 v245, v241
    s_bitset0_b32 s4, 0
    s_call_b64 s[14:15], L_rescale
    s_branch L_bk_126
L_st_127:
    v_mov_b32 v243, 48
    s_call_b64 s[14:15], L_spin
    s_branch L_bk_128
L_st_129:
    s_call_b64 s[14:15], L_newref
    v_exp_f32 v241, v245
    s_bitset1_b32 s4, 0
    s_branch L_bk_130
L_st_131:
    v_mov_b32 v243, 49
    s_call_b64 s[14:15], L_spin
    s_branch L_bk_132
L_st_133:
    v_mov_b32 v245, v242
    s_bitset0_b32 s4, 1
    s_call_b64 s[14:15], L_rescale
    s_branch L_bk_134
L_st_135:
    v_mov_b32 v243, 52
    s_call_b64 s[14:15], L_spin
    s_branch L_bk_136
L_st_137:
    s_call_b64 s[14:15], L_newref
    v_exp_f32 v242, v245
    s_bitset1_b32 s4, 1
    s_branch L_bk_138
L_st_139:
    v_mov_b32 v243, 53
    s_call_b64 s[14:15], L_spin
    s_branch L_bk_140
L_st_141:
    v_mov_b32 v245, v241
    s_bitset0_b32 s4, 0
    s_call_b64 s[14:15], L_rescale
    s_branch L_bk_142
L_st_143:
    v_mov_b32 v243, 56
    s_call_b64 s[14:15], L_spin
    s_branch L_bk_144
L_st_145:
    s_call_b64 s[14:15], L_newref
    v_exp_f32 v241, v245
    s_bitset1_b32 s4, 0
    s_branch L_bk_146
L_st_147:
    v_mov_b32 v243, 57
    s_call_b64 s[14:15], L_spin
    s_branch L_bk_148
L_st_149:
    v_mov_b32 v245, v242
    s_bitset0_b32 s4, 1
    s_call_b64 s[14:15], L_rescale
    s_branch L_bk_150
L_st_151:
    v_mov_b32 v243, 60
    s_call_b64 s[14:15], L_spin
    s_branch L_bk_152
L_st_153:
    s_call_b64 s[14:15], L_newref
    v_exp_f32 v242, v245
    s_bitset1_b32 s4, 1
    s_branch L_bk_154
L_st_155:
    v_mov_b32 v243, 61
    s_call_b64 s[14:15], L_spin
    s_branch L_bk_156
L_st_157:
    s_call_b64 s[14:15], L_cispin
    s_branch L_bk_158
L_st_159:
    v_mov_b32 v245, v241
    s_bitset0_b32 s4, 0
    s_call_b64 s[14:15], L_rescale
    s_branch L_bk_160
L_st_161:
    v_mov_b32 v243, 64
    s_call_b64 s[14:15], L_spin
    s_branch L_bk_162
L_st_163:
    s_call_b64 s[14:15], L_newref
    v_exp_f32 v241, v245
    s_bitset1_b32 s4, 0
    s_branch L_bk_164
L_st_165:
    v_mov_b32 v243, 66
    s_call_b64 s[14:15], L_spin
    s_branch L_bk_166
L_st_167:
    v_mov_b32 v245, v242
    s_bitset0_b32 s4, 1
    s_call_b64 s[14:15], L_rescale
    s_branch L_bk_168
L_st_169:
    v_mov_b32 v243, 68
    s_call_b64 s[14:15], L_spin
    s_branch L_bk_170
L_st_171:
    s_call_b64 s[14:15], L_newref
    v_exp_f32 v242, v245
    s_bitset1_b32 s4, 1
    s_branch L_bk_172
L_st_173:
    v_mov_b32 v243, 70
    s_call_b64 s[14:15], L_spin
    s_branch L_bk_174
L_st_175:
    v_mov_b32 v245, v241
    s_bitset0_b32 s4, 0
    s_call_b64 s[14:15], L_rescale
    s_branch L_bk_176
L_st_177:
    v_mov_b32 v243, 73
    s_call_b64 s[14:15], L_spin
    s_branch L_bk_178
L_st_179:
    s_call_b64 s[14:15], L_newref
    v_exp_f32 v241, v245
    s_bitset1_b32 s4, 0
    s_branch L_bk_180
L_st_181:
    v_mov_b32 v243, 75
    s_call_b64 s[14:15], L_spin
    s_branch L_bk_182
L_st_183:
    v_mov_b32 v245, v242
    s_bitset0_b32 s4, 1
    s_call_b64 s[14:15], L_rescale
    s_branch L_bk_184
L_st_187:
    s_call_b64 s[14:15], L_newref
    v_exp_f32 v242, v245
    s_bitset1_b32 s4, 1
    s_branch L_bk_188
L_st_191:
    v_mov_b32 v245, v241
    s_bitset0_b32 s4, 0
    s_call_b64 s[14:15], L_rescale
    s_branch L_bk_192
L_st_197:
    v_mov_b32 v245, v242
    s_bitset0_b32 s4, 1
    s_call_b64 s[14:15], L_rescale
    s_branch L_bk_198
L_spin:
    s_mov_b32 s74, 4194304
L_spin2:
    ds_read_b32 v246, v247
    s_sub_u32 s74, s74, 1
    s_cmp_eq_u32 s74, 0
    s_cbranch_scc1 L_spin3
    s_waitcnt lgkmcnt(0)
    v_cmp_le_u32 vcc, v243, v246
    s_cbranch_vccz L_spin2
L_spin3:
    s_waitcnt lgkmcnt(0)
    s_setpc_b64 s[14:15]
L_checkin:
    s_lshl_b32 s65, s60, 5
    v_mov_b32 v2, 1
    v_mov_b32 v3, 0
    s_mov_b64 exec, 1
    s_waitcnt vmcnt(0)
    buffer_atomic_add v2, v3, s[56:59], s65 offen sc1
    s_mov_b64 exec, -1
    s_setpc_b64 s[14:15]
L_cispin:
    s_mov_b32 s74, 524288
L_ci2:
    buffer_load_dword v2, v3, s[56:59], s65 offen sc1
    s_sub_u32 s74, s74, 1
    s_cmp_eq_u32 s74, 0
    s_cbranch_scc1 L_ci3
    s_waitcnt vmcnt(0)
    v_cmp_le_u32 vcc, 32, v2
    s_cbranch_vccz L_ci2
L_ci3:
    s_waitcnt vmcnt(0)
    s_setpc_b64 s[14:15]
L_newref:
    s_nop 7
    v_mov_b32 v245, v244
    s_nop 1
    v_permlane32_swap_b32 v244, v245
    v_max3_f32 v244, v244, v245, 0
    v_sub_f32 v128, v128, v244
    v_sub_f32 v129, v129, v244
    v_sub_f32 v130, v130, v244
    v_sub_f32 v131, v131, v244
    v_sub_f32 v132, v132, v244
    v_sub_f32 v133, v133, v244
    v_sub_f32 v134, v134, v244
    v_sub_f32 v135, v135, v244
    v_sub_f32 v136, v136, v244
    v_sub_f32 v137, v137, v244
    v_sub_f32 v138, v138, v244
    v_sub_f32 v139, v139, v244
    v_sub_f32 v140, v140, v244
    v_sub_f32 v141, v141, v244
    v_sub_f32 v142, v142, v244
    v_sub_f32 v143, v143, v244
    v_sub_f32 v144, v144, v244
    v_sub_f32 v145, v145, v244
    v_sub_f32 v146, v146, v244
    v_sub_f32 v147, v147, v244
    v_sub_f32 v148, v148, v244
    v_sub_f32 v149, v149, v244
    v_sub_f32 v150, v150, v244
    v_sub_f32 v151, v151, v244
    v_sub_f32 v152, v152, v244
    v_sub_f32 v153, v153, v244
    v_sub_f32 v154, v154, v244
    v_sub_f32 v155, v155, v244
    v_sub_f32 v156, v156, v244
    v_sub_f32 v157, v157, v244
    v_sub_f32 v158, v158, v244
    v_sub_f32 v159, v159, v244
    v_sub_f32 v32, v32, v244
    v_sub_f32 v33, v33, v244
    v_sub_f32 v34, v34, v244
    v_sub_f32 v35, v35, v244
    v_sub_f32 v36, v36, v244
    v_sub_f32 v37, v37, v244
    v_sub_f32 v38, v38, v244
    v_sub_f32 v39, v39, v244
    v_sub_f32 v40, v40, v244
    v_sub_f32 v41, v41, v244
    v_sub_f32 v42, v42, v244
    v_sub_f32 v43, v43, v244
    v_sub_f32 v44, v44, v244
    v_sub_f32 v45, v45, v244
    v_sub_f32 v46, v46, v244
    v_sub_f32 v47, v47, v244
    v_sub_f32 v245, 0, v244
    s_setpc_b64 s[14:15]
L_rescale:
    s_nop 15
    v_mul_f32 v64, v245, v64
    v_mul_f32 v65, v245, v65
    v_mul_f32 v66, v245, v66
    v_mul_f32 v67, v245, v67
    v_mul_f32 v68, v245, v68
    v_mul_f32 v69, v245, v69
    v_mul_f32 v70, v245, v70
    v_mul_f32 v71, v245, v71
    v_mul_f32 v72, v245, v72
    v_mul_f32 v73, v245, v73
    v_mul_f32 v74, v245, v74
    v_mul_f32 v75, v245, v75
    v_mul_f32 v76, v245, v76
    v_mul_f32 v77, v245, v77
    v_mul_f32 v78, v245, v78
    v_mul_f32 v79, v245, v79
    v_mul_f32 v80, v245, v80
    v_mul_f32 v81, v245, v81
    v_mul_f32 v82, v245, v82
    v_mul_f32 v83, v245, v83
    v_mul_f32 v84, v245, v84
    v_mul_f32 v85, v245, v85
    v_mul_f32 v86, v245, v86
    v_mul_f32 v87, v245, v87
    v_mul_f32 v88, v245, v88
    v_mul_f32 v89, v245, v89
    v_mul_f32 v90, v245, v90
    v_mul_f32 v91, v245, v91
    v_mul_f32 v92, v245, v92
    v_mul_f32 v93, v245, v93
    v_mul_f32 v94, v245, v94
    v_mul_f32 v95, v245, v95
    v_mul_f32 v96, v245, v96
    v_mul_f32 v97, v245, v97
    v_mul_f32 v98, v245, v98
    v_mul_f32 v99, v245, v99
    v_mul_f32 v100, v245, v100
    v_mul_f32 v101, v245, v101
    v_mul_f32 v102, v245, v102
    v_mul_f32 v103, v245, v103
    v_mul_f32 v104, v245, v104
    v_mul_f32 v105, v245, v105
    v_mul_f32 v106, v245, v106
    v_mul_f32 v107, v245, v107
    v_mul_f32 v108, v245, v108
    v_mul_f32 v109, v245, v109
    v_mul_f32 v110, v245, v110
    v_mul_f32 v111, v245, v111
    v_mul_f32 v112, v245, v112
    v_mul_f32 v113, v245, v113
    v_mul_f32 v114, v245, v114
    v_mul_f32 v115, v245, v115
    v_mul_f32 v116, v245, v116
    v_mul_f32 v117, v245, v117
    v_mul_f32 v118, v245, v118
    v_mul_f32 v119, v245, v119
    v_mul_f32 v120, v245, v120
    v_mul_f32 v121, v245, v121
    v_mul_f32 v122, v245, v122
    v_mul_f32 v123, v245, v123
    v_mul_f32 v124, v245, v124
    v_mul_f32 v125, v245, v125
    v_mul_f32 v126, v245, v126
    v_mul_f32 v127, v245, v127
    v_mul_f32 v48, v245, v48
    v_mul_f32 v49, v245, v49
    v_mul_f32 v50, v245, v50
    v_mul_f32 v51, v245, v51
    s_nop 0
    s_setpc_b64 s[14:15]
L_end:
    s_endpgm
.section .rodata,"a"
.p2align 6
.amdhsa_kernel standalone__mha_block_cached__near_ridge_kernel
  .amdhsa_next_free_vgpr 512
  .amdhsa_next_free_sgpr 102
  .amdhsa_accum_offset 256
  .amdhsa_group_segment_fixed_size 0
  .amdhsa_kernarg_size 64
  .amdhsa_user_sgpr_count 2
  .amdhsa_user_sgpr_kernarg_segment_ptr 1
  .amdhsa_system_sgpr_workgroup_id_x 1
.end_amdhsa_kernel
```
